```python
import torch

def _softmax(x, axis=-1):
    return torch.softmax(x, dim=axis)

def _gelu(x):
    return torch.nn.functional.gelu(x, approximate='tanh')

def _silu(x):
    return torch.nn.functional.silu(x)

def _sigmoid(x):
    return torch.sigmoid(x)

def _layernorm(x, axis=-1, eps=1e-05):
    m = x.mean(dim=axis, keepdim=True)
    v = x.var(dim=axis, keepdim=True, unbiased=False)
    return (x - m) / torch.sqrt(v + eps)

def _scatter_add(tgt, idx, src, axis=0):
    return tgt.clone().index_add_(axis, idx, src)

def _segment_sum(src, seg, n):
    out = torch.zeros((n,) + src.shape[1:], dtype=src.dtype)
    return out.index_add_(0, seg, src)

def _pad(x, pw):
    flat = tuple((v for pair in reversed(pw) for v in pair))
    return torch.nn.functional.pad(x, flat)
kernel_name = 'standalone__tree_speculative_verify_tree_attention_over_candidate_token_tree__sampling'

def setup_inputs():

    _w = lambda a: (lambda t: t.to(torch.bfloat16) if t.is_floating_point() else t)(torch.as_tensor(a))
    B, Hq, Hkv, T, C, D = (8, 16, 8, 16, 8192, 256)
    tree_mask = torch.zeros((B, T, T), dtype=float)
    for b in range(B):
        parent = torch.zeros(T, dtype=torch.int64)
        for i in range(1, T):
            parent[i] = int(torch.randint(0, i, (1,)).item())
        for i in range(T):
            j = i
            tree_mask[b, i, j] = 1.0
            while j > 0:
                j = parent[j]
                tree_mask[b, i, j] = 1.0
    return {'q': _w((lambda *s: torch.randn(*s, dtype=torch.bfloat16) * 0.8)(B, Hq, T, D)), 'k_cache': _w((lambda *s: torch.randn(*s, dtype=torch.bfloat16) * 0.8)(B, Hkv, C, D)), 'v_cache': _w((lambda *s: torch.randn(*s, dtype=torch.bfloat16) * 0.05)(B, Hkv, C, D)), 'k_tree': _w((lambda *s: torch.randn(*s, dtype=torch.bfloat16) * 0.8)(B, Hkv, T, D)), 'v_tree': _w((lambda *s: torch.randn(*s, dtype=torch.bfloat16) * 0.05)(B, Hkv, T, D)), 'tree_mask': _w(tree_mask)}

def reference(q, k_cache, v_cache, k_tree, v_tree, tree_mask):
    B, Hq, T, D = q.shape
    Hkv, C = (k_cache.shape[1], k_cache.shape[2])
    rep = Hq // Hkv
    kc = (lambda x, n, axis: torch.repeat_interleave(x, n, dim=axis))(k_cache, rep, axis=1)
    vc = (lambda x, n, axis: torch.repeat_interleave(x, n, dim=axis))(v_cache, rep, axis=1)
    kt = (lambda x, n, axis: torch.repeat_interleave(x, n, dim=axis))(k_tree, rep, axis=1)
    vt = (lambda x, n, axis: torch.repeat_interleave(x, n, dim=axis))(v_tree, rep, axis=1)
    k = torch.concatenate([kc, kt], axis=2)
    v = torch.concatenate([vc, vt], axis=2)
    scale = D ** (-0.5)
    scores = torch.einsum('bhqd,bhkd->bhqk', q, k) * scale
    ctx_mask = torch.ones((B, 1, T, C), dtype=scores.dtype)
    tm = tree_mask[:, None, :, :].clone()
    full_mask = torch.concatenate([ctx_mask, tm], axis=-1)
    scores = scores + (1.0 - full_mask) * -1000000000.0
    p = _softmax(scores, axis=-1)
    return torch.einsum('bhqk,bhkd->bhqd', p, v)
```

```asm
; @launch grid=(256,1,1) block=(256,1,1) lds=152576
.amdgcn_target "amdgcn-amd-amdhsa--gfx950"
.text
.globl standalone__tree_speculative_verify_tree_attention_over_candidate_token_tree__sampling_kernel
.p2align 8
.type standalone__tree_speculative_verify_tree_attention_over_candidate_token_tree__sampling_kernel,@function
standalone__tree_speculative_verify_tree_attention_over_candidate_token_tree__sampling_kernel:
  s_cmp_ge_u32 s2, 256
  s_cbranch_scc1 L_done
  s_load_dwordx16 s[16:31], s[0:1], 0
  s_load_dwordx2 s[32:33], s[0:1], 64
  v_lshrrev_b32 v4, 6, v0
  v_and_b32 v0, 63, v0
  v_readfirstlane_b32 s3, v4
  s_lshr_b32 s52, s2, 2
  s_lshr_b32 s53, s2, 3
  s_add_u32 s53, s53, s2
  s_and_b32 s53, s53, 3
  v_lshrrev_b32 v4, 5, v0
  v_and_b32 v5, 31, v0
  v_lshlrev_b32 v2, 4, v0
  v_lshlrev_b32 v12, 6, v4
  v_xor_b32 v1, v2, v12
  v_lshlrev_b32 v13, 4, v4
  v_xor_b32 v13, v13, v2
  s_and_b32 s58, s3, 1
  s_lshl_b32 s58, s58, 7
  v_xor_b32 v13, s58, v13
  s_lshl_b32 s43, s3, 15
  s_lshl_b32 s55, s53, 20
  s_lshl_b32 s57, s3, 12
  s_add_u32 s55, s55, s57
  s_mov_b32 s11, 0x20000
  s_mov_b32 s15, 0x20000
  s_mov_b32 s39, 0x20000
  s_mov_b32 s10, 0x400000
  s_mov_b32 s14, 0x400000
  s_mov_b32 s38, 16384
  s_add_u32 s44, s55, 0
  s_add_u32 s45, s55, 16384
  s_add_u32 s46, s55, 32768
  s_add_u32 s47, s55, 49152
  s_lshl_b32 s56, s52, 22
  s_lshl_b32 s58, s52, 14
  s_waitcnt lgkmcnt(0)
  s_add_u32 s60, s18, s56
  s_addc_u32 s61, s19, 0
  s_and_b32 s61, s61, 0xffff
  s_mov_b32 s8, s60
  s_mov_b32 s9, s61
  s_add_u32 s36, s16, s58
  s_addc_u32 s37, s17, 0
  s_and_b32 s37, s37, 0xffff
  s_add_u32 m0, s43, 0
  s_nop 0
  buffer_load_dwordx4 v1, s[8:11], s44 offen offset:0 nt lds
  v_xor_b32 v5, 16, v1
  buffer_load_dwordx4 v5, s[8:11], s44 offen offset:1024 nt lds
  v_xor_b32 v4, 32, v1
  buffer_load_dwordx4 v4, s[8:11], s44 offen offset:2048 nt lds
  v_xor_b32 v5, 48, v1
  buffer_load_dwordx4 v5, s[8:11], s44 offen offset:3072 nt lds
  s_add_u32 m0, s57, 132096
  v_xor_b32 v12, 0, v13
  buffer_load_dwordx4 v12, s[36:39], s57 offen offset:0 lds
  v_xor_b32 v12, 32, v13
  buffer_load_dwordx4 v12, s[36:39], s57 offen offset:1024 lds
  v_xor_b32 v12, 64, v13
  buffer_load_dwordx4 v12, s[36:39], s57 offen offset:2048 lds
  v_xor_b32 v12, 96, v13
  buffer_load_dwordx4 v12, s[36:39], s57 offen offset:3072 lds
  s_lshl_b32 s80, s53, 2
  s_add_u32 s80, s80, s3
  s_lshl_b32 s83, s80, 9
  s_lshl_b32 s58, s52, 13
  s_add_u32 s36, s22, s58
  s_addc_u32 s37, s23, 0
  s_and_b32 s37, s37, 0xffff
  s_mov_b32 s38, 8192
  s_lshl_b32 s82, s3, 10
  s_add_u32 m0, s82, 148480
  v_and_b32 v12, 0x1f0, v2
  buffer_load_dwordx4 v2, s[36:39], s83 offen lds
  s_add_u32 s36, s24, s58
  s_addc_u32 s37, s25, 0
  s_and_b32 s37, s37, 0xffff
  buffer_load_dwordx4 v[64:67], v12, s[36:39], s83 offen
  s_lshr_b32 s58, s52, 3
  s_lshl_b32 s58, s58, 9
  s_add_u32 s36, s26, s58
  s_addc_u32 s37, s27, 0
  s_and_b32 s37, s37, 0xffff
  s_mov_b32 s38, 512
  s_lshl_b32 s83, s80, 1
  v_and_b32 v12, 15, v0
  v_lshlrev_b32 v12, 5, v12
  buffer_load_ushort v63, v12, s[36:39], s83 offen
  s_add_u32 m0, s43, 4096
  v_xor_b32 v4, 128, v1
  buffer_load_dwordx4 v4, s[8:11], s45 offen offset:0 nt lds
  v_xor_b32 v5, 144, v1
  buffer_load_dwordx4 v5, s[8:11], s45 offen offset:1024 nt lds
  v_xor_b32 v4, 160, v1
  buffer_load_dwordx4 v4, s[8:11], s45 offen offset:2048 nt lds
  v_xor_b32 v5, 176, v1
  buffer_load_dwordx4 v5, s[8:11], s45 offen offset:3072 nt lds
  s_add_u32 m0, s43, 8192
  s_nop 0
  buffer_load_dwordx4 v1, s[8:11], s46 offen offset:0 nt lds
  v_xor_b32 v5, 16, v1
  buffer_load_dwordx4 v5, s[8:11], s46 offen offset:1024 nt lds
  v_xor_b32 v4, 32, v1
  buffer_load_dwordx4 v4, s[8:11], s46 offen offset:2048 nt lds
  v_xor_b32 v5, 48, v1
  buffer_load_dwordx4 v5, s[8:11], s46 offen offset:3072 nt lds
  s_add_u32 m0, s43, 12288
  v_xor_b32 v4, 128, v1
  buffer_load_dwordx4 v4, s[8:11], s47 offen offset:0 nt lds
  v_xor_b32 v5, 144, v1
  buffer_load_dwordx4 v5, s[8:11], s47 offen offset:1024 nt lds
  v_xor_b32 v4, 160, v1
  buffer_load_dwordx4 v4, s[8:11], s47 offen offset:2048 nt lds
  v_xor_b32 v5, 176, v1
  buffer_load_dwordx4 v5, s[8:11], s47 offen offset:3072 nt lds
  s_add_u32 s62, s20, s56
  s_addc_u32 s63, s21, 0
  s_and_b32 s63, s63, 0xffff
  s_mov_b32 s12, s62
  s_mov_b32 s13, s63
  v_lshrrev_b32 v4, 5, v0
  v_and_b32 v5, 31, v0
  v_and_b32 v12, 24, v5
  v_and_b32 v13, 3, v5
  v_lshl_add_u32 v12, v13, 1, v12
  v_bfe_u32 v13, v5, 2, 1
  v_add_u32 v12, v12, v13
  v_and_b32 v13, 15, v5
  v_xor_b32 v13, v13, v4
  v_lshlrev_b32 v13, 4, v13
  v_lshl_add_u32 v3, v12, 9, v13
  v_add_u32 v3, s43, v3
  v_lshl_add_u32 v13, v5, 9, v13
  v_add_u32 v13, 132096, v13
  s_cmp_lg_u32 s53, 0
  s_cselect_b64 vcc, -1, 0
  v_mov_b32 v60, 0
  v_mov_b32 v61, 0
  s_lshl_b32 s58, s3, 2
  s_add_u32 s58, s58, 16
  v_mov_b32 v62, s58
  s_mov_b32 s40, 0x3db8aa3b
  s_mov_b32 s41, 0x05040100
  s_mov_b32 s42, 0x07060302
  s_mov_b32 s59, 1
  s_mov_b32 s75, 0x20000
  s_mov_b32 s79, 0x20000
  s_mov_b32 s81, 0
  s_mov_b32 s54, 15
  s_cmp_eq_u32 s53, 0
  s_cselect_b32 s86, 2, 2
  s_lshl_b32 s56, s52, 2
  s_add_u32 s72, s30, s56
  s_addc_u32 s73, s31, 0
  s_and_b32 s73, s73, 0xffff
  s_mov_b32 s74, 4
  s_lshl_b32 s56, s52, 8
  s_add_u32 s56, s56, 16777216
  s_add_u32 s76, s32, s56
  s_addc_u32 s77, s33, 0
  s_and_b32 s77, s77, 0xffff
  s_mov_b32 s78, 32
  s_cmp_eq_u32 s3, 0
  s_cbranch_scc0 L_noticket
  v_mov_b32 v15, 1
  s_mov_b64 exec, 1
  buffer_atomic_add v15, v60, s[72:75], 0 offen sc0
  s_mov_b64 exec, -1
  s_mov_b32 s81, 1
L_noticket:
  v_lshrrev_b32 v4, 5, v0
  v_lshlrev_b32 v8, 4, v4
  s_add_u32 s82, s82, 148480
  v_add_u32 v8, s82, v8
  v_sub_u32 v4, 1, v4
  v_mul_u32_u24 v32, 0x3f80, v4
  v_cvt_f32_u32 v7, v4
  v_mov_b32 v33, 0
  v_mov_b32 v34, 0
  v_mov_b32 v35, 0
  v_mov_b32 v40, 0
  v_mov_b32 v41, 0
  v_mov_b32 v42, 0
  v_mov_b32 v43, 0
  v_mov_b32 v44, 0
  v_mov_b32 v45, 0
  v_mov_b32 v46, 0
  v_mov_b32 v47, 0
  v_mov_b32 v48, 0
  v_mov_b32 v49, 0
  v_mov_b32 v50, 0
  v_mov_b32 v51, 0
  v_mov_b32 v52, 0
  v_mov_b32 v53, 0
  v_mov_b32 v54, 0
  v_mov_b32 v55, 0
  s_waitcnt vmcnt(12)
  s_barrier
  v_xor_b32 v12, 0, v13
  ds_read_b128 a[0:3], v12 offset:0
  ds_read_b128 a[32:35], v12 offset:256
  v_xor_b32 v12, 32, v13
  ds_read_b128 a[4:7], v12 offset:0
  ds_read_b128 a[36:39], v12 offset:256
  v_xor_b32 v12, 64, v13
  ds_read_b128 a[8:11], v12 offset:0
  ds_read_b128 a[40:43], v12 offset:256
  v_xor_b32 v12, 96, v13
  ds_read_b128 a[12:15], v12 offset:0
  ds_read_b128 a[44:47], v12 offset:256
  v_xor_b32 v12, 128, v13
  ds_read_b128 a[16:19], v12 offset:0
  ds_read_b128 a[48:51], v12 offset:256
  v_xor_b32 v12, 160, v13
  ds_read_b128 a[20:23], v12 offset:0
  ds_read_b128 a[52:55], v12 offset:256
  v_xor_b32 v12, 192, v13
  ds_read_b128 a[24:27], v12 offset:0
  ds_read_b128 a[56:59], v12 offset:256
  v_xor_b32 v12, 224, v13
  ds_read_b128 a[28:31], v12 offset:0
  ds_read_b128 a[60:63], v12 offset:256
  s_waitcnt lgkmcnt(0)
  s_branch L_s_sinit
L_s_sinit:
  s_add_u32 s44, s55, 65536
  s_add_u32 s45, s55, 81920
  s_add_u32 s46, s55, 98304
  s_add_u32 s47, s55, 114688
  v_mov_b32 v16, 0
  v_mov_b32 v17, 0
  v_mov_b32 v18, 0
  v_mov_b32 v19, 0
  v_mov_b32 v20, 0
  v_mov_b32 v21, 0
  v_mov_b32 v22, 0
  v_mov_b32 v23, 0
  v_mov_b32 v24, 0
  v_mov_b32 v25, 0
  v_mov_b32 v26, 0
  v_mov_b32 v27, 0
  v_mov_b32 v28, 0
  v_mov_b32 v29, 0
  v_mov_b32 v30, 0
  v_mov_b32 v31, 0
  ds_read_b128 a[64:67], v8 offset:0
  ds_read_b128 a[68:71], v8 offset:32
  ds_read_b128 a[72:75], v8 offset:64
  ds_read_b128 a[76:79], v8 offset:96
  ds_read_b128 a[80:83], v8 offset:128
  ds_read_b128 a[84:87], v8 offset:160
  ds_read_b128 a[88:91], v8 offset:192
  ds_read_b128 a[92:95], v8 offset:224
  ds_read_b128 a[96:99], v8 offset:256
  ds_read_b128 a[100:103], v8 offset:288
  ds_read_b128 a[104:107], v8 offset:320
  ds_read_b128 a[108:111], v8 offset:352
  ds_read_b128 a[112:115], v8 offset:384
  ds_read_b128 a[116:119], v8 offset:416
  ds_read_b128 a[120:123], v8 offset:448
  ds_read_b128 a[124:127], v8 offset:480
  s_waitcnt lgkmcnt(15)
  v_mfma_f32_32x32x16_bf16 v[16:31], a[64:67], a[0:3], v[16:31]
  s_waitcnt lgkmcnt(14)
  v_mfma_f32_32x32x16_bf16 v[16:31], a[68:71], a[4:7], v[16:31]
  s_waitcnt lgkmcnt(13)
  v_mfma_f32_32x32x16_bf16 v[16:31], a[72:75], a[8:11], v[16:31]
  s_waitcnt lgkmcnt(12)
  v_mfma_f32_32x32x16_bf16 v[16:31], a[76:79], a[12:15], v[16:31]
  s_waitcnt lgkmcnt(11)
  v_mfma_f32_32x32x16_bf16 v[16:31], a[80:83], a[16:19], v[16:31]
  s_waitcnt lgkmcnt(10)
  v_mfma_f32_32x32x16_bf16 v[16:31], a[84:87], a[20:23], v[16:31]
  s_waitcnt lgkmcnt(9)
  v_mfma_f32_32x32x16_bf16 v[16:31], a[88:91], a[24:27], v[16:31]
  s_waitcnt lgkmcnt(8)
  v_mfma_f32_32x32x16_bf16 v[16:31], a[92:95], a[28:31], v[16:31]
  s_waitcnt lgkmcnt(7)
  v_mfma_f32_32x32x16_bf16 v[16:31], a[96:99], a[32:35], v[16:31]
  s_waitcnt lgkmcnt(6)
  v_mfma_f32_32x32x16_bf16 v[16:31], a[100:103], a[36:39], v[16:31]
  s_waitcnt lgkmcnt(5)
  v_mfma_f32_32x32x16_bf16 v[16:31], a[104:107], a[40:43], v[16:31]
  s_waitcnt lgkmcnt(4)
  v_mfma_f32_32x32x16_bf16 v[16:31], a[108:111], a[44:47], v[16:31]
  s_waitcnt lgkmcnt(3)
  v_mfma_f32_32x32x16_bf16 v[16:31], a[112:115], a[48:51], v[16:31]
  s_waitcnt lgkmcnt(2)
  v_mfma_f32_32x32x16_bf16 v[16:31], a[116:119], a[52:55], v[16:31]
  s_waitcnt lgkmcnt(1)
  v_mfma_f32_32x32x16_bf16 v[16:31], a[120:123], a[56:59], v[16:31]
  s_waitcnt lgkmcnt(0)
  v_mfma_f32_32x32x16_bf16 v[16:31], a[124:127], a[60:63], v[16:31]
  v_perm_b32 v40, v64, v64, s41
  s_nop 1
  v_mfma_f32_32x32x16_bf16 v[128:143], v[40:43], v[32:35], 0
  v_perm_b32 v44, v64, v64, s42
  s_nop 1
  v_mfma_f32_32x32x16_bf16 v[144:159], v[44:47], v[32:35], 0
  v_perm_b32 v48, v65, v65, s41
  s_nop 1
  v_mfma_f32_32x32x16_bf16 v[160:175], v[48:51], v[32:35], 0
  v_perm_b32 v52, v65, v65, s42
  s_nop 1
  v_mfma_f32_32x32x16_bf16 v[176:191], v[52:55], v[32:35], 0
  v_perm_b32 v40, v66, v66, s41
  s_nop 1
  v_mfma_f32_32x32x16_bf16 v[192:207], v[40:43], v[32:35], 0
  v_perm_b32 v44, v66, v66, s42
  s_nop 1
  v_mfma_f32_32x32x16_bf16 v[208:223], v[44:47], v[32:35], 0
  v_perm_b32 v48, v67, v67, s41
  s_nop 1
  v_mfma_f32_32x32x16_bf16 v[224:239], v[48:51], v[32:35], 0
  v_perm_b32 v52, v67, v67, s42
  s_nop 1
  v_mfma_f32_32x32x16_bf16 v[240:255], v[52:55], v[32:35], 0
  s_mov_b32 s56, 0x506e6b28
  v_mov_b32 v12, 0xd06e6b28
  v_lshlrev_b32 v63, 16, v63
  v_fma_f32 v63, v63, s56, v12
  v_add_f32 v63, v63, v16
  v_mul_f32 v6, s40, v63
  v_mov_b32 v16, 0
  v_mov_b32 v17, 0
  v_mov_b32 v18, 0
  v_mov_b32 v19, 0
  v_mov_b32 v20, 0
  v_mov_b32 v21, 0
  v_mov_b32 v22, 0
  v_mov_b32 v23, 0
  v_mov_b32 v24, 0
  v_mov_b32 v25, 0
  v_mov_b32 v26, 0
  v_mov_b32 v27, 0
  v_mov_b32 v28, 0
  v_mov_b32 v29, 0
  v_mov_b32 v30, 0
  v_mov_b32 v31, 0
  s_nop 1
  s_add_u32 m0, s43, 16384
  s_nop 0
  s_waitcnt vmcnt(4)
  buffer_load_dwordx4 v1, s[8:11], s44 offen offset:0 nt lds
  v_xor_b32 v5, 16, v1
  s_waitcnt vmcnt(4)
  buffer_load_dwordx4 v5, s[8:11], s44 offen offset:1024 nt lds
  v_xor_b32 v4, 32, v1
  s_waitcnt vmcnt(5)
  s_cbranch_vccnz L_w1
  s_waitcnt vmcnt(4)
L_w1:
  buffer_load_dwordx4 v4, s[8:11], s44 offen offset:2048 nt lds
  v_xor_b32 v5, 48, v1
  s_waitcnt vmcnt(4)
  buffer_load_dwordx4 v5, s[8:11], s44 offen offset:3072 nt lds
  s_add_u32 m0, s43, 20480
  v_xor_b32 v4, 128, v1
  s_waitcnt vmcnt(4)
  buffer_load_dwordx4 v4, s[8:11], s45 offen offset:0 nt lds
  ds_read_b128 a[64:67], v3 offset:0
  ds_read_b128 a[68:71], v3 offset:256
  v_xor_b32 v5, 32, v3
  ds_read_b128 a[72:75], v5 offset:0
  ds_read_b128 a[76:79], v5 offset:256
  v_xor_b32 v4, 64, v3
  ds_read_b128 a[80:83], v4 offset:0
  ds_read_b128 a[84:87], v4 offset:256
  v_xor_b32 v5, 96, v3
  ds_read_b128 a[88:91], v5 offset:0
  ds_read_b128 a[92:95], v5 offset:256
  v_xor_b32 v4, 128, v3
  ds_read_b128 a[96:99], v4 offset:0
  ds_read_b128 a[100:103], v4 offset:256
  v_xor_b32 v5, 160, v3
  ds_read_b128 a[104:107], v5 offset:0
  ds_read_b128 a[108:111], v5 offset:256
  v_xor_b32 v4, 192, v3
  ds_read_b128 a[112:115], v4 offset:0
  ds_read_b128 a[116:119], v4 offset:256
  v_xor_b32 v5, 224, v3
  ds_read_b128 a[120:123], v5 offset:0
  ds_read_b128 a[124:127], v5 offset:256
  s_waitcnt lgkmcnt(15)
  v_mfma_f32_32x32x16_bf16 v[16:31], a[64:67], a[0:3], v[16:31]
  s_waitcnt lgkmcnt(14)
  v_mfma_f32_32x32x16_bf16 v[16:31], a[68:71], a[32:35], v[16:31]
  v_xor_b32 v5, 144, v1
  s_waitcnt vmcnt(4)
  buffer_load_dwordx4 v5, s[8:11], s45 offen offset:1024 nt lds
  s_waitcnt lgkmcnt(13)
  v_mfma_f32_32x32x16_bf16 v[16:31], a[72:75], a[4:7], v[16:31]
  s_waitcnt lgkmcnt(12)
  v_mfma_f32_32x32x16_bf16 v[16:31], a[76:79], a[36:39], v[16:31]
  s_waitcnt lgkmcnt(11)
  v_mfma_f32_32x32x16_bf16 v[16:31], a[80:83], a[8:11], v[16:31]
  v_xor_b32 v4, 160, v1
  s_waitcnt vmcnt(4)
  buffer_load_dwordx4 v4, s[8:11], s45 offen offset:2048 nt lds
  s_waitcnt lgkmcnt(10)
  v_mfma_f32_32x32x16_bf16 v[16:31], a[84:87], a[40:43], v[16:31]
  s_waitcnt lgkmcnt(9)
  v_mfma_f32_32x32x16_bf16 v[16:31], a[88:91], a[12:15], v[16:31]
  s_waitcnt lgkmcnt(8)
  v_mfma_f32_32x32x16_bf16 v[16:31], a[92:95], a[44:47], v[16:31]
  v_xor_b32 v5, 176, v1
  s_waitcnt vmcnt(4)
  buffer_load_dwordx4 v5, s[8:11], s45 offen offset:3072 nt lds
  s_waitcnt lgkmcnt(7)
  v_mfma_f32_32x32x16_bf16 v[16:31], a[96:99], a[16:19], v[16:31]
  s_waitcnt lgkmcnt(6)
  v_mfma_f32_32x32x16_bf16 v[16:31], a[100:103], a[48:51], v[16:31]
  s_waitcnt lgkmcnt(5)
  v_mfma_f32_32x32x16_bf16 v[16:31], a[104:107], a[20:23], v[16:31]
  s_add_u32 m0, s43, 24576
  s_nop 0
  s_waitcnt vmcnt(4)
  buffer_load_dwordx4 v1, s[8:11], s46 offen offset:0 nt lds
  s_waitcnt lgkmcnt(4)
  v_mfma_f32_32x32x16_bf16 v[16:31], a[108:111], a[52:55], v[16:31]
  s_waitcnt lgkmcnt(3)
  v_mfma_f32_32x32x16_bf16 v[16:31], a[112:115], a[24:27], v[16:31]
  s_waitcnt lgkmcnt(2)
  v_mfma_f32_32x32x16_bf16 v[16:31], a[116:119], a[56:59], v[16:31]
  v_xor_b32 v5, 16, v1
  s_waitcnt vmcnt(4)
  buffer_load_dwordx4 v5, s[8:11], s46 offen offset:1024 nt lds
  s_waitcnt lgkmcnt(1)
  v_mfma_f32_32x32x16_bf16 v[16:31], a[120:123], a[28:31], v[16:31]
  s_waitcnt lgkmcnt(0)
  v_mfma_f32_32x32x16_bf16 v[16:31], a[124:127], a[60:63], v[16:31]
  v_xor_b32 v4, 32, v1
  s_waitcnt vmcnt(5)
  s_cbranch_vccnz L_w2
  s_waitcnt vmcnt(4)
L_w2:
  buffer_load_dwordx4 v4, s[8:11], s46 offen offset:2048 nt lds
  s_nop 7
  s_nop 3
  v_max3_f32 v8, v16, v17, v18
  v_max3_f32 v8, v8, v19, v20
  v_max3_f32 v8, v8, v21, v22
  v_max3_f32 v8, v8, v23, v24
  v_max3_f32 v8, v8, v25, v26
  v_max3_f32 v8, v8, v27, v28
  v_max3_f32 v8, v8, v29, v30
  v_max_f32 v8, v8, v31
  v_mul_f32 v8, s40, v8
  v_mov_b32 v9, v8
  s_nop 1
  v_permlane32_swap_b32 v8, v9
  s_nop 1
  v_max3_f32 v8, v8, v9, v6
  v_sub_f32 v10, v6, v8
  v_exp_f32 v10, v10
  v_mov_b32 v6, v8
  v_mov_b32 v11, v10
  v_mul_f32 v7, v7, v10
  v_mov_b32 v40, v10
  v_xor_b32 v5, 48, v1
  s_waitcnt vmcnt(4)
  buffer_load_dwordx4 v5, s[8:11], s46 offen offset:3072 nt lds
  v_fma_f32 v16, v16, s40, -v6
  v_fma_f32 v17, v17, s40, -v6
  v_fma_f32 v18, v18, s40, -v6
  v_fma_f32 v19, v19, s40, -v6
  v_fma_f32 v20, v20, s40, -v6
  v_fma_f32 v21, v21, s40, -v6
  v_fma_f32 v22, v22, s40, -v6
  v_fma_f32 v23, v23, s40, -v6
  v_exp_f32 v16, v16
  v_exp_f32 v17, v17
  v_exp_f32 v18, v18
  v_exp_f32 v19, v19
  v_exp_f32 v20, v20
  v_exp_f32 v21, v21
  v_exp_f32 v22, v22
  v_exp_f32 v23, v23
  s_nop 0
  v_add_f32 v7, v7, v16
  v_add_f32 v7, v7, v17
  v_add_f32 v7, v7, v18
  v_add_f32 v7, v7, v19
  v_add_f32 v7, v7, v20
  v_add_f32 v7, v7, v21
  v_add_f32 v7, v7, v22
  v_add_f32 v7, v7, v23
  v_cvt_pk_bf16_f32 v32, v16, v17
  v_cvt_pk_bf16_f32 v33, v18, v19
  v_cvt_pk_bf16_f32 v34, v20, v21
  v_cvt_pk_bf16_f32 v35, v22, v23
  v_accvgpr_write_b32 a128, v32
  v_accvgpr_write_b32 a129, v33
  v_accvgpr_write_b32 a130, v34
  v_accvgpr_write_b32 a131, v35
  s_add_u32 m0, s43, 28672
  v_xor_b32 v4, 128, v1
  s_waitcnt vmcnt(4)
  buffer_load_dwordx4 v4, s[8:11], s47 offen offset:0 nt lds
  v_fma_f32 v24, v24, s40, -v6
  v_fma_f32 v25, v25, s40, -v6
  v_fma_f32 v26, v26, s40, -v6
  v_fma_f32 v27, v27, s40, -v6
  v_fma_f32 v28, v28, s40, -v6
  v_fma_f32 v29, v29, s40, -v6
  v_fma_f32 v30, v30, s40, -v6
  v_fma_f32 v31, v31, s40, -v6
  v_exp_f32 v24, v24
  v_exp_f32 v25, v25
  v_exp_f32 v26, v26
  v_exp_f32 v27, v27
  v_exp_f32 v28, v28
  v_exp_f32 v29, v29
  v_exp_f32 v30, v30
  v_exp_f32 v31, v31
  s_nop 0
  v_add_f32 v7, v7, v24
  v_add_f32 v7, v7, v25
  v_add_f32 v7, v7, v26
  v_add_f32 v7, v7, v27
  v_add_f32 v7, v7, v28
  v_add_f32 v7, v7, v29
  v_add_f32 v7, v7, v30
  v_add_f32 v7, v7, v31
  v_cvt_pk_bf16_f32 v36, v24, v25
  v_cvt_pk_bf16_f32 v37, v26, v27
  v_cvt_pk_bf16_f32 v38, v28, v29
  v_cvt_pk_bf16_f32 v39, v30, v31
  v_accvgpr_write_b32 a132, v36
  v_accvgpr_write_b32 a133, v37
  v_accvgpr_write_b32 a134, v38
  v_accvgpr_write_b32 a135, v39
  v_xor_b32 v5, 144, v1
  s_waitcnt vmcnt(4)
  buffer_load_dwordx4 v5, s[8:11], s47 offen offset:1024 nt lds
  v_xor_b32 v4, 160, v1
  s_waitcnt vmcnt(4)
  buffer_load_dwordx4 v4, s[8:11], s47 offen offset:2048 nt lds
  v_xor_b32 v5, 176, v1
  s_waitcnt vmcnt(4)
  buffer_load_dwordx4 v5, s[8:11], s47 offen offset:3072 nt lds
  s_add_u32 s44, s55, 131072
  s_add_u32 s45, s55, 147456
  s_add_u32 s46, s55, 163840
  s_add_u32 s47, s55, 180224
  v_mov_b32 v16, 0
  v_mov_b32 v17, 0
  v_mov_b32 v18, 0
  v_mov_b32 v19, 0
  v_mov_b32 v20, 0
  v_mov_b32 v21, 0
  v_mov_b32 v22, 0
  v_mov_b32 v23, 0
  v_mov_b32 v24, 0
  v_mov_b32 v25, 0
  v_mov_b32 v26, 0
  v_mov_b32 v27, 0
  v_mov_b32 v28, 0
  v_mov_b32 v29, 0
  v_mov_b32 v30, 0
  v_mov_b32 v31, 0
  s_add_u32 m0, s43, 0
  s_nop 0
  s_waitcnt vmcnt(4)
  buffer_load_dwordx4 v1, s[8:11], s44 offen offset:0 nt lds
  v_xor_b32 v5, 16, v1
  s_waitcnt vmcnt(4)
  buffer_load_dwordx4 v5, s[8:11], s44 offen offset:1024 nt lds
  v_xor_b32 v4, 32, v1
  s_waitcnt vmcnt(5)
  s_cbranch_vccnz L_w3
  s_waitcnt vmcnt(4)
L_w3:
  buffer_load_dwordx4 v4, s[8:11], s44 offen offset:2048 nt lds
  v_xor_b32 v5, 48, v1
  s_waitcnt vmcnt(4)
  buffer_load_dwordx4 v5, s[8:11], s44 offen offset:3072 nt lds
  s_add_u32 m0, s43, 4096
  v_xor_b32 v4, 128, v1
  s_waitcnt vmcnt(4)
  buffer_load_dwordx4 v4, s[8:11], s45 offen offset:0 nt lds
  ds_read_b128 a[64:67], v3 offset:16384
  ds_read_b128 a[68:71], v3 offset:16640
  v_xor_b32 v5, 32, v3
  ds_read_b128 a[72:75], v5 offset:16384
  ds_read_b128 a[76:79], v5 offset:16640
  v_xor_b32 v4, 64, v3
  ds_read_b128 a[80:83], v4 offset:16384
  ds_read_b128 a[84:87], v4 offset:16640
  v_xor_b32 v5, 96, v3
  ds_read_b128 a[88:91], v5 offset:16384
  ds_read_b128 a[92:95], v5 offset:16640
  v_xor_b32 v4, 128, v3
  ds_read_b128 a[96:99], v4 offset:16384
  ds_read_b128 a[100:103], v4 offset:16640
  v_xor_b32 v5, 160, v3
  ds_read_b128 a[104:107], v5 offset:16384
  ds_read_b128 a[108:111], v5 offset:16640
  v_xor_b32 v4, 192, v3
  ds_read_b128 a[112:115], v4 offset:16384
  ds_read_b128 a[116:119], v4 offset:16640
  v_xor_b32 v5, 224, v3
  ds_read_b128 a[120:123], v5 offset:16384
  ds_read_b128 a[124:127], v5 offset:16640
  s_waitcnt lgkmcnt(15)
  v_mfma_f32_32x32x16_bf16 v[16:31], a[64:67], a[0:3], v[16:31]
  s_waitcnt lgkmcnt(14)
  v_mfma_f32_32x32x16_bf16 v[16:31], a[68:71], a[32:35], v[16:31]
  v_xor_b32 v5, 144, v1
  s_waitcnt vmcnt(4)
  buffer_load_dwordx4 v5, s[8:11], s45 offen offset:1024 nt lds
  s_waitcnt lgkmcnt(13)
  v_mfma_f32_32x32x16_bf16 v[16:31], a[72:75], a[4:7], v[16:31]
  s_waitcnt lgkmcnt(12)
  v_mfma_f32_32x32x16_bf16 v[16:31], a[76:79], a[36:39], v[16:31]
  s_waitcnt lgkmcnt(11)
  v_mfma_f32_32x32x16_bf16 v[16:31], a[80:83], a[8:11], v[16:31]
  v_xor_b32 v4, 160, v1
  s_waitcnt vmcnt(4)
  buffer_load_dwordx4 v4, s[8:11], s45 offen offset:2048 nt lds
  s_waitcnt lgkmcnt(10)
  v_mfma_f32_32x32x16_bf16 v[16:31], a[84:87], a[40:43], v[16:31]
  s_waitcnt lgkmcnt(9)
  v_mfma_f32_32x32x16_bf16 v[16:31], a[88:91], a[12:15], v[16:31]
  s_waitcnt lgkmcnt(8)
  v_mfma_f32_32x32x16_bf16 v[16:31], a[92:95], a[44:47], v[16:31]
  v_xor_b32 v5, 176, v1
  s_waitcnt vmcnt(4)
  buffer_load_dwordx4 v5, s[8:11], s45 offen offset:3072 nt lds
  s_waitcnt lgkmcnt(7)
  v_mfma_f32_32x32x16_bf16 v[16:31], a[96:99], a[16:19], v[16:31]
  s_waitcnt lgkmcnt(6)
  v_mfma_f32_32x32x16_bf16 v[16:31], a[100:103], a[48:51], v[16:31]
  s_waitcnt lgkmcnt(5)
  v_mfma_f32_32x32x16_bf16 v[16:31], a[104:107], a[20:23], v[16:31]
  s_add_u32 m0, s43, 8192
  s_nop 0
  s_waitcnt vmcnt(4)
  buffer_load_dwordx4 v1, s[8:11], s46 offen offset:0 nt lds
  s_waitcnt lgkmcnt(4)
  v_mfma_f32_32x32x16_bf16 v[16:31], a[108:111], a[52:55], v[16:31]
  s_waitcnt lgkmcnt(3)
  v_mfma_f32_32x32x16_bf16 v[16:31], a[112:115], a[24:27], v[16:31]
  s_waitcnt lgkmcnt(2)
  v_mfma_f32_32x32x16_bf16 v[16:31], a[116:119], a[56:59], v[16:31]
  v_xor_b32 v5, 16, v1
  s_waitcnt vmcnt(4)
  buffer_load_dwordx4 v5, s[8:11], s46 offen offset:1024 nt lds
  s_waitcnt lgkmcnt(1)
  v_mfma_f32_32x32x16_bf16 v[16:31], a[120:123], a[28:31], v[16:31]
  s_waitcnt lgkmcnt(0)
  v_mfma_f32_32x32x16_bf16 v[16:31], a[124:127], a[60:63], v[16:31]
  v_xor_b32 v4, 32, v1
  s_waitcnt vmcnt(5)
  s_cbranch_vccnz L_w4
  s_waitcnt vmcnt(4)
L_w4:
  buffer_load_dwordx4 v4, s[8:11], s46 offen offset:2048 nt lds
  s_nop 7
  s_nop 3
  v_max3_f32 v8, v16, v17, v18
  v_max3_f32 v8, v8, v19, v20
  v_max3_f32 v8, v8, v21, v22
  v_max3_f32 v8, v8, v23, v24
  v_max3_f32 v8, v8, v25, v26
  v_max3_f32 v8, v8, v27, v28
  v_max3_f32 v8, v8, v29, v30
  v_max_f32 v8, v8, v31
  v_mul_f32 v8, s40, v8
  v_mov_b32 v9, v8
  s_nop 1
  v_permlane32_swap_b32 v8, v9
  s_nop 1
  v_max3_f32 v8, v8, v9, v6
  v_sub_f32 v10, v6, v8
  v_exp_f32 v10, v10
  v_mov_b32 v6, v8
  v_mov_b32 v11, v10
  v_mul_f32 v7, v7, v10
  v_mov_b32 v41, v10
  v_xor_b32 v5, 48, v1
  s_waitcnt vmcnt(4)
  buffer_load_dwordx4 v5, s[8:11], s46 offen offset:3072 nt lds
  v_fma_f32 v16, v16, s40, -v6
  v_fma_f32 v17, v17, s40, -v6
  v_fma_f32 v18, v18, s40, -v6
  v_fma_f32 v19, v19, s40, -v6
  v_fma_f32 v20, v20, s40, -v6
  v_fma_f32 v21, v21, s40, -v6
  v_fma_f32 v22, v22, s40, -v6
  v_fma_f32 v23, v23, s40, -v6
  v_exp_f32 v16, v16
  v_exp_f32 v17, v17
  v_exp_f32 v18, v18
  v_exp_f32 v19, v19
  v_exp_f32 v20, v20
  v_exp_f32 v21, v21
  v_exp_f32 v22, v22
  v_exp_f32 v23, v23
  s_nop 0
  v_add_f32 v7, v7, v16
  v_add_f32 v7, v7, v17
  v_add_f32 v7, v7, v18
  v_add_f32 v7, v7, v19
  v_add_f32 v7, v7, v20
  v_add_f32 v7, v7, v21
  v_add_f32 v7, v7, v22
  v_add_f32 v7, v7, v23
  v_cvt_pk_bf16_f32 v32, v16, v17
  v_cvt_pk_bf16_f32 v33, v18, v19
  v_cvt_pk_bf16_f32 v34, v20, v21
  v_cvt_pk_bf16_f32 v35, v22, v23
  v_accvgpr_write_b32 a136, v32
  v_accvgpr_write_b32 a137, v33
  v_accvgpr_write_b32 a138, v34
  v_accvgpr_write_b32 a139, v35
  s_add_u32 m0, s43, 12288
  v_xor_b32 v4, 128, v1
  s_waitcnt vmcnt(4)
  buffer_load_dwordx4 v4, s[8:11], s47 offen offset:0 nt lds
  v_fma_f32 v24, v24, s40, -v6
  v_fma_f32 v25, v25, s40, -v6
  v_fma_f32 v26, v26, s40, -v6
  v_fma_f32 v27, v27, s40, -v6
  v_fma_f32 v28, v28, s40, -v6
  v_fma_f32 v29, v29, s40, -v6
  v_fma_f32 v30, v30, s40, -v6
  v_fma_f32 v31, v31, s40, -v6
  v_exp_f32 v24, v24
  v_exp_f32 v25, v25
  v_exp_f32 v26, v26
  v_exp_f32 v27, v27
  v_exp_f32 v28, v28
  v_exp_f32 v29, v29
  v_exp_f32 v30, v30
  v_exp_f32 v31, v31
  s_nop 0
  v_add_f32 v7, v7, v24
  v_add_f32 v7, v7, v25
  v_add_f32 v7, v7, v26
  v_add_f32 v7, v7, v27
  v_add_f32 v7, v7, v28
  v_add_f32 v7, v7, v29
  v_add_f32 v7, v7, v30
  v_add_f32 v7, v7, v31
  v_cvt_pk_bf16_f32 v36, v24, v25
  v_cvt_pk_bf16_f32 v37, v26, v27
  v_cvt_pk_bf16_f32 v38, v28, v29
  v_cvt_pk_bf16_f32 v39, v30, v31
  v_accvgpr_write_b32 a140, v36
  v_accvgpr_write_b32 a141, v37
  v_accvgpr_write_b32 a142, v38
  v_accvgpr_write_b32 a143, v39
  v_xor_b32 v5, 144, v1
  s_waitcnt vmcnt(4)
  buffer_load_dwordx4 v5, s[8:11], s47 offen offset:1024 nt lds
  v_xor_b32 v4, 160, v1
  s_waitcnt vmcnt(4)
  buffer_load_dwordx4 v4, s[8:11], s47 offen offset:2048 nt lds
  v_xor_b32 v5, 176, v1
  s_waitcnt vmcnt(4)
  buffer_load_dwordx4 v5, s[8:11], s47 offen offset:3072 nt lds
  s_cmp_eq_u32 s81, 1
  s_cbranch_scc0 L_i1
  v_readfirstlane_b32 s56, v15
  s_mov_b32 s81, 0
  s_nop 3
  s_and_b32 s56, s56, 0xff
  s_cmp_eq_u32 s56, 0
  s_cbranch_scc0 L_i1
  v_mov_b32 v15, 0
  v_lshlrev_b32 v56, 2, v0
  s_mov_b64 exec, 0xff
  buffer_atomic_swap v15, v56, s[76:79], 0 offen sc0
  s_mov_b64 exec, -1
  s_mov_b32 s81, 2
L_i1:
  s_add_u32 s44, s55, 196608
  s_add_u32 s45, s55, 212992
  s_add_u32 s46, s55, 229376
  s_add_u32 s47, s55, 245760
  v_mov_b32 v16, 0
  v_mov_b32 v17, 0
  v_mov_b32 v18, 0
  v_mov_b32 v19, 0
  v_mov_b32 v20, 0
  v_mov_b32 v21, 0
  v_mov_b32 v22, 0
  v_mov_b32 v23, 0
  v_mov_b32 v24, 0
  v_mov_b32 v25, 0
  v_mov_b32 v26, 0
  v_mov_b32 v27, 0
  v_mov_b32 v28, 0
  v_mov_b32 v29, 0
  v_mov_b32 v30, 0
  v_mov_b32 v31, 0
  s_add_u32 m0, s43, 16384
  s_nop 0
  s_waitcnt vmcnt(4)
  buffer_load_dwordx4 v1, s[8:11], s44 offen offset:0 nt lds
  v_xor_b32 v5, 16, v1
  s_waitcnt vmcnt(4)
  buffer_load_dwordx4 v5, s[8:11], s44 offen offset:1024 nt lds
  v_xor_b32 v4, 32, v1
  s_waitcnt vmcnt(5)
  s_cbranch_vccnz L_w5
  s_waitcnt vmcnt(4)
L_w5:
  buffer_load_dwordx4 v4, s[8:11], s44 offen offset:2048 nt lds
  v_xor_b32 v5, 48, v1
  s_waitcnt vmcnt(4)
  buffer_load_dwordx4 v5, s[8:11], s44 offen offset:3072 nt lds
  s_add_u32 m0, s43, 20480
  v_xor_b32 v4, 128, v1
  s_waitcnt vmcnt(4)
  buffer_load_dwordx4 v4, s[8:11], s45 offen offset:0 nt lds
  ds_read_b128 a[64:67], v3 offset:0
  ds_read_b128 a[68:71], v3 offset:256
  v_xor_b32 v5, 32, v3
  ds_read_b128 a[72:75], v5 offset:0
  ds_read_b128 a[76:79], v5 offset:256
  v_xor_b32 v4, 64, v3
  ds_read_b128 a[80:83], v4 offset:0
  ds_read_b128 a[84:87], v4 offset:256
  v_xor_b32 v5, 96, v3
  ds_read_b128 a[88:91], v5 offset:0
  ds_read_b128 a[92:95], v5 offset:256
  v_xor_b32 v4, 128, v3
  ds_read_b128 a[96:99], v4 offset:0
  ds_read_b128 a[100:103], v4 offset:256
  v_xor_b32 v5, 160, v3
  ds_read_b128 a[104:107], v5 offset:0
  ds_read_b128 a[108:111], v5 offset:256
  v_xor_b32 v4, 192, v3
  ds_read_b128 a[112:115], v4 offset:0
  ds_read_b128 a[116:119], v4 offset:256
  v_xor_b32 v5, 224, v3
  ds_read_b128 a[120:123], v5 offset:0
  ds_read_b128 a[124:127], v5 offset:256
  s_waitcnt lgkmcnt(15)
  v_mfma_f32_32x32x16_bf16 v[16:31], a[64:67], a[0:3], v[16:31]
  s_waitcnt lgkmcnt(14)
  v_mfma_f32_32x32x16_bf16 v[16:31], a[68:71], a[32:35], v[16:31]
  v_xor_b32 v5, 144, v1
  s_waitcnt vmcnt(4)
  buffer_load_dwordx4 v5, s[8:11], s45 offen offset:1024 nt lds
  s_waitcnt lgkmcnt(13)
  v_mfma_f32_32x32x16_bf16 v[16:31], a[72:75], a[4:7], v[16:31]
  s_waitcnt lgkmcnt(12)
  v_mfma_f32_32x32x16_bf16 v[16:31], a[76:79], a[36:39], v[16:31]
  s_waitcnt lgkmcnt(11)
  v_mfma_f32_32x32x16_bf16 v[16:31], a[80:83], a[8:11], v[16:31]
  v_xor_b32 v4, 160, v1
  s_waitcnt vmcnt(4)
  buffer_load_dwordx4 v4, s[8:11], s45 offen offset:2048 nt lds
  s_waitcnt lgkmcnt(10)
  v_mfma_f32_32x32x16_bf16 v[16:31], a[84:87], a[40:43], v[16:31]
  s_waitcnt lgkmcnt(9)
  v_mfma_f32_32x32x16_bf16 v[16:31], a[88:91], a[12:15], v[16:31]
  s_waitcnt lgkmcnt(8)
  v_mfma_f32_32x32x16_bf16 v[16:31], a[92:95], a[44:47], v[16:31]
  v_xor_b32 v5, 176, v1
  s_waitcnt vmcnt(4)
  buffer_load_dwordx4 v5, s[8:11], s45 offen offset:3072 nt lds
  s_waitcnt lgkmcnt(7)
  v_mfma_f32_32x32x16_bf16 v[16:31], a[96:99], a[16:19], v[16:31]
  s_waitcnt lgkmcnt(6)
  v_mfma_f32_32x32x16_bf16 v[16:31], a[100:103], a[48:51], v[16:31]
  s_waitcnt lgkmcnt(5)
  v_mfma_f32_32x32x16_bf16 v[16:31], a[104:107], a[20:23], v[16:31]
  s_add_u32 m0, s43, 24576
  s_nop 0
  s_waitcnt vmcnt(4)
  buffer_load_dwordx4 v1, s[8:11], s46 offen offset:0 nt lds
  s_waitcnt lgkmcnt(4)
  v_mfma_f32_32x32x16_bf16 v[16:31], a[108:111], a[52:55], v[16:31]
  s_waitcnt lgkmcnt(3)
  v_mfma_f32_32x32x16_bf16 v[16:31], a[112:115], a[24:27], v[16:31]
  s_waitcnt lgkmcnt(2)
  v_mfma_f32_32x32x16_bf16 v[16:31], a[116:119], a[56:59], v[16:31]
  v_xor_b32 v5, 16, v1
  s_waitcnt vmcnt(4)
  buffer_load_dwordx4 v5, s[8:11], s46 offen offset:1024 nt lds
  s_waitcnt lgkmcnt(1)
  v_mfma_f32_32x32x16_bf16 v[16:31], a[120:123], a[28:31], v[16:31]
  s_waitcnt lgkmcnt(0)
  v_mfma_f32_32x32x16_bf16 v[16:31], a[124:127], a[60:63], v[16:31]
  v_xor_b32 v4, 32, v1
  s_waitcnt vmcnt(5)
  s_cbranch_vccnz L_w6
  s_waitcnt vmcnt(4)
L_w6:
  buffer_load_dwordx4 v4, s[8:11], s46 offen offset:2048 nt lds
  s_nop 7
  s_nop 3
  v_max3_f32 v8, v16, v17, v18
  v_max3_f32 v8, v8, v19, v20
  v_max3_f32 v8, v8, v21, v22
  v_max3_f32 v8, v8, v23, v24
  v_max3_f32 v8, v8, v25, v26
  v_max3_f32 v8, v8, v27, v28
  v_max3_f32 v8, v8, v29, v30
  v_max_f32 v8, v8, v31
  v_mul_f32 v8, s40, v8
  v_mov_b32 v9, v8
  s_nop 1
  v_permlane32_swap_b32 v8, v9
  s_nop 1
  v_max3_f32 v8, v8, v9, v6
  v_sub_f32 v10, v6, v8
  v_exp_f32 v10, v10
  v_mov_b32 v6, v8
  v_mov_b32 v11, v10
  v_mul_f32 v7, v7, v10
  v_mov_b32 v42, v10
  v_xor_b32 v5, 48, v1
  s_waitcnt vmcnt(4)
  buffer_load_dwordx4 v5, s[8:11], s46 offen offset:3072 nt lds
  v_fma_f32 v16, v16, s40, -v6
  v_fma_f32 v17, v17, s40, -v6
  v_fma_f32 v18, v18, s40, -v6
  v_fma_f32 v19, v19, s40, -v6
  v_fma_f32 v20, v20, s40, -v6
  v_fma_f32 v21, v21, s40, -v6
  v_fma_f32 v22, v22, s40, -v6
  v_fma_f32 v23, v23, s40, -v6
  v_exp_f32 v16, v16
  v_exp_f32 v17, v17
  v_exp_f32 v18, v18
  v_exp_f32 v19, v19
  v_exp_f32 v20, v20
  v_exp_f32 v21, v21
  v_exp_f32 v22, v22
  v_exp_f32 v23, v23
  s_nop 0
  v_add_f32 v7, v7, v16
  v_add_f32 v7, v7, v17
  v_add_f32 v7, v7, v18
  v_add_f32 v7, v7, v19
  v_add_f32 v7, v7, v20
  v_add_f32 v7, v7, v21
  v_add_f32 v7, v7, v22
  v_add_f32 v7, v7, v23
  v_cvt_pk_bf16_f32 v32, v16, v17
  v_cvt_pk_bf16_f32 v33, v18, v19
  v_cvt_pk_bf16_f32 v34, v20, v21
  v_cvt_pk_bf16_f32 v35, v22, v23
  v_accvgpr_write_b32 a144, v32
  v_accvgpr_write_b32 a145, v33
  v_accvgpr_write_b32 a146, v34
  v_accvgpr_write_b32 a147, v35
  s_add_u32 m0, s43, 28672
  v_xor_b32 v4, 128, v1
  s_waitcnt vmcnt(4)
  buffer_load_dwordx4 v4, s[8:11], s47 offen offset:0 nt lds
  v_fma_f32 v24, v24, s40, -v6
  v_fma_f32 v25, v25, s40, -v6
  v_fma_f32 v26, v26, s40, -v6
  v_fma_f32 v27, v27, s40, -v6
  v_fma_f32 v28, v28, s40, -v6
  v_fma_f32 v29, v29, s40, -v6
  v_fma_f32 v30, v30, s40, -v6
  v_fma_f32 v31, v31, s40, -v6
  v_exp_f32 v24, v24
  v_exp_f32 v25, v25
  v_exp_f32 v26, v26
  v_exp_f32 v27, v27
  v_exp_f32 v28, v28
  v_exp_f32 v29, v29
  v_exp_f32 v30, v30
  v_exp_f32 v31, v31
  s_nop 0
  v_add_f32 v7, v7, v24
  v_add_f32 v7, v7, v25
  v_add_f32 v7, v7, v26
  v_add_f32 v7, v7, v27
  v_add_f32 v7, v7, v28
  v_add_f32 v7, v7, v29
  v_add_f32 v7, v7, v30
  v_add_f32 v7, v7, v31
  v_cvt_pk_bf16_f32 v36, v24, v25
  v_cvt_pk_bf16_f32 v37, v26, v27
  v_cvt_pk_bf16_f32 v38, v28, v29
  v_cvt_pk_bf16_f32 v39, v30, v31
  v_accvgpr_write_b32 a148, v36
  v_accvgpr_write_b32 a149, v37
  v_accvgpr_write_b32 a150, v38
  v_accvgpr_write_b32 a151, v39
  v_xor_b32 v5, 144, v1
  s_waitcnt vmcnt(4)
  buffer_load_dwordx4 v5, s[8:11], s47 offen offset:1024 nt lds
  v_xor_b32 v4, 160, v1
  s_waitcnt vmcnt(4)
  buffer_load_dwordx4 v4, s[8:11], s47 offen offset:2048 nt lds
  v_xor_b32 v5, 176, v1
  s_waitcnt vmcnt(4)
  buffer_load_dwordx4 v5, s[8:11], s47 offen offset:3072 nt lds
  s_add_u32 s44, s55, 262144
  s_add_u32 s45, s55, 278528
  s_add_u32 s46, s55, 294912
  s_add_u32 s47, s55, 311296
  v_mov_b32 v16, 0
  v_mov_b32 v17, 0
  v_mov_b32 v18, 0
  v_mov_b32 v19, 0
  v_mov_b32 v20, 0
  v_mov_b32 v21, 0
  v_mov_b32 v22, 0
  v_mov_b32 v23, 0
  v_mov_b32 v24, 0
  v_mov_b32 v25, 0
  v_mov_b32 v26, 0
  v_mov_b32 v27, 0
  v_mov_b32 v28, 0
  v_mov_b32 v29, 0
  v_mov_b32 v30, 0
  v_mov_b32 v31, 0
  s_add_u32 m0, s43, 0
  s_nop 0
  s_waitcnt vmcnt(4)
  buffer_load_dwordx4 v1, s[8:11], s44 offen offset:0 nt lds
  v_xor_b32 v5, 16, v1
  s_waitcnt vmcnt(4)
  buffer_load_dwordx4 v5, s[8:11], s44 offen offset:1024 nt lds
  v_xor_b32 v4, 32, v1
  s_waitcnt vmcnt(5)
  s_cbranch_vccnz L_w7
  s_waitcnt vmcnt(4)
L_w7:
  buffer_load_dwordx4 v4, s[8:11], s44 offen offset:2048 nt lds
  v_xor_b32 v5, 48, v1
  s_waitcnt vmcnt(4)
  buffer_load_dwordx4 v5, s[8:11], s44 offen offset:3072 nt lds
  s_add_u32 m0, s43, 4096
  v_xor_b32 v4, 128, v1
  s_waitcnt vmcnt(4)
  buffer_load_dwordx4 v4, s[8:11], s45 offen offset:0 nt lds
  ds_read_b128 a[64:67], v3 offset:16384
  ds_read_b128 a[68:71], v3 offset:16640
  v_xor_b32 v5, 32, v3
  ds_read_b128 a[72:75], v5 offset:16384
  ds_read_b128 a[76:79], v5 offset:16640
  v_xor_b32 v4, 64, v3
  ds_read_b128 a[80:83], v4 offset:16384
  ds_read_b128 a[84:87], v4 offset:16640
  v_xor_b32 v5, 96, v3
  ds_read_b128 a[88:91], v5 offset:16384
  ds_read_b128 a[92:95], v5 offset:16640
  v_xor_b32 v4, 128, v3
  ds_read_b128 a[96:99], v4 offset:16384
  ds_read_b128 a[100:103], v4 offset:16640
  v_xor_b32 v5, 160, v3
  ds_read_b128 a[104:107], v5 offset:16384
  ds_read_b128 a[108:111], v5 offset:16640
  v_xor_b32 v4, 192, v3
  ds_read_b128 a[112:115], v4 offset:16384
  ds_read_b128 a[116:119], v4 offset:16640
  v_xor_b32 v5, 224, v3
  ds_read_b128 a[120:123], v5 offset:16384
  ds_read_b128 a[124:127], v5 offset:16640
  s_waitcnt lgkmcnt(15)
  v_mfma_f32_32x32x16_bf16 v[16:31], a[64:67], a[0:3], v[16:31]
  s_waitcnt lgkmcnt(14)
  v_mfma_f32_32x32x16_bf16 v[16:31], a[68:71], a[32:35], v[16:31]
  v_xor_b32 v5, 144, v1
  s_waitcnt vmcnt(4)
  buffer_load_dwordx4 v5, s[8:11], s45 offen offset:1024 nt lds
  s_waitcnt lgkmcnt(13)
  v_mfma_f32_32x32x16_bf16 v[16:31], a[72:75], a[4:7], v[16:31]
  s_waitcnt lgkmcnt(12)
  v_mfma_f32_32x32x16_bf16 v[16:31], a[76:79], a[36:39], v[16:31]
  s_waitcnt lgkmcnt(11)
  v_mfma_f32_32x32x16_bf16 v[16:31], a[80:83], a[8:11], v[16:31]
  v_xor_b32 v4, 160, v1
  s_waitcnt vmcnt(4)
  buffer_load_dwordx4 v4, s[8:11], s45 offen offset:2048 nt lds
  s_waitcnt lgkmcnt(10)
  v_mfma_f32_32x32x16_bf16 v[16:31], a[84:87], a[40:43], v[16:31]
  s_waitcnt lgkmcnt(9)
  v_mfma_f32_32x32x16_bf16 v[16:31], a[88:91], a[12:15], v[16:31]
  s_waitcnt lgkmcnt(8)
  v_mfma_f32_32x32x16_bf16 v[16:31], a[92:95], a[44:47], v[16:31]
  v_xor_b32 v5, 176, v1
  s_waitcnt vmcnt(4)
  buffer_load_dwordx4 v5, s[8:11], s45 offen offset:3072 nt lds
  s_waitcnt lgkmcnt(7)
  v_mfma_f32_32x32x16_bf16 v[16:31], a[96:99], a[16:19], v[16:31]
  s_waitcnt lgkmcnt(6)
  v_mfma_f32_32x32x16_bf16 v[16:31], a[100:103], a[48:51], v[16:31]
  s_waitcnt lgkmcnt(5)
  v_mfma_f32_32x32x16_bf16 v[16:31], a[104:107], a[20:23], v[16:31]
  s_add_u32 m0, s43, 8192
  s_nop 0
  s_waitcnt vmcnt(4)
  buffer_load_dwordx4 v1, s[8:11], s46 offen offset:0 nt lds
  s_waitcnt lgkmcnt(4)
  v_mfma_f32_32x32x16_bf16 v[16:31], a[108:111], a[52:55], v[16:31]
  s_waitcnt lgkmcnt(3)
  v_mfma_f32_32x32x16_bf16 v[16:31], a[112:115], a[24:27], v[16:31]
  s_waitcnt lgkmcnt(2)
  v_mfma_f32_32x32x16_bf16 v[16:31], a[116:119], a[56:59], v[16:31]
  v_xor_b32 v5, 16, v1
  s_waitcnt vmcnt(4)
  buffer_load_dwordx4 v5, s[8:11], s46 offen offset:1024 nt lds
  s_waitcnt lgkmcnt(1)
  v_mfma_f32_32x32x16_bf16 v[16:31], a[120:123], a[28:31], v[16:31]
  s_waitcnt lgkmcnt(0)
  v_mfma_f32_32x32x16_bf16 v[16:31], a[124:127], a[60:63], v[16:31]
  v_xor_b32 v4, 32, v1
  s_waitcnt vmcnt(5)
  s_cbranch_vccnz L_w8
  s_waitcnt vmcnt(4)
L_w8:
  buffer_load_dwordx4 v4, s[8:11], s46 offen offset:2048 nt lds
  s_nop 7
  s_nop 3
  v_max3_f32 v8, v16, v17, v18
  v_max3_f32 v8, v8, v19, v20
  v_max3_f32 v8, v8, v21, v22
  v_max3_f32 v8, v8, v23, v24
  v_max3_f32 v8, v8, v25, v26
  v_max3_f32 v8, v8, v27, v28
  v_max3_f32 v8, v8, v29, v30
  v_max_f32 v8, v8, v31
  v_mul_f32 v8, s40, v8
  v_mov_b32 v9, v8
  s_nop 1
  v_permlane32_swap_b32 v8, v9
  s_nop 1
  v_max3_f32 v8, v8, v9, v6
  v_sub_f32 v10, v6, v8
  v_exp_f32 v10, v10
  v_mov_b32 v6, v8
  v_mov_b32 v11, v10
  v_mul_f32 v7, v7, v10
  v_mov_b32 v43, v10
  v_xor_b32 v5, 48, v1
  s_waitcnt vmcnt(4)
  buffer_load_dwordx4 v5, s[8:11], s46 offen offset:3072 nt lds
  v_fma_f32 v16, v16, s40, -v6
  v_fma_f32 v17, v17, s40, -v6
  v_fma_f32 v18, v18, s40, -v6
  v_fma_f32 v19, v19, s40, -v6
  v_fma_f32 v20, v20, s40, -v6
  v_fma_f32 v21, v21, s40, -v6
  v_fma_f32 v22, v22, s40, -v6
  v_fma_f32 v23, v23, s40, -v6
  v_exp_f32 v16, v16
  v_exp_f32 v17, v17
  v_exp_f32 v18, v18
  v_exp_f32 v19, v19
  v_exp_f32 v20, v20
  v_exp_f32 v21, v21
  v_exp_f32 v22, v22
  v_exp_f32 v23, v23
  s_nop 0
  v_add_f32 v7, v7, v16
  v_add_f32 v7, v7, v17
  v_add_f32 v7, v7, v18
  v_add_f32 v7, v7, v19
  v_add_f32 v7, v7, v20
  v_add_f32 v7, v7, v21
  v_add_f32 v7, v7, v22
  v_add_f32 v7, v7, v23
  v_cvt_pk_bf16_f32 v32, v16, v17
  v_cvt_pk_bf16_f32 v33, v18, v19
  v_cvt_pk_bf16_f32 v34, v20, v21
  v_cvt_pk_bf16_f32 v35, v22, v23
  v_accvgpr_write_b32 a152, v32
  v_accvgpr_write_b32 a153, v33
  v_accvgpr_write_b32 a154, v34
  v_accvgpr_write_b32 a155, v35
  s_add_u32 m0, s43, 12288
  v_xor_b32 v4, 128, v1
  s_waitcnt vmcnt(4)
  buffer_load_dwordx4 v4, s[8:11], s47 offen offset:0 nt lds
  v_fma_f32 v24, v24, s40, -v6
  v_fma_f32 v25, v25, s40, -v6
  v_fma_f32 v26, v26, s40, -v6
  v_fma_f32 v27, v27, s40, -v6
  v_fma_f32 v28, v28, s40, -v6
  v_fma_f32 v29, v29, s40, -v6
  v_fma_f32 v30, v30, s40, -v6
  v_fma_f32 v31, v31, s40, -v6
  v_exp_f32 v24, v24
  v_exp_f32 v25, v25
  v_exp_f32 v26, v26
  v_exp_f32 v27, v27
  v_exp_f32 v28, v28
  v_exp_f32 v29, v29
  v_exp_f32 v30, v30
  v_exp_f32 v31, v31
  s_nop 0
  v_add_f32 v7, v7, v24
  v_add_f32 v7, v7, v25
  v_add_f32 v7, v7, v26
  v_add_f32 v7, v7, v27
  v_add_f32 v7, v7, v28
  v_add_f32 v7, v7, v29
  v_add_f32 v7, v7, v30
  v_add_f32 v7, v7, v31
  v_cvt_pk_bf16_f32 v36, v24, v25
  v_cvt_pk_bf16_f32 v37, v26, v27
  v_cvt_pk_bf16_f32 v38, v28, v29
  v_cvt_pk_bf16_f32 v39, v30, v31
  v_accvgpr_write_b32 a156, v36
  v_accvgpr_write_b32 a157, v37
  v_accvgpr_write_b32 a158, v38
  v_accvgpr_write_b32 a159, v39
  v_xor_b32 v5, 144, v1
  s_waitcnt vmcnt(4)
  buffer_load_dwordx4 v5, s[8:11], s47 offen offset:1024 nt lds
  v_xor_b32 v4, 160, v1
  s_waitcnt vmcnt(4)
  buffer_load_dwordx4 v4, s[8:11], s47 offen offset:2048 nt lds
  v_xor_b32 v5, 176, v1
  s_waitcnt vmcnt(4)
  buffer_load_dwordx4 v5, s[8:11], s47 offen offset:3072 nt lds
  s_cmp_eq_u32 s81, 2
  s_cbranch_scc0 L_i2
  v_mov_b32 v56, 0x10000
  s_mov_b64 exec, 1
  buffer_atomic_or v56, v60, s[72:75], 0 offen
  s_mov_b64 exec, -1
L_i2:
  s_add_u32 s44, s55, 327680
  s_add_u32 s45, s55, 344064
  s_add_u32 s46, s55, 360448
  s_add_u32 s47, s55, 376832
  v_mov_b32 v16, 0
  v_mov_b32 v17, 0
  v_mov_b32 v18, 0
  v_mov_b32 v19, 0
  v_mov_b32 v20, 0
  v_mov_b32 v21, 0
  v_mov_b32 v22, 0
  v_mov_b32 v23, 0
  v_mov_b32 v24, 0
  v_mov_b32 v25, 0
  v_mov_b32 v26, 0
  v_mov_b32 v27, 0
  v_mov_b32 v28, 0
  v_mov_b32 v29, 0
  v_mov_b32 v30, 0
  v_mov_b32 v31, 0
  s_add_u32 m0, s43, 16384
  s_nop 0
  s_waitcnt vmcnt(4)
  buffer_load_dwordx4 v1, s[8:11], s44 offen offset:0 nt lds
  v_xor_b32 v5, 16, v1
  s_waitcnt vmcnt(4)
  buffer_load_dwordx4 v5, s[8:11], s44 offen offset:1024 nt lds
  v_xor_b32 v4, 32, v1
  s_waitcnt vmcnt(5)
  s_cbranch_vccnz L_w9
  s_waitcnt vmcnt(4)
L_w9:
  buffer_load_dwordx4 v4, s[8:11], s44 offen offset:2048 nt lds
  v_xor_b32 v5, 48, v1
  s_waitcnt vmcnt(4)
  buffer_load_dwordx4 v5, s[8:11], s44 offen offset:3072 nt lds
  s_add_u32 m0, s43, 20480
  v_xor_b32 v4, 128, v1
  s_waitcnt vmcnt(4)
  buffer_load_dwordx4 v4, s[8:11], s45 offen offset:0 nt lds
  ds_read_b128 a[64:67], v3 offset:0
  ds_read_b128 a[68:71], v3 offset:256
  v_xor_b32 v5, 32, v3
  ds_read_b128 a[72:75], v5 offset:0
  ds_read_b128 a[76:79], v5 offset:256
  v_xor_b32 v4, 64, v3
  ds_read_b128 a[80:83], v4 offset:0
  ds_read_b128 a[84:87], v4 offset:256
  v_xor_b32 v5, 96, v3
  ds_read_b128 a[88:91], v5 offset:0
  ds_read_b128 a[92:95], v5 offset:256
  v_xor_b32 v4, 128, v3
  ds_read_b128 a[96:99], v4 offset:0
  ds_read_b128 a[100:103], v4 offset:256
  v_xor_b32 v5, 160, v3
  ds_read_b128 a[104:107], v5 offset:0
  ds_read_b128 a[108:111], v5 offset:256
  v_xor_b32 v4, 192, v3
  ds_read_b128 a[112:115], v4 offset:0
  ds_read_b128 a[116:119], v4 offset:256
  v_xor_b32 v5, 224, v3
  ds_read_b128 a[120:123], v5 offset:0
  ds_read_b128 a[124:127], v5 offset:256
  s_waitcnt lgkmcnt(15)
  v_mfma_f32_32x32x16_bf16 v[16:31], a[64:67], a[0:3], v[16:31]
  s_waitcnt lgkmcnt(14)
  v_mfma_f32_32x32x16_bf16 v[16:31], a[68:71], a[32:35], v[16:31]
  v_xor_b32 v5, 144, v1
  s_waitcnt vmcnt(4)
  buffer_load_dwordx4 v5, s[8:11], s45 offen offset:1024 nt lds
  s_waitcnt lgkmcnt(13)
  v_mfma_f32_32x32x16_bf16 v[16:31], a[72:75], a[4:7], v[16:31]
  s_waitcnt lgkmcnt(12)
  v_mfma_f32_32x32x16_bf16 v[16:31], a[76:79], a[36:39], v[16:31]
  s_waitcnt lgkmcnt(11)
  v_mfma_f32_32x32x16_bf16 v[16:31], a[80:83], a[8:11], v[16:31]
  v_xor_b32 v4, 160, v1
  s_waitcnt vmcnt(4)
  buffer_load_dwordx4 v4, s[8:11], s45 offen offset:2048 nt lds
  s_waitcnt lgkmcnt(10)
  v_mfma_f32_32x32x16_bf16 v[16:31], a[84:87], a[40:43], v[16:31]
  s_waitcnt lgkmcnt(9)
  v_mfma_f32_32x32x16_bf16 v[16:31], a[88:91], a[12:15], v[16:31]
  s_waitcnt lgkmcnt(8)
  v_mfma_f32_32x32x16_bf16 v[16:31], a[92:95], a[44:47], v[16:31]
  v_xor_b32 v5, 176, v1
  s_waitcnt vmcnt(4)
  buffer_load_dwordx4 v5, s[8:11], s45 offen offset:3072 nt lds
  s_waitcnt lgkmcnt(7)
  v_mfma_f32_32x32x16_bf16 v[16:31], a[96:99], a[16:19], v[16:31]
  s_waitcnt lgkmcnt(6)
  v_mfma_f32_32x32x16_bf16 v[16:31], a[100:103], a[48:51], v[16:31]
  s_waitcnt lgkmcnt(5)
  v_mfma_f32_32x32x16_bf16 v[16:31], a[104:107], a[20:23], v[16:31]
  s_add_u32 m0, s43, 24576
  s_nop 0
  s_waitcnt vmcnt(4)
  buffer_load_dwordx4 v1, s[8:11], s46 offen offset:0 nt lds
  s_waitcnt lgkmcnt(4)
  v_mfma_f32_32x32x16_bf16 v[16:31], a[108:111], a[52:55], v[16:31]
  s_waitcnt lgkmcnt(3)
  v_mfma_f32_32x32x16_bf16 v[16:31], a[112:115], a[24:27], v[16:31]
  s_waitcnt lgkmcnt(2)
  v_mfma_f32_32x32x16_bf16 v[16:31], a[116:119], a[56:59], v[16:31]
  v_xor_b32 v5, 16, v1
  s_waitcnt vmcnt(4)
  buffer_load_dwordx4 v5, s[8:11], s46 offen offset:1024 nt lds
  s_waitcnt lgkmcnt(1)
  v_mfma_f32_32x32x16_bf16 v[16:31], a[120:123], a[28:31], v[16:31]
  s_waitcnt lgkmcnt(0)
  v_mfma_f32_32x32x16_bf16 v[16:31], a[124:127], a[60:63], v[16:31]
  v_xor_b32 v4, 32, v1
  s_waitcnt vmcnt(5)
  s_cbranch_vccnz L_w10
  s_waitcnt vmcnt(4)
L_w10:
  buffer_load_dwordx4 v4, s[8:11], s46 offen offset:2048 nt lds
  s_nop 7
  s_nop 3
  v_max3_f32 v8, v16, v17, v18
  v_max3_f32 v8, v8, v19, v20
  v_max3_f32 v8, v8, v21, v22
  v_max3_f32 v8, v8, v23, v24
  v_max3_f32 v8, v8, v25, v26
  v_max3_f32 v8, v8, v27, v28
  v_max3_f32 v8, v8, v29, v30
  v_max_f32 v8, v8, v31
  v_mul_f32 v8, s40, v8
  v_mov_b32 v9, v8
  s_nop 1
  v_permlane32_swap_b32 v8, v9
  s_nop 1
  v_max3_f32 v8, v8, v9, v6
  v_sub_f32 v10, v6, v8
  v_exp_f32 v10, v10
  v_mov_b32 v6, v8
  v_mov_b32 v11, v10
  v_mul_f32 v7, v7, v10
  v_mov_b32 v44, v10
  v_xor_b32 v5, 48, v1
  s_waitcnt vmcnt(4)
  buffer_load_dwordx4 v5, s[8:11], s46 offen offset:3072 nt lds
  v_fma_f32 v16, v16, s40, -v6
  v_fma_f32 v17, v17, s40, -v6
  v_fma_f32 v18, v18, s40, -v6
  v_fma_f32 v19, v19, s40, -v6
  v_fma_f32 v20, v20, s40, -v6
  v_fma_f32 v21, v21, s40, -v6
  v_fma_f32 v22, v22, s40, -v6
  v_fma_f32 v23, v23, s40, -v6
  v_exp_f32 v16, v16
  v_exp_f32 v17, v17
  v_exp_f32 v18, v18
  v_exp_f32 v19, v19
  v_exp_f32 v20, v20
  v_exp_f32 v21, v21
  v_exp_f32 v22, v22
  v_exp_f32 v23, v23
  s_nop 0
  v_add_f32 v7, v7, v16
  v_add_f32 v7, v7, v17
  v_add_f32 v7, v7, v18
  v_add_f32 v7, v7, v19
  v_add_f32 v7, v7, v20
  v_add_f32 v7, v7, v21
  v_add_f32 v7, v7, v22
  v_add_f32 v7, v7, v23
  v_cvt_pk_bf16_f32 v32, v16, v17
  v_cvt_pk_bf16_f32 v33, v18, v19
  v_cvt_pk_bf16_f32 v34, v20, v21
  v_cvt_pk_bf16_f32 v35, v22, v23
  v_accvgpr_write_b32 a160, v32
  v_accvgpr_write_b32 a161, v33
  v_accvgpr_write_b32 a162, v34
  v_accvgpr_write_b32 a163, v35
  s_add_u32 m0, s43, 28672
  v_xor_b32 v4, 128, v1
  s_waitcnt vmcnt(4)
  buffer_load_dwordx4 v4, s[8:11], s47 offen offset:0 nt lds
  v_fma_f32 v24, v24, s40, -v6
  v_fma_f32 v25, v25, s40, -v6
  v_fma_f32 v26, v26, s40, -v6
  v_fma_f32 v27, v27, s40, -v6
  v_fma_f32 v28, v28, s40, -v6
  v_fma_f32 v29, v29, s40, -v6
  v_fma_f32 v30, v30, s40, -v6
  v_fma_f32 v31, v31, s40, -v6
  v_exp_f32 v24, v24
  v_exp_f32 v25, v25
  v_exp_f32 v26, v26
  v_exp_f32 v27, v27
  v_exp_f32 v28, v28
  v_exp_f32 v29, v29
  v_exp_f32 v30, v30
  v_exp_f32 v31, v31
  s_nop 0
  v_add_f32 v7, v7, v24
  v_add_f32 v7, v7, v25
  v_add_f32 v7, v7, v26
  v_add_f32 v7, v7, v27
  v_add_f32 v7, v7, v28
  v_add_f32 v7, v7, v29
  v_add_f32 v7, v7, v30
  v_add_f32 v7, v7, v31
  v_cvt_pk_bf16_f32 v36, v24, v25
  v_cvt_pk_bf16_f32 v37, v26, v27
  v_cvt_pk_bf16_f32 v38, v28, v29
  v_cvt_pk_bf16_f32 v39, v30, v31
  v_accvgpr_write_b32 a164, v36
  v_accvgpr_write_b32 a165, v37
  v_accvgpr_write_b32 a166, v38
  v_accvgpr_write_b32 a167, v39
  v_xor_b32 v5, 144, v1
  s_waitcnt vmcnt(4)
  buffer_load_dwordx4 v5, s[8:11], s47 offen offset:1024 nt lds
  v_xor_b32 v4, 160, v1
  s_waitcnt vmcnt(4)
  buffer_load_dwordx4 v4, s[8:11], s47 offen offset:2048 nt lds
  v_xor_b32 v5, 176, v1
  s_waitcnt vmcnt(4)
  buffer_load_dwordx4 v5, s[8:11], s47 offen offset:3072 nt lds
  s_add_u32 s44, s55, 393216
  s_add_u32 s45, s55, 409600
  s_add_u32 s46, s55, 425984
  s_add_u32 s47, s55, 442368
  v_mov_b32 v16, 0
  v_mov_b32 v17, 0
  v_mov_b32 v18, 0
  v_mov_b32 v19, 0
  v_mov_b32 v20, 0
  v_mov_b32 v21, 0
  v_mov_b32 v22, 0
  v_mov_b32 v23, 0
  v_mov_b32 v24, 0
  v_mov_b32 v25, 0
  v_mov_b32 v26, 0
  v_mov_b32 v27, 0
  v_mov_b32 v28, 0
  v_mov_b32 v29, 0
  v_mov_b32 v30, 0
  v_mov_b32 v31, 0
  s_add_u32 m0, s43, 0
  s_nop 0
  s_waitcnt vmcnt(4)
  buffer_load_dwordx4 v1, s[8:11], s44 offen offset:0 nt lds
  v_xor_b32 v5, 16, v1
  s_waitcnt vmcnt(4)
  buffer_load_dwordx4 v5, s[8:11], s44 offen offset:1024 nt lds
  v_xor_b32 v4, 32, v1
  s_waitcnt vmcnt(5)
  s_cbranch_vccnz L_w11
  s_waitcnt vmcnt(4)
L_w11:
  buffer_load_dwordx4 v4, s[8:11], s44 offen offset:2048 nt lds
  v_xor_b32 v5, 48, v1
  s_waitcnt vmcnt(4)
  buffer_load_dwordx4 v5, s[8:11], s44 offen offset:3072 nt lds
  s_add_u32 m0, s43, 4096
  v_xor_b32 v4, 128, v1
  s_waitcnt vmcnt(4)
  buffer_load_dwordx4 v4, s[8:11], s45 offen offset:0 nt lds
  ds_read_b128 a[64:67], v3 offset:16384
  ds_read_b128 a[68:71], v3 offset:16640
  v_xor_b32 v5, 32, v3
  ds_read_b128 a[72:75], v5 offset:16384
  ds_read_b128 a[76:79], v5 offset:16640
  v_xor_b32 v4, 64, v3
  ds_read_b128 a[80:83], v4 offset:16384
  ds_read_b128 a[84:87], v4 offset:16640
  v_xor_b32 v5, 96, v3
  ds_read_b128 a[88:91], v5 offset:16384
  ds_read_b128 a[92:95], v5 offset:16640
  v_xor_b32 v4, 128, v3
  ds_read_b128 a[96:99], v4 offset:16384
  ds_read_b128 a[100:103], v4 offset:16640
  v_xor_b32 v5, 160, v3
  ds_read_b128 a[104:107], v5 offset:16384
  ds_read_b128 a[108:111], v5 offset:16640
  v_xor_b32 v4, 192, v3
  ds_read_b128 a[112:115], v4 offset:16384
  ds_read_b128 a[116:119], v4 offset:16640
  v_xor_b32 v5, 224, v3
  ds_read_b128 a[120:123], v5 offset:16384
  ds_read_b128 a[124:127], v5 offset:16640
  s_waitcnt lgkmcnt(15)
  v_mfma_f32_32x32x16_bf16 v[16:31], a[64:67], a[0:3], v[16:31]
  s_waitcnt lgkmcnt(14)
  v_mfma_f32_32x32x16_bf16 v[16:31], a[68:71], a[32:35], v[16:31]
  v_xor_b32 v5, 144, v1
  s_waitcnt vmcnt(4)
  buffer_load_dwordx4 v5, s[8:11], s45 offen offset:1024 nt lds
  s_waitcnt lgkmcnt(13)
  v_mfma_f32_32x32x16_bf16 v[16:31], a[72:75], a[4:7], v[16:31]
  s_waitcnt lgkmcnt(12)
  v_mfma_f32_32x32x16_bf16 v[16:31], a[76:79], a[36:39], v[16:31]
  s_waitcnt lgkmcnt(11)
  v_mfma_f32_32x32x16_bf16 v[16:31], a[80:83], a[8:11], v[16:31]
  v_xor_b32 v4, 160, v1
  s_waitcnt vmcnt(4)
  buffer_load_dwordx4 v4, s[8:11], s45 offen offset:2048 nt lds
  s_waitcnt lgkmcnt(10)
  v_mfma_f32_32x32x16_bf16 v[16:31], a[84:87], a[40:43], v[16:31]
  s_waitcnt lgkmcnt(9)
  v_mfma_f32_32x32x16_bf16 v[16:31], a[88:91], a[12:15], v[16:31]
  s_waitcnt lgkmcnt(8)
  v_mfma_f32_32x32x16_bf16 v[16:31], a[92:95], a[44:47], v[16:31]
  v_xor_b32 v5, 176, v1
  s_waitcnt vmcnt(4)
  buffer_load_dwordx4 v5, s[8:11], s45 offen offset:3072 nt lds
  s_waitcnt lgkmcnt(7)
  v_mfma_f32_32x32x16_bf16 v[16:31], a[96:99], a[16:19], v[16:31]
  s_waitcnt lgkmcnt(6)
  v_mfma_f32_32x32x16_bf16 v[16:31], a[100:103], a[48:51], v[16:31]
  s_waitcnt lgkmcnt(5)
  v_mfma_f32_32x32x16_bf16 v[16:31], a[104:107], a[20:23], v[16:31]
  s_add_u32 m0, s43, 8192
  s_nop 0
  s_waitcnt vmcnt(4)
  buffer_load_dwordx4 v1, s[8:11], s46 offen offset:0 nt lds
  s_waitcnt lgkmcnt(4)
  v_mfma_f32_32x32x16_bf16 v[16:31], a[108:111], a[52:55], v[16:31]
  s_waitcnt lgkmcnt(3)
  v_mfma_f32_32x32x16_bf16 v[16:31], a[112:115], a[24:27], v[16:31]
  s_waitcnt lgkmcnt(2)
  v_mfma_f32_32x32x16_bf16 v[16:31], a[116:119], a[56:59], v[16:31]
  v_xor_b32 v5, 16, v1
  s_waitcnt vmcnt(4)
  buffer_load_dwordx4 v5, s[8:11], s46 offen offset:1024 nt lds
  s_waitcnt lgkmcnt(1)
  v_mfma_f32_32x32x16_bf16 v[16:31], a[120:123], a[28:31], v[16:31]
  s_waitcnt lgkmcnt(0)
  v_mfma_f32_32x32x16_bf16 v[16:31], a[124:127], a[60:63], v[16:31]
  v_xor_b32 v4, 32, v1
  s_waitcnt vmcnt(5)
  s_cbranch_vccnz L_w12
  s_waitcnt vmcnt(4)
L_w12:
  buffer_load_dwordx4 v4, s[8:11], s46 offen offset:2048 nt lds
  s_nop 7
  s_nop 3
  v_max3_f32 v8, v16, v17, v18
  v_max3_f32 v8, v8, v19, v20
  v_max3_f32 v8, v8, v21, v22
  v_max3_f32 v8, v8, v23, v24
  v_max3_f32 v8, v8, v25, v26
  v_max3_f32 v8, v8, v27, v28
  v_max3_f32 v8, v8, v29, v30
  v_max_f32 v8, v8, v31
  v_mul_f32 v8, s40, v8
  v_mov_b32 v9, v8
  s_nop 1
  v_permlane32_swap_b32 v8, v9
  s_nop 1
  v_max3_f32 v8, v8, v9, v6
  v_sub_f32 v10, v6, v8
  v_exp_f32 v10, v10
  v_mov_b32 v6, v8
  v_mov_b32 v11, v10
  v_mul_f32 v7, v7, v10
  v_mov_b32 v45, v10
  v_xor_b32 v5, 48, v1
  s_waitcnt vmcnt(4)
  buffer_load_dwordx4 v5, s[8:11], s46 offen offset:3072 nt lds
  v_fma_f32 v16, v16, s40, -v6
  v_fma_f32 v17, v17, s40, -v6
  v_fma_f32 v18, v18, s40, -v6
  v_fma_f32 v19, v19, s40, -v6
  v_fma_f32 v20, v20, s40, -v6
  v_fma_f32 v21, v21, s40, -v6
  v_fma_f32 v22, v22, s40, -v6
  v_fma_f32 v23, v23, s40, -v6
  v_exp_f32 v16, v16
  v_exp_f32 v17, v17
  v_exp_f32 v18, v18
  v_exp_f32 v19, v19
  v_exp_f32 v20, v20
  v_exp_f32 v21, v21
  v_exp_f32 v22, v22
  v_exp_f32 v23, v23
  s_nop 0
  v_add_f32 v7, v7, v16
  v_add_f32 v7, v7, v17
  v_add_f32 v7, v7, v18
  v_add_f32 v7, v7, v19
  v_add_f32 v7, v7, v20
  v_add_f32 v7, v7, v21
  v_add_f32 v7, v7, v22
  v_add_f32 v7, v7, v23
  v_cvt_pk_bf16_f32 v32, v16, v17
  v_cvt_pk_bf16_f32 v33, v18, v19
  v_cvt_pk_bf16_f32 v34, v20, v21
  v_cvt_pk_bf16_f32 v35, v22, v23
  v_accvgpr_write_b32 a168, v32
  v_accvgpr_write_b32 a169, v33
  v_accvgpr_write_b32 a170, v34
  v_accvgpr_write_b32 a171, v35
  s_add_u32 m0, s43, 12288
  v_xor_b32 v4, 128, v1
  s_waitcnt vmcnt(4)
  buffer_load_dwordx4 v4, s[8:11], s47 offen offset:0 nt lds
  v_fma_f32 v24, v24, s40, -v6
  v_fma_f32 v25, v25, s40, -v6
  v_fma_f32 v26, v26, s40, -v6
  v_fma_f32 v27, v27, s40, -v6
  v_fma_f32 v28, v28, s40, -v6
  v_fma_f32 v29, v29, s40, -v6
  v_fma_f32 v30, v30, s40, -v6
  v_fma_f32 v31, v31, s40, -v6
  v_exp_f32 v24, v24
  v_exp_f32 v25, v25
  v_exp_f32 v26, v26
  v_exp_f32 v27, v27
  v_exp_f32 v28, v28
  v_exp_f32 v29, v29
  v_exp_f32 v30, v30
  v_exp_f32 v31, v31
  s_nop 0
  v_add_f32 v7, v7, v24
  v_add_f32 v7, v7, v25
  v_add_f32 v7, v7, v26
  v_add_f32 v7, v7, v27
  v_add_f32 v7, v7, v28
  v_add_f32 v7, v7, v29
  v_add_f32 v7, v7, v30
  v_add_f32 v7, v7, v31
  v_cvt_pk_bf16_f32 v36, v24, v25
  v_cvt_pk_bf16_f32 v37, v26, v27
  v_cvt_pk_bf16_f32 v38, v28, v29
  v_cvt_pk_bf16_f32 v39, v30, v31
  v_accvgpr_write_b32 a172, v36
  v_accvgpr_write_b32 a173, v37
  v_accvgpr_write_b32 a174, v38
  v_accvgpr_write_b32 a175, v39
  v_xor_b32 v5, 144, v1
  s_waitcnt vmcnt(4)
  buffer_load_dwordx4 v5, s[8:11], s47 offen offset:1024 nt lds
  v_xor_b32 v4, 160, v1
  s_waitcnt vmcnt(4)
  buffer_load_dwordx4 v4, s[8:11], s47 offen offset:2048 nt lds
  v_xor_b32 v5, 176, v1
  s_waitcnt vmcnt(4)
  buffer_load_dwordx4 v5, s[8:11], s47 offen offset:3072 nt lds
  s_add_u32 s44, s55, 458752
  s_add_u32 s45, s55, 475136
  s_add_u32 s46, s55, 491520
  s_add_u32 s47, s55, 507904
  v_mov_b32 v16, 0
  v_mov_b32 v17, 0
  v_mov_b32 v18, 0
  v_mov_b32 v19, 0
  v_mov_b32 v20, 0
  v_mov_b32 v21, 0
  v_mov_b32 v22, 0
  v_mov_b32 v23, 0
  v_mov_b32 v24, 0
  v_mov_b32 v25, 0
  v_mov_b32 v26, 0
  v_mov_b32 v27, 0
  v_mov_b32 v28, 0
  v_mov_b32 v29, 0
  v_mov_b32 v30, 0
  v_mov_b32 v31, 0
  s_add_u32 m0, s43, 16384
  s_nop 0
  s_waitcnt vmcnt(4)
  buffer_load_dwordx4 v1, s[8:11], s44 offen offset:0 nt lds
  v_xor_b32 v5, 16, v1
  s_waitcnt vmcnt(4)
  buffer_load_dwordx4 v5, s[8:11], s44 offen offset:1024 nt lds
  v_xor_b32 v4, 32, v1
  s_waitcnt vmcnt(5)
  s_cbranch_vccnz L_w13
  s_waitcnt vmcnt(4)
L_w13:
  buffer_load_dwordx4 v4, s[8:11], s44 offen offset:2048 nt lds
  v_xor_b32 v5, 48, v1
  s_waitcnt vmcnt(4)
  buffer_load_dwordx4 v5, s[8:11], s44 offen offset:3072 nt lds
  s_add_u32 m0, s43, 20480
  v_xor_b32 v4, 128, v1
  s_waitcnt vmcnt(4)
  buffer_load_dwordx4 v4, s[8:11], s45 offen offset:0 nt lds
  ds_read_b128 a[64:67], v3 offset:0
  ds_read_b128 a[68:71], v3 offset:256
  v_xor_b32 v5, 32, v3
  ds_read_b128 a[72:75], v5 offset:0
  ds_read_b128 a[76:79], v5 offset:256
  v_xor_b32 v4, 64, v3
  ds_read_b128 a[80:83], v4 offset:0
  ds_read_b128 a[84:87], v4 offset:256
  v_xor_b32 v5, 96, v3
  ds_read_b128 a[88:91], v5 offset:0
  ds_read_b128 a[92:95], v5 offset:256
  v_xor_b32 v4, 128, v3
  ds_read_b128 a[96:99], v4 offset:0
  ds_read_b128 a[100:103], v4 offset:256
  v_xor_b32 v5, 160, v3
  ds_read_b128 a[104:107], v5 offset:0
  ds_read_b128 a[108:111], v5 offset:256
  v_xor_b32 v4, 192, v3
  ds_read_b128 a[112:115], v4 offset:0
  ds_read_b128 a[116:119], v4 offset:256
  v_xor_b32 v5, 224, v3
  ds_read_b128 a[120:123], v5 offset:0
  ds_read_b128 a[124:127], v5 offset:256
  s_waitcnt lgkmcnt(15)
  v_mfma_f32_32x32x16_bf16 v[16:31], a[64:67], a[0:3], v[16:31]
  s_waitcnt lgkmcnt(14)
  v_mfma_f32_32x32x16_bf16 v[16:31], a[68:71], a[32:35], v[16:31]
  v_xor_b32 v5, 144, v1
  s_waitcnt vmcnt(4)
  buffer_load_dwordx4 v5, s[8:11], s45 offen offset:1024 nt lds
  s_waitcnt lgkmcnt(13)
  v_mfma_f32_32x32x16_bf16 v[16:31], a[72:75], a[4:7], v[16:31]
  s_waitcnt lgkmcnt(12)
  v_mfma_f32_32x32x16_bf16 v[16:31], a[76:79], a[36:39], v[16:31]
  s_waitcnt lgkmcnt(11)
  v_mfma_f32_32x32x16_bf16 v[16:31], a[80:83], a[8:11], v[16:31]
  v_xor_b32 v4, 160, v1
  s_waitcnt vmcnt(4)
  buffer_load_dwordx4 v4, s[8:11], s45 offen offset:2048 nt lds
  s_waitcnt lgkmcnt(10)
  v_mfma_f32_32x32x16_bf16 v[16:31], a[84:87], a[40:43], v[16:31]
  s_waitcnt lgkmcnt(9)
  v_mfma_f32_32x32x16_bf16 v[16:31], a[88:91], a[12:15], v[16:31]
  s_waitcnt lgkmcnt(8)
  v_mfma_f32_32x32x16_bf16 v[16:31], a[92:95], a[44:47], v[16:31]
  v_xor_b32 v5, 176, v1
  s_waitcnt vmcnt(4)
  buffer_load_dwordx4 v5, s[8:11], s45 offen offset:3072 nt lds
  s_waitcnt lgkmcnt(7)
  v_mfma_f32_32x32x16_bf16 v[16:31], a[96:99], a[16:19], v[16:31]
  s_waitcnt lgkmcnt(6)
  v_mfma_f32_32x32x16_bf16 v[16:31], a[100:103], a[48:51], v[16:31]
  s_waitcnt lgkmcnt(5)
  v_mfma_f32_32x32x16_bf16 v[16:31], a[104:107], a[20:23], v[16:31]
  s_add_u32 m0, s43, 24576
  s_nop 0
  s_waitcnt vmcnt(4)
  buffer_load_dwordx4 v1, s[8:11], s46 offen offset:0 nt lds
  s_waitcnt lgkmcnt(4)
  v_mfma_f32_32x32x16_bf16 v[16:31], a[108:111], a[52:55], v[16:31]
  s_waitcnt lgkmcnt(3)
  v_mfma_f32_32x32x16_bf16 v[16:31], a[112:115], a[24:27], v[16:31]
  s_waitcnt lgkmcnt(2)
  v_mfma_f32_32x32x16_bf16 v[16:31], a[116:119], a[56:59], v[16:31]
  v_xor_b32 v5, 16, v1
  s_waitcnt vmcnt(4)
  buffer_load_dwordx4 v5, s[8:11], s46 offen offset:1024 nt lds
  s_waitcnt lgkmcnt(1)
  v_mfma_f32_32x32x16_bf16 v[16:31], a[120:123], a[28:31], v[16:31]
  s_waitcnt lgkmcnt(0)
  v_mfma_f32_32x32x16_bf16 v[16:31], a[124:127], a[60:63], v[16:31]
  v_xor_b32 v4, 32, v1
  s_waitcnt vmcnt(5)
  s_cbranch_vccnz L_w14
  s_waitcnt vmcnt(4)
L_w14:
  buffer_load_dwordx4 v4, s[8:11], s46 offen offset:2048 nt lds
  s_nop 7
  s_nop 3
  v_max3_f32 v8, v16, v17, v18
  v_max3_f32 v8, v8, v19, v20
  v_max3_f32 v8, v8, v21, v22
  v_max3_f32 v8, v8, v23, v24
  v_max3_f32 v8, v8, v25, v26
  v_max3_f32 v8, v8, v27, v28
  v_max3_f32 v8, v8, v29, v30
  v_max_f32 v8, v8, v31
  v_mul_f32 v8, s40, v8
  v_mov_b32 v9, v8
  s_nop 1
  v_permlane32_swap_b32 v8, v9
  s_nop 1
  v_max3_f32 v8, v8, v9, v6
  v_sub_f32 v10, v6, v8
  v_exp_f32 v10, v10
  v_mov_b32 v6, v8
  v_mov_b32 v11, v10
  v_mul_f32 v7, v7, v10
  v_mov_b32 v46, v10
  v_xor_b32 v5, 48, v1
  s_waitcnt vmcnt(4)
  buffer_load_dwordx4 v5, s[8:11], s46 offen offset:3072 nt lds
  v_fma_f32 v16, v16, s40, -v6
  v_fma_f32 v17, v17, s40, -v6
  v_fma_f32 v18, v18, s40, -v6
  v_fma_f32 v19, v19, s40, -v6
  v_fma_f32 v20, v20, s40, -v6
  v_fma_f32 v21, v21, s40, -v6
  v_fma_f32 v22, v22, s40, -v6
  v_fma_f32 v23, v23, s40, -v6
  v_exp_f32 v16, v16
  v_exp_f32 v17, v17
  v_exp_f32 v18, v18
  v_exp_f32 v19, v19
  v_exp_f32 v20, v20
  v_exp_f32 v21, v21
  v_exp_f32 v22, v22
  v_exp_f32 v23, v23
  s_nop 0
  v_add_f32 v7, v7, v16
  v_add_f32 v7, v7, v17
  v_add_f32 v7, v7, v18
  v_add_f32 v7, v7, v19
  v_add_f32 v7, v7, v20
  v_add_f32 v7, v7, v21
  v_add_f32 v7, v7, v22
  v_add_f32 v7, v7, v23
  v_cvt_pk_bf16_f32 v32, v16, v17
  v_cvt_pk_bf16_f32 v33, v18, v19
  v_cvt_pk_bf16_f32 v34, v20, v21
  v_cvt_pk_bf16_f32 v35, v22, v23
  v_accvgpr_write_b32 a176, v32
  v_accvgpr_write_b32 a177, v33
  v_accvgpr_write_b32 a178, v34
  v_accvgpr_write_b32 a179, v35
  s_add_u32 m0, s43, 28672
  v_xor_b32 v4, 128, v1
  s_waitcnt vmcnt(4)
  buffer_load_dwordx4 v4, s[8:11], s47 offen offset:0 nt lds
  v_fma_f32 v24, v24, s40, -v6
  v_fma_f32 v25, v25, s40, -v6
  v_fma_f32 v26, v26, s40, -v6
  v_fma_f32 v27, v27, s40, -v6
  v_fma_f32 v28, v28, s40, -v6
  v_fma_f32 v29, v29, s40, -v6
  v_fma_f32 v30, v30, s40, -v6
  v_fma_f32 v31, v31, s40, -v6
  v_exp_f32 v24, v24
  v_exp_f32 v25, v25
  v_exp_f32 v26, v26
  v_exp_f32 v27, v27
  v_exp_f32 v28, v28
  v_exp_f32 v29, v29
  v_exp_f32 v30, v30
  v_exp_f32 v31, v31
  s_nop 0
  v_add_f32 v7, v7, v24
  v_add_f32 v7, v7, v25
  v_add_f32 v7, v7, v26
  v_add_f32 v7, v7, v27
  v_add_f32 v7, v7, v28
  v_add_f32 v7, v7, v29
  v_add_f32 v7, v7, v30
  v_add_f32 v7, v7, v31
  v_cvt_pk_bf16_f32 v36, v24, v25
  v_cvt_pk_bf16_f32 v37, v26, v27
  v_cvt_pk_bf16_f32 v38, v28, v29
  v_cvt_pk_bf16_f32 v39, v30, v31
  v_accvgpr_write_b32 a180, v36
  v_accvgpr_write_b32 a181, v37
  v_accvgpr_write_b32 a182, v38
  v_accvgpr_write_b32 a183, v39
  v_xor_b32 v5, 144, v1
  s_waitcnt vmcnt(4)
  buffer_load_dwordx4 v5, s[8:11], s47 offen offset:1024 nt lds
  v_xor_b32 v4, 160, v1
  s_waitcnt vmcnt(4)
  buffer_load_dwordx4 v4, s[8:11], s47 offen offset:2048 nt lds
  v_xor_b32 v5, 176, v1
  s_waitcnt vmcnt(4)
  buffer_load_dwordx4 v5, s[8:11], s47 offen offset:3072 nt lds
  s_add_u32 s44, s55, 524288
  s_add_u32 s45, s55, 540672
  s_add_u32 s46, s55, 557056
  s_add_u32 s47, s55, 573440
  v_mov_b32 v16, 0
  v_mov_b32 v17, 0
  v_mov_b32 v18, 0
  v_mov_b32 v19, 0
  v_mov_b32 v20, 0
  v_mov_b32 v21, 0
  v_mov_b32 v22, 0
  v_mov_b32 v23, 0
  v_mov_b32 v24, 0
  v_mov_b32 v25, 0
  v_mov_b32 v26, 0
  v_mov_b32 v27, 0
  v_mov_b32 v28, 0
  v_mov_b32 v29, 0
  v_mov_b32 v30, 0
  v_mov_b32 v31, 0
  s_add_u32 m0, s43, 0
  s_nop 0
  s_waitcnt vmcnt(4)
  buffer_load_dwordx4 v1, s[8:11], s44 offen offset:0 nt lds
  v_xor_b32 v5, 16, v1
  s_waitcnt vmcnt(4)
  buffer_load_dwordx4 v5, s[8:11], s44 offen offset:1024 nt lds
  v_xor_b32 v4, 32, v1
  s_waitcnt vmcnt(5)
  s_cbranch_vccnz L_w15
  s_waitcnt vmcnt(4)
L_w15:
  buffer_load_dwordx4 v4, s[8:11], s44 offen offset:2048 nt lds
  v_xor_b32 v5, 48, v1
  s_waitcnt vmcnt(4)
  buffer_load_dwordx4 v5, s[8:11], s44 offen offset:3072 nt lds
  s_add_u32 m0, s43, 4096
  v_xor_b32 v4, 128, v1
  s_waitcnt vmcnt(4)
  buffer_load_dwordx4 v4, s[8:11], s45 offen offset:0 nt lds
  ds_read_b128 a[64:67], v3 offset:16384
  ds_read_b128 a[68:71], v3 offset:16640
  v_xor_b32 v5, 32, v3
  ds_read_b128 a[72:75], v5 offset:16384
  ds_read_b128 a[76:79], v5 offset:16640
  v_xor_b32 v4, 64, v3
  ds_read_b128 a[80:83], v4 offset:16384
  ds_read_b128 a[84:87], v4 offset:16640
  v_xor_b32 v5, 96, v3
  ds_read_b128 a[88:91], v5 offset:16384
  ds_read_b128 a[92:95], v5 offset:16640
  v_xor_b32 v4, 128, v3
  ds_read_b128 a[96:99], v4 offset:16384
  ds_read_b128 a[100:103], v4 offset:16640
  v_xor_b32 v5, 160, v3
  ds_read_b128 a[104:107], v5 offset:16384
  ds_read_b128 a[108:111], v5 offset:16640
  v_xor_b32 v4, 192, v3
  ds_read_b128 a[112:115], v4 offset:16384
  ds_read_b128 a[116:119], v4 offset:16640
  v_xor_b32 v5, 224, v3
  ds_read_b128 a[120:123], v5 offset:16384
  ds_read_b128 a[124:127], v5 offset:16640
  s_waitcnt lgkmcnt(15)
  v_mfma_f32_32x32x16_bf16 v[16:31], a[64:67], a[0:3], v[16:31]
  s_waitcnt lgkmcnt(14)
  v_mfma_f32_32x32x16_bf16 v[16:31], a[68:71], a[32:35], v[16:31]
  v_xor_b32 v5, 144, v1
  s_waitcnt vmcnt(4)
  buffer_load_dwordx4 v5, s[8:11], s45 offen offset:1024 nt lds
  s_waitcnt lgkmcnt(13)
  v_mfma_f32_32x32x16_bf16 v[16:31], a[72:75], a[4:7], v[16:31]
  s_waitcnt lgkmcnt(12)
  v_mfma_f32_32x32x16_bf16 v[16:31], a[76:79], a[36:39], v[16:31]
  s_waitcnt lgkmcnt(11)
  v_mfma_f32_32x32x16_bf16 v[16:31], a[80:83], a[8:11], v[16:31]
  v_xor_b32 v4, 160, v1
  s_waitcnt vmcnt(4)
  buffer_load_dwordx4 v4, s[8:11], s45 offen offset:2048 nt lds
  s_waitcnt lgkmcnt(10)
  v_mfma_f32_32x32x16_bf16 v[16:31], a[84:87], a[40:43], v[16:31]
  s_waitcnt lgkmcnt(9)
  v_mfma_f32_32x32x16_bf16 v[16:31], a[88:91], a[12:15], v[16:31]
  s_waitcnt lgkmcnt(8)
  v_mfma_f32_32x32x16_bf16 v[16:31], a[92:95], a[44:47], v[16:31]
  v_xor_b32 v5, 176, v1
  s_waitcnt vmcnt(4)
  buffer_load_dwordx4 v5, s[8:11], s45 offen offset:3072 nt lds
  s_waitcnt lgkmcnt(7)
  v_mfma_f32_32x32x16_bf16 v[16:31], a[96:99], a[16:19], v[16:31]
  s_waitcnt lgkmcnt(6)
  v_mfma_f32_32x32x16_bf16 v[16:31], a[100:103], a[48:51], v[16:31]
  s_waitcnt lgkmcnt(5)
  v_mfma_f32_32x32x16_bf16 v[16:31], a[104:107], a[20:23], v[16:31]
  s_add_u32 m0, s43, 8192
  s_nop 0
  s_waitcnt vmcnt(4)
  buffer_load_dwordx4 v1, s[8:11], s46 offen offset:0 nt lds
  s_waitcnt lgkmcnt(4)
  v_mfma_f32_32x32x16_bf16 v[16:31], a[108:111], a[52:55], v[16:31]
  s_waitcnt lgkmcnt(3)
  v_mfma_f32_32x32x16_bf16 v[16:31], a[112:115], a[24:27], v[16:31]
  s_waitcnt lgkmcnt(2)
  v_mfma_f32_32x32x16_bf16 v[16:31], a[116:119], a[56:59], v[16:31]
  v_xor_b32 v5, 16, v1
  s_waitcnt vmcnt(4)
  buffer_load_dwordx4 v5, s[8:11], s46 offen offset:1024 nt lds
  s_waitcnt lgkmcnt(1)
  v_mfma_f32_32x32x16_bf16 v[16:31], a[120:123], a[28:31], v[16:31]
  s_waitcnt lgkmcnt(0)
  v_mfma_f32_32x32x16_bf16 v[16:31], a[124:127], a[60:63], v[16:31]
  v_xor_b32 v4, 32, v1
  s_waitcnt vmcnt(5)
  s_cbranch_vccnz L_w16
  s_waitcnt vmcnt(4)
L_w16:
  buffer_load_dwordx4 v4, s[8:11], s46 offen offset:2048 nt lds
  s_nop 7
  s_nop 3
  v_max3_f32 v8, v16, v17, v18
  v_max3_f32 v8, v8, v19, v20
  v_max3_f32 v8, v8, v21, v22
  v_max3_f32 v8, v8, v23, v24
  v_max3_f32 v8, v8, v25, v26
  v_max3_f32 v8, v8, v27, v28
  v_max3_f32 v8, v8, v29, v30
  v_max_f32 v8, v8, v31
  v_mul_f32 v8, s40, v8
  v_mov_b32 v9, v8
  s_nop 1
  v_permlane32_swap_b32 v8, v9
  s_nop 1
  v_max3_f32 v8, v8, v9, v6
  v_sub_f32 v10, v6, v8
  v_exp_f32 v10, v10
  v_mov_b32 v6, v8
  v_mov_b32 v11, v10
  v_mul_f32 v7, v7, v10
  v_mov_b32 v47, v10
  v_xor_b32 v5, 48, v1
  s_waitcnt vmcnt(4)
  buffer_load_dwordx4 v5, s[8:11], s46 offen offset:3072 nt lds
  v_fma_f32 v16, v16, s40, -v6
  v_fma_f32 v17, v17, s40, -v6
  v_fma_f32 v18, v18, s40, -v6
  v_fma_f32 v19, v19, s40, -v6
  v_fma_f32 v20, v20, s40, -v6
  v_fma_f32 v21, v21, s40, -v6
  v_fma_f32 v22, v22, s40, -v6
  v_fma_f32 v23, v23, s40, -v6
  v_exp_f32 v16, v16
  v_exp_f32 v17, v17
  v_exp_f32 v18, v18
  v_exp_f32 v19, v19
  v_exp_f32 v20, v20
  v_exp_f32 v21, v21
  v_exp_f32 v22, v22
  v_exp_f32 v23, v23
  s_nop 0
  v_add_f32 v7, v7, v16
  v_add_f32 v7, v7, v17
  v_add_f32 v7, v7, v18
  v_add_f32 v7, v7, v19
  v_add_f32 v7, v7, v20
  v_add_f32 v7, v7, v21
  v_add_f32 v7, v7, v22
  v_add_f32 v7, v7, v23
  v_cvt_pk_bf16_f32 v32, v16, v17
  v_cvt_pk_bf16_f32 v33, v18, v19
  v_cvt_pk_bf16_f32 v34, v20, v21
  v_cvt_pk_bf16_f32 v35, v22, v23
  v_accvgpr_write_b32 a184, v32
  v_accvgpr_write_b32 a185, v33
  v_accvgpr_write_b32 a186, v34
  v_accvgpr_write_b32 a187, v35
  s_add_u32 m0, s43, 12288
  v_xor_b32 v4, 128, v1
  s_waitcnt vmcnt(4)
  buffer_load_dwordx4 v4, s[8:11], s47 offen offset:0 nt lds
  v_fma_f32 v24, v24, s40, -v6
  v_fma_f32 v25, v25, s40, -v6
  v_fma_f32 v26, v26, s40, -v6
  v_fma_f32 v27, v27, s40, -v6
  v_fma_f32 v28, v28, s40, -v6
  v_fma_f32 v29, v29, s40, -v6
  v_fma_f32 v30, v30, s40, -v6
  v_fma_f32 v31, v31, s40, -v6
  v_exp_f32 v24, v24
  v_exp_f32 v25, v25
  v_exp_f32 v26, v26
  v_exp_f32 v27, v27
  v_exp_f32 v28, v28
  v_exp_f32 v29, v29
  v_exp_f32 v30, v30
  v_exp_f32 v31, v31
  s_nop 0
  v_add_f32 v7, v7, v24
  v_add_f32 v7, v7, v25
  v_add_f32 v7, v7, v26
  v_add_f32 v7, v7, v27
  v_add_f32 v7, v7, v28
  v_add_f32 v7, v7, v29
  v_add_f32 v7, v7, v30
  v_add_f32 v7, v7, v31
  v_cvt_pk_bf16_f32 v36, v24, v25
  v_cvt_pk_bf16_f32 v37, v26, v27
  v_cvt_pk_bf16_f32 v38, v28, v29
  v_cvt_pk_bf16_f32 v39, v30, v31
  v_accvgpr_write_b32 a188, v36
  v_accvgpr_write_b32 a189, v37
  v_accvgpr_write_b32 a190, v38
  v_accvgpr_write_b32 a191, v39
  v_xor_b32 v5, 144, v1
  s_waitcnt vmcnt(4)
  buffer_load_dwordx4 v5, s[8:11], s47 offen offset:1024 nt lds
  v_xor_b32 v4, 160, v1
  s_waitcnt vmcnt(4)
  buffer_load_dwordx4 v4, s[8:11], s47 offen offset:2048 nt lds
  v_xor_b32 v5, 176, v1
  s_waitcnt vmcnt(4)
  buffer_load_dwordx4 v5, s[8:11], s47 offen offset:3072 nt lds
  s_add_u32 s44, s55, 589824
  s_add_u32 s45, s55, 606208
  s_add_u32 s46, s55, 622592
  s_add_u32 s47, s55, 638976
  v_mov_b32 v16, 0
  v_mov_b32 v17, 0
  v_mov_b32 v18, 0
  v_mov_b32 v19, 0
  v_mov_b32 v20, 0
  v_mov_b32 v21, 0
  v_mov_b32 v22, 0
  v_mov_b32 v23, 0
  v_mov_b32 v24, 0
  v_mov_b32 v25, 0
  v_mov_b32 v26, 0
  v_mov_b32 v27, 0
  v_mov_b32 v28, 0
  v_mov_b32 v29, 0
  v_mov_b32 v30, 0
  v_mov_b32 v31, 0
  s_add_u32 m0, s43, 16384
  s_nop 0
  s_waitcnt vmcnt(4)
  buffer_load_dwordx4 v1, s[8:11], s44 offen offset:0 nt lds
  v_xor_b32 v5, 16, v1
  s_waitcnt vmcnt(4)
  buffer_load_dwordx4 v5, s[8:11], s44 offen offset:1024 nt lds
  v_xor_b32 v4, 32, v1
  s_waitcnt vmcnt(5)
  s_cbranch_vccnz L_w17
  s_waitcnt vmcnt(4)
L_w17:
  buffer_load_dwordx4 v4, s[8:11], s44 offen offset:2048 nt lds
  v_xor_b32 v5, 48, v1
  s_waitcnt vmcnt(4)
  buffer_load_dwordx4 v5, s[8:11], s44 offen offset:3072 nt lds
  s_add_u32 m0, s43, 20480
  v_xor_b32 v4, 128, v1
  s_waitcnt vmcnt(4)
  buffer_load_dwordx4 v4, s[8:11], s45 offen offset:0 nt lds
  ds_read_b128 a[64:67], v3 offset:0
  ds_read_b128 a[68:71], v3 offset:256
  v_xor_b32 v5, 32, v3
  ds_read_b128 a[72:75], v5 offset:0
  ds_read_b128 a[76:79], v5 offset:256
  v_xor_b32 v4, 64, v3
  ds_read_b128 a[80:83], v4 offset:0
  ds_read_b128 a[84:87], v4 offset:256
  v_xor_b32 v5, 96, v3
  ds_read_b128 a[88:91], v5 offset:0
  ds_read_b128 a[92:95], v5 offset:256
  v_xor_b32 v4, 128, v3
  ds_read_b128 a[96:99], v4 offset:0
  ds_read_b128 a[100:103], v4 offset:256
  v_xor_b32 v5, 160, v3
  ds_read_b128 a[104:107], v5 offset:0
  ds_read_b128 a[108:111], v5 offset:256
  v_xor_b32 v4, 192, v3
  ds_read_b128 a[112:115], v4 offset:0
  ds_read_b128 a[116:119], v4 offset:256
  v_xor_b32 v5, 224, v3
  ds_read_b128 a[120:123], v5 offset:0
  ds_read_b128 a[124:127], v5 offset:256
  s_waitcnt lgkmcnt(15)
  v_mfma_f32_32x32x16_bf16 v[16:31], a[64:67], a[0:3], v[16:31]
  s_waitcnt lgkmcnt(14)
  v_mfma_f32_32x32x16_bf16 v[16:31], a[68:71], a[32:35], v[16:31]
  v_xor_b32 v5, 144, v1
  s_waitcnt vmcnt(4)
  buffer_load_dwordx4 v5, s[8:11], s45 offen offset:1024 nt lds
  s_waitcnt lgkmcnt(13)
  v_mfma_f32_32x32x16_bf16 v[16:31], a[72:75], a[4:7], v[16:31]
  s_waitcnt lgkmcnt(12)
  v_mfma_f32_32x32x16_bf16 v[16:31], a[76:79], a[36:39], v[16:31]
  s_waitcnt lgkmcnt(11)
  v_mfma_f32_32x32x16_bf16 v[16:31], a[80:83], a[8:11], v[16:31]
  v_xor_b32 v4, 160, v1
  s_waitcnt vmcnt(4)
  buffer_load_dwordx4 v4, s[8:11], s45 offen offset:2048 nt lds
  s_waitcnt lgkmcnt(10)
  v_mfma_f32_32x32x16_bf16 v[16:31], a[84:87], a[40:43], v[16:31]
  s_waitcnt lgkmcnt(9)
  v_mfma_f32_32x32x16_bf16 v[16:31], a[88:91], a[12:15], v[16:31]
  s_waitcnt lgkmcnt(8)
  v_mfma_f32_32x32x16_bf16 v[16:31], a[92:95], a[44:47], v[16:31]
  v_xor_b32 v5, 176, v1
  s_waitcnt vmcnt(4)
  buffer_load_dwordx4 v5, s[8:11], s45 offen offset:3072 nt lds
  s_waitcnt lgkmcnt(7)
  v_mfma_f32_32x32x16_bf16 v[16:31], a[96:99], a[16:19], v[16:31]
  s_waitcnt lgkmcnt(6)
  v_mfma_f32_32x32x16_bf16 v[16:31], a[100:103], a[48:51], v[16:31]
  s_waitcnt lgkmcnt(5)
  v_mfma_f32_32x32x16_bf16 v[16:31], a[104:107], a[20:23], v[16:31]
  s_add_u32 m0, s43, 24576
  s_nop 0
  s_waitcnt vmcnt(4)
  buffer_load_dwordx4 v1, s[8:11], s46 offen offset:0 nt lds
  s_waitcnt lgkmcnt(4)
  v_mfma_f32_32x32x16_bf16 v[16:31], a[108:111], a[52:55], v[16:31]
  s_waitcnt lgkmcnt(3)
  v_mfma_f32_32x32x16_bf16 v[16:31], a[112:115], a[24:27], v[16:31]
  s_waitcnt lgkmcnt(2)
  v_mfma_f32_32x32x16_bf16 v[16:31], a[116:119], a[56:59], v[16:31]
  v_xor_b32 v5, 16, v1
  s_waitcnt vmcnt(4)
  buffer_load_dwordx4 v5, s[8:11], s46 offen offset:1024 nt lds
  s_waitcnt lgkmcnt(1)
  v_mfma_f32_32x32x16_bf16 v[16:31], a[120:123], a[28:31], v[16:31]
  s_waitcnt lgkmcnt(0)
  v_mfma_f32_32x32x16_bf16 v[16:31], a[124:127], a[60:63], v[16:31]
  v_xor_b32 v4, 32, v1
  s_waitcnt vmcnt(5)
  s_cbranch_vccnz L_w18
  s_waitcnt vmcnt(4)
L_w18:
  buffer_load_dwordx4 v4, s[8:11], s46 offen offset:2048 nt lds
  s_nop 7
  s_nop 3
  v_max3_f32 v8, v16, v17, v18
  v_max3_f32 v8, v8, v19, v20
  v_max3_f32 v8, v8, v21, v22
  v_max3_f32 v8, v8, v23, v24
  v_max3_f32 v8, v8, v25, v26
  v_max3_f32 v8, v8, v27, v28
  v_max3_f32 v8, v8, v29, v30
  v_max_f32 v8, v8, v31
  v_mul_f32 v8, s40, v8
  v_mov_b32 v9, v8
  s_nop 1
  v_permlane32_swap_b32 v8, v9
  s_nop 1
  v_max3_f32 v8, v8, v9, v6
  v_sub_f32 v10, v6, v8
  v_exp_f32 v10, v10
  v_mov_b32 v6, v8
  v_mov_b32 v11, v10
  v_mul_f32 v7, v7, v10
  v_mov_b32 v48, v10
  v_xor_b32 v5, 48, v1
  s_waitcnt vmcnt(4)
  buffer_load_dwordx4 v5, s[8:11], s46 offen offset:3072 nt lds
  v_fma_f32 v16, v16, s40, -v6
  v_fma_f32 v17, v17, s40, -v6
  v_fma_f32 v18, v18, s40, -v6
  v_fma_f32 v19, v19, s40, -v6
  v_fma_f32 v20, v20, s40, -v6
  v_fma_f32 v21, v21, s40, -v6
  v_fma_f32 v22, v22, s40, -v6
  v_fma_f32 v23, v23, s40, -v6
  v_exp_f32 v16, v16
  v_exp_f32 v17, v17
  v_exp_f32 v18, v18
  v_exp_f32 v19, v19
  v_exp_f32 v20, v20
  v_exp_f32 v21, v21
  v_exp_f32 v22, v22
  v_exp_f32 v23, v23
  s_nop 0
  v_add_f32 v7, v7, v16
  v_add_f32 v7, v7, v17
  v_add_f32 v7, v7, v18
  v_add_f32 v7, v7, v19
  v_add_f32 v7, v7, v20
  v_add_f32 v7, v7, v21
  v_add_f32 v7, v7, v22
  v_add_f32 v7, v7, v23
  v_cvt_pk_bf16_f32 v32, v16, v17
  v_cvt_pk_bf16_f32 v33, v18, v19
  v_cvt_pk_bf16_f32 v34, v20, v21
  v_cvt_pk_bf16_f32 v35, v22, v23
  v_accvgpr_write_b32 a192, v32
  v_accvgpr_write_b32 a193, v33
  v_accvgpr_write_b32 a194, v34
  v_accvgpr_write_b32 a195, v35
  s_add_u32 m0, s43, 28672
  v_xor_b32 v4, 128, v1
  s_waitcnt vmcnt(4)
  buffer_load_dwordx4 v4, s[8:11], s47 offen offset:0 nt lds
  v_fma_f32 v24, v24, s40, -v6
  v_fma_f32 v25, v25, s40, -v6
  v_fma_f32 v26, v26, s40, -v6
  v_fma_f32 v27, v27, s40, -v6
  v_fma_f32 v28, v28, s40, -v6
  v_fma_f32 v29, v29, s40, -v6
  v_fma_f32 v30, v30, s40, -v6
  v_fma_f32 v31, v31, s40, -v6
  v_exp_f32 v24, v24
  v_exp_f32 v25, v25
  v_exp_f32 v26, v26
  v_exp_f32 v27, v27
  v_exp_f32 v28, v28
  v_exp_f32 v29, v29
  v_exp_f32 v30, v30
  v_exp_f32 v31, v31
  s_nop 0
  v_add_f32 v7, v7, v24
  v_add_f32 v7, v7, v25
  v_add_f32 v7, v7, v26
  v_add_f32 v7, v7, v27
  v_add_f32 v7, v7, v28
  v_add_f32 v7, v7, v29
  v_add_f32 v7, v7, v30
  v_add_f32 v7, v7, v31
  v_cvt_pk_bf16_f32 v36, v24, v25
  v_cvt_pk_bf16_f32 v37, v26, v27
  v_cvt_pk_bf16_f32 v38, v28, v29
  v_cvt_pk_bf16_f32 v39, v30, v31
  v_accvgpr_write_b32 a196, v36
  v_accvgpr_write_b32 a197, v37
  v_accvgpr_write_b32 a198, v38
  v_accvgpr_write_b32 a199, v39
  v_xor_b32 v5, 144, v1
  s_waitcnt vmcnt(4)
  buffer_load_dwordx4 v5, s[8:11], s47 offen offset:1024 nt lds
  v_xor_b32 v4, 160, v1
  s_waitcnt vmcnt(4)
  buffer_load_dwordx4 v4, s[8:11], s47 offen offset:2048 nt lds
  v_xor_b32 v5, 176, v1
  s_waitcnt vmcnt(4)
  buffer_load_dwordx4 v5, s[8:11], s47 offen offset:3072 nt lds
  s_add_u32 s44, s55, 655360
  s_add_u32 s45, s55, 671744
  s_add_u32 s46, s55, 688128
  s_add_u32 s47, s55, 704512
  v_mov_b32 v16, 0
  v_mov_b32 v17, 0
  v_mov_b32 v18, 0
  v_mov_b32 v19, 0
  v_mov_b32 v20, 0
  v_mov_b32 v21, 0
  v_mov_b32 v22, 0
  v_mov_b32 v23, 0
  v_mov_b32 v24, 0
  v_mov_b32 v25, 0
  v_mov_b32 v26, 0
  v_mov_b32 v27, 0
  v_mov_b32 v28, 0
  v_mov_b32 v29, 0
  v_mov_b32 v30, 0
  v_mov_b32 v31, 0
  s_add_u32 m0, s43, 0
  s_nop 0
  s_waitcnt vmcnt(4)
  buffer_load_dwordx4 v1, s[8:11], s44 offen offset:0 nt lds
  v_xor_b32 v5, 16, v1
  s_waitcnt vmcnt(4)
  buffer_load_dwordx4 v5, s[8:11], s44 offen offset:1024 nt lds
  v_xor_b32 v4, 32, v1
  s_waitcnt vmcnt(5)
  s_cbranch_vccnz L_w19
  s_waitcnt vmcnt(4)
L_w19:
  buffer_load_dwordx4 v4, s[8:11], s44 offen offset:2048 nt lds
  v_xor_b32 v5, 48, v1
  s_waitcnt vmcnt(4)
  buffer_load_dwordx4 v5, s[8:11], s44 offen offset:3072 nt lds
  s_add_u32 m0, s43, 4096
  v_xor_b32 v4, 128, v1
  s_waitcnt vmcnt(4)
  buffer_load_dwordx4 v4, s[8:11], s45 offen offset:0 nt lds
  ds_read_b128 a[64:67], v3 offset:16384
  ds_read_b128 a[68:71], v3 offset:16640
  v_xor_b32 v5, 32, v3
  ds_read_b128 a[72:75], v5 offset:16384
  ds_read_b128 a[76:79], v5 offset:16640
  v_xor_b32 v4, 64, v3
  ds_read_b128 a[80:83], v4 offset:16384
  ds_read_b128 a[84:87], v4 offset:16640
  v_xor_b32 v5, 96, v3
  ds_read_b128 a[88:91], v5 offset:16384
  ds_read_b128 a[92:95], v5 offset:16640
  v_xor_b32 v4, 128, v3
  ds_read_b128 a[96:99], v4 offset:16384
  ds_read_b128 a[100:103], v4 offset:16640
  v_xor_b32 v5, 160, v3
  ds_read_b128 a[104:107], v5 offset:16384
  ds_read_b128 a[108:111], v5 offset:16640
  v_xor_b32 v4, 192, v3
  ds_read_b128 a[112:115], v4 offset:16384
  ds_read_b128 a[116:119], v4 offset:16640
  v_xor_b32 v5, 224, v3
  ds_read_b128 a[120:123], v5 offset:16384
  ds_read_b128 a[124:127], v5 offset:16640
  s_waitcnt lgkmcnt(15)
  v_mfma_f32_32x32x16_bf16 v[16:31], a[64:67], a[0:3], v[16:31]
  s_waitcnt lgkmcnt(14)
  v_mfma_f32_32x32x16_bf16 v[16:31], a[68:71], a[32:35], v[16:31]
  v_xor_b32 v5, 144, v1
  s_waitcnt vmcnt(4)
  buffer_load_dwordx4 v5, s[8:11], s45 offen offset:1024 nt lds
  s_waitcnt lgkmcnt(13)
  v_mfma_f32_32x32x16_bf16 v[16:31], a[72:75], a[4:7], v[16:31]
  s_waitcnt lgkmcnt(12)
  v_mfma_f32_32x32x16_bf16 v[16:31], a[76:79], a[36:39], v[16:31]
  s_waitcnt lgkmcnt(11)
  v_mfma_f32_32x32x16_bf16 v[16:31], a[80:83], a[8:11], v[16:31]
  v_xor_b32 v4, 160, v1
  s_waitcnt vmcnt(4)
  buffer_load_dwordx4 v4, s[8:11], s45 offen offset:2048 nt lds
  s_waitcnt lgkmcnt(10)
  v_mfma_f32_32x32x16_bf16 v[16:31], a[84:87], a[40:43], v[16:31]
  s_waitcnt lgkmcnt(9)
  v_mfma_f32_32x32x16_bf16 v[16:31], a[88:91], a[12:15], v[16:31]
  s_waitcnt lgkmcnt(8)
  v_mfma_f32_32x32x16_bf16 v[16:31], a[92:95], a[44:47], v[16:31]
  v_xor_b32 v5, 176, v1
  s_waitcnt vmcnt(4)
  buffer_load_dwordx4 v5, s[8:11], s45 offen offset:3072 nt lds
  s_waitcnt lgkmcnt(7)
  v_mfma_f32_32x32x16_bf16 v[16:31], a[96:99], a[16:19], v[16:31]
  s_waitcnt lgkmcnt(6)
  v_mfma_f32_32x32x16_bf16 v[16:31], a[100:103], a[48:51], v[16:31]
  s_waitcnt lgkmcnt(5)
  v_mfma_f32_32x32x16_bf16 v[16:31], a[104:107], a[20:23], v[16:31]
  s_add_u32 m0, s43, 8192
  s_nop 0
  s_waitcnt vmcnt(4)
  buffer_load_dwordx4 v1, s[8:11], s46 offen offset:0 nt lds
  s_waitcnt lgkmcnt(4)
  v_mfma_f32_32x32x16_bf16 v[16:31], a[108:111], a[52:55], v[16:31]
  s_waitcnt lgkmcnt(3)
  v_mfma_f32_32x32x16_bf16 v[16:31], a[112:115], a[24:27], v[16:31]
  s_waitcnt lgkmcnt(2)
  v_mfma_f32_32x32x16_bf16 v[16:31], a[116:119], a[56:59], v[16:31]
  v_xor_b32 v5, 16, v1
  s_waitcnt vmcnt(4)
  buffer_load_dwordx4 v5, s[8:11], s46 offen offset:1024 nt lds
  s_waitcnt lgkmcnt(1)
  v_mfma_f32_32x32x16_bf16 v[16:31], a[120:123], a[28:31], v[16:31]
  s_waitcnt lgkmcnt(0)
  v_mfma_f32_32x32x16_bf16 v[16:31], a[124:127], a[60:63], v[16:31]
  v_xor_b32 v4, 32, v1
  s_waitcnt vmcnt(5)
  s_cbranch_vccnz L_w20
  s_waitcnt vmcnt(4)
L_w20:
  buffer_load_dwordx4 v4, s[8:11], s46 offen offset:2048 nt lds
  s_nop 7
  s_nop 3
  v_max3_f32 v8, v16, v17, v18
  v_max3_f32 v8, v8, v19, v20
  v_max3_f32 v8, v8, v21, v22
  v_max3_f32 v8, v8, v23, v24
  v_max3_f32 v8, v8, v25, v26
  v_max3_f32 v8, v8, v27, v28
  v_max3_f32 v8, v8, v29, v30
  v_max_f32 v8, v8, v31
  v_mul_f32 v8, s40, v8
  v_mov_b32 v9, v8
  s_nop 1
  v_permlane32_swap_b32 v8, v9
  s_nop 1
  v_max3_f32 v8, v8, v9, v6
  v_sub_f32 v10, v6, v8
  v_exp_f32 v10, v10
  v_mov_b32 v6, v8
  v_mov_b32 v11, v10
  v_mul_f32 v7, v7, v10
  v_mov_b32 v49, v10
  v_xor_b32 v5, 48, v1
  s_waitcnt vmcnt(4)
  buffer_load_dwordx4 v5, s[8:11], s46 offen offset:3072 nt lds
  v_fma_f32 v16, v16, s40, -v6
  v_fma_f32 v17, v17, s40, -v6
  v_fma_f32 v18, v18, s40, -v6
  v_fma_f32 v19, v19, s40, -v6
  v_fma_f32 v20, v20, s40, -v6
  v_fma_f32 v21, v21, s40, -v6
  v_fma_f32 v22, v22, s40, -v6
  v_fma_f32 v23, v23, s40, -v6
  v_exp_f32 v16, v16
  v_exp_f32 v17, v17
  v_exp_f32 v18, v18
  v_exp_f32 v19, v19
  v_exp_f32 v20, v20
  v_exp_f32 v21, v21
  v_exp_f32 v22, v22
  v_exp_f32 v23, v23
  s_nop 0
  v_add_f32 v7, v7, v16
  v_add_f32 v7, v7, v17
  v_add_f32 v7, v7, v18
  v_add_f32 v7, v7, v19
  v_add_f32 v7, v7, v20
  v_add_f32 v7, v7, v21
  v_add_f32 v7, v7, v22
  v_add_f32 v7, v7, v23
  v_cvt_pk_bf16_f32 v32, v16, v17
  v_cvt_pk_bf16_f32 v33, v18, v19
  v_cvt_pk_bf16_f32 v34, v20, v21
  v_cvt_pk_bf16_f32 v35, v22, v23
  v_accvgpr_write_b32 a200, v32
  v_accvgpr_write_b32 a201, v33
  v_accvgpr_write_b32 a202, v34
  v_accvgpr_write_b32 a203, v35
  s_add_u32 m0, s43, 12288
  v_xor_b32 v4, 128, v1
  s_waitcnt vmcnt(4)
  buffer_load_dwordx4 v4, s[8:11], s47 offen offset:0 nt lds
  v_fma_f32 v24, v24, s40, -v6
  v_fma_f32 v25, v25, s40, -v6
  v_fma_f32 v26, v26, s40, -v6
  v_fma_f32 v27, v27, s40, -v6
  v_fma_f32 v28, v28, s40, -v6
  v_fma_f32 v29, v29, s40, -v6
  v_fma_f32 v30, v30, s40, -v6
  v_fma_f32 v31, v31, s40, -v6
  v_exp_f32 v24, v24
  v_exp_f32 v25, v25
  v_exp_f32 v26, v26
  v_exp_f32 v27, v27
  v_exp_f32 v28, v28
  v_exp_f32 v29, v29
  v_exp_f32 v30, v30
  v_exp_f32 v31, v31
  s_nop 0
  v_add_f32 v7, v7, v24
  v_add_f32 v7, v7, v25
  v_add_f32 v7, v7, v26
  v_add_f32 v7, v7, v27
  v_add_f32 v7, v7, v28
  v_add_f32 v7, v7, v29
  v_add_f32 v7, v7, v30
  v_add_f32 v7, v7, v31
  v_cvt_pk_bf16_f32 v36, v24, v25
  v_cvt_pk_bf16_f32 v37, v26, v27
  v_cvt_pk_bf16_f32 v38, v28, v29
  v_cvt_pk_bf16_f32 v39, v30, v31
  v_accvgpr_write_b32 a204, v36
  v_accvgpr_write_b32 a205, v37
  v_accvgpr_write_b32 a206, v38
  v_accvgpr_write_b32 a207, v39
  v_xor_b32 v5, 144, v1
  s_waitcnt vmcnt(4)
  buffer_load_dwordx4 v5, s[8:11], s47 offen offset:1024 nt lds
  v_xor_b32 v4, 160, v1
  s_waitcnt vmcnt(4)
  buffer_load_dwordx4 v4, s[8:11], s47 offen offset:2048 nt lds
  v_xor_b32 v5, 176, v1
  s_waitcnt vmcnt(4)
  buffer_load_dwordx4 v5, s[8:11], s47 offen offset:3072 nt lds
  s_add_u32 s44, s55, 720896
  s_add_u32 s45, s55, 737280
  s_add_u32 s46, s55, 753664
  s_add_u32 s47, s55, 770048
  v_mov_b32 v16, 0
  v_mov_b32 v17, 0
  v_mov_b32 v18, 0
  v_mov_b32 v19, 0
  v_mov_b32 v20, 0
  v_mov_b32 v21, 0
  v_mov_b32 v22, 0
  v_mov_b32 v23, 0
  v_mov_b32 v24, 0
  v_mov_b32 v25, 0
  v_mov_b32 v26, 0
  v_mov_b32 v27, 0
  v_mov_b32 v28, 0
  v_mov_b32 v29, 0
  v_mov_b32 v30, 0
  v_mov_b32 v31, 0
  s_add_u32 m0, s43, 16384
  s_nop 0
  s_waitcnt vmcnt(4)
  buffer_load_dwordx4 v1, s[8:11], s44 offen offset:0 nt lds
  v_xor_b32 v5, 16, v1
  s_waitcnt vmcnt(4)
  buffer_load_dwordx4 v5, s[8:11], s44 offen offset:1024 nt lds
  v_xor_b32 v4, 32, v1
  s_waitcnt vmcnt(5)
  s_cbranch_vccnz L_w21
  s_waitcnt vmcnt(4)
L_w21:
  buffer_load_dwordx4 v4, s[8:11], s44 offen offset:2048 nt lds
  v_xor_b32 v5, 48, v1
  s_waitcnt vmcnt(4)
  buffer_load_dwordx4 v5, s[8:11], s44 offen offset:3072 nt lds
  s_add_u32 m0, s43, 20480
  v_xor_b32 v4, 128, v1
  s_waitcnt vmcnt(4)
  buffer_load_dwordx4 v4, s[8:11], s45 offen offset:0 nt lds
  ds_read_b128 a[64:67], v3 offset:0
  ds_read_b128 a[68:71], v3 offset:256
  v_xor_b32 v5, 32, v3
  ds_read_b128 a[72:75], v5 offset:0
  ds_read_b128 a[76:79], v5 offset:256
  v_xor_b32 v4, 64, v3
  ds_read_b128 a[80:83], v4 offset:0
  ds_read_b128 a[84:87], v4 offset:256
  v_xor_b32 v5, 96, v3
  ds_read_b128 a[88:91], v5 offset:0
  ds_read_b128 a[92:95], v5 offset:256
  v_xor_b32 v4, 128, v3
  ds_read_b128 a[96:99], v4 offset:0
  ds_read_b128 a[100:103], v4 offset:256
  v_xor_b32 v5, 160, v3
  ds_read_b128 a[104:107], v5 offset:0
  ds_read_b128 a[108:111], v5 offset:256
  v_xor_b32 v4, 192, v3
  ds_read_b128 a[112:115], v4 offset:0
  ds_read_b128 a[116:119], v4 offset:256
  v_xor_b32 v5, 224, v3
  ds_read_b128 a[120:123], v5 offset:0
  ds_read_b128 a[124:127], v5 offset:256
  s_waitcnt lgkmcnt(15)
  v_mfma_f32_32x32x16_bf16 v[16:31], a[64:67], a[0:3], v[16:31]
  s_waitcnt lgkmcnt(14)
  v_mfma_f32_32x32x16_bf16 v[16:31], a[68:71], a[32:35], v[16:31]
  v_xor_b32 v5, 144, v1
  s_waitcnt vmcnt(4)
  buffer_load_dwordx4 v5, s[8:11], s45 offen offset:1024 nt lds
  s_waitcnt lgkmcnt(13)
  v_mfma_f32_32x32x16_bf16 v[16:31], a[72:75], a[4:7], v[16:31]
  s_waitcnt lgkmcnt(12)
  v_mfma_f32_32x32x16_bf16 v[16:31], a[76:79], a[36:39], v[16:31]
  s_waitcnt lgkmcnt(11)
  v_mfma_f32_32x32x16_bf16 v[16:31], a[80:83], a[8:11], v[16:31]
  v_xor_b32 v4, 160, v1
  s_waitcnt vmcnt(4)
  buffer_load_dwordx4 v4, s[8:11], s45 offen offset:2048 nt lds
  s_waitcnt lgkmcnt(10)
  v_mfma_f32_32x32x16_bf16 v[16:31], a[84:87], a[40:43], v[16:31]
  s_waitcnt lgkmcnt(9)
  v_mfma_f32_32x32x16_bf16 v[16:31], a[88:91], a[12:15], v[16:31]
  s_waitcnt lgkmcnt(8)
  v_mfma_f32_32x32x16_bf16 v[16:31], a[92:95], a[44:47], v[16:31]
  v_xor_b32 v5, 176, v1
  s_waitcnt vmcnt(4)
  buffer_load_dwordx4 v5, s[8:11], s45 offen offset:3072 nt lds
  s_waitcnt lgkmcnt(7)
  v_mfma_f32_32x32x16_bf16 v[16:31], a[96:99], a[16:19], v[16:31]
  s_waitcnt lgkmcnt(6)
  v_mfma_f32_32x32x16_bf16 v[16:31], a[100:103], a[48:51], v[16:31]
  s_waitcnt lgkmcnt(5)
  v_mfma_f32_32x32x16_bf16 v[16:31], a[104:107], a[20:23], v[16:31]
  s_add_u32 m0, s43, 24576
  s_nop 0
  s_waitcnt vmcnt(4)
  buffer_load_dwordx4 v1, s[8:11], s46 offen offset:0 nt lds
  s_waitcnt lgkmcnt(4)
  v_mfma_f32_32x32x16_bf16 v[16:31], a[108:111], a[52:55], v[16:31]
  s_waitcnt lgkmcnt(3)
  v_mfma_f32_32x32x16_bf16 v[16:31], a[112:115], a[24:27], v[16:31]
  s_waitcnt lgkmcnt(2)
  v_mfma_f32_32x32x16_bf16 v[16:31], a[116:119], a[56:59], v[16:31]
  v_xor_b32 v5, 16, v1
  s_waitcnt vmcnt(4)
  buffer_load_dwordx4 v5, s[8:11], s46 offen offset:1024 nt lds
  s_waitcnt lgkmcnt(1)
  v_mfma_f32_32x32x16_bf16 v[16:31], a[120:123], a[28:31], v[16:31]
  s_waitcnt lgkmcnt(0)
  v_mfma_f32_32x32x16_bf16 v[16:31], a[124:127], a[60:63], v[16:31]
  v_xor_b32 v4, 32, v1
  s_waitcnt vmcnt(5)
  s_cbranch_vccnz L_w22
  s_waitcnt vmcnt(4)
L_w22:
  buffer_load_dwordx4 v4, s[8:11], s46 offen offset:2048 nt lds
  s_nop 7
  s_nop 3
  v_max3_f32 v8, v16, v17, v18
  v_max3_f32 v8, v8, v19, v20
  v_max3_f32 v8, v8, v21, v22
  v_max3_f32 v8, v8, v23, v24
  v_max3_f32 v8, v8, v25, v26
  v_max3_f32 v8, v8, v27, v28
  v_max3_f32 v8, v8, v29, v30
  v_max_f32 v8, v8, v31
  v_mul_f32 v8, s40, v8
  v_mov_b32 v9, v8
  s_nop 1
  v_permlane32_swap_b32 v8, v9
  s_nop 1
  v_max3_f32 v8, v8, v9, v6
  v_sub_f32 v10, v6, v8
  v_exp_f32 v10, v10
  v_mov_b32 v6, v8
  v_mov_b32 v11, v10
  v_mul_f32 v7, v7, v10
  v_mov_b32 v50, v10
  v_xor_b32 v5, 48, v1
  s_waitcnt vmcnt(4)
  buffer_load_dwordx4 v5, s[8:11], s46 offen offset:3072 nt lds
  v_fma_f32 v16, v16, s40, -v6
  v_fma_f32 v17, v17, s40, -v6
  v_fma_f32 v18, v18, s40, -v6
  v_fma_f32 v19, v19, s40, -v6
  v_fma_f32 v20, v20, s40, -v6
  v_fma_f32 v21, v21, s40, -v6
  v_fma_f32 v22, v22, s40, -v6
  v_fma_f32 v23, v23, s40, -v6
  v_exp_f32 v16, v16
  v_exp_f32 v17, v17
  v_exp_f32 v18, v18
  v_exp_f32 v19, v19
  v_exp_f32 v20, v20
  v_exp_f32 v21, v21
  v_exp_f32 v22, v22
  v_exp_f32 v23, v23
  s_nop 0
  v_add_f32 v7, v7, v16
  v_add_f32 v7, v7, v17
  v_add_f32 v7, v7, v18
  v_add_f32 v7, v7, v19
  v_add_f32 v7, v7, v20
  v_add_f32 v7, v7, v21
  v_add_f32 v7, v7, v22
  v_add_f32 v7, v7, v23
  v_cvt_pk_bf16_f32 v32, v16, v17
  v_cvt_pk_bf16_f32 v33, v18, v19
  v_cvt_pk_bf16_f32 v34, v20, v21
  v_cvt_pk_bf16_f32 v35, v22, v23
  v_accvgpr_write_b32 a208, v32
  v_accvgpr_write_b32 a209, v33
  v_accvgpr_write_b32 a210, v34
  v_accvgpr_write_b32 a211, v35
  s_add_u32 m0, s43, 28672
  v_xor_b32 v4, 128, v1
  s_waitcnt vmcnt(4)
  buffer_load_dwordx4 v4, s[8:11], s47 offen offset:0 nt lds
  v_fma_f32 v24, v24, s40, -v6
  v_fma_f32 v25, v25, s40, -v6
  v_fma_f32 v26, v26, s40, -v6
  v_fma_f32 v27, v27, s40, -v6
  v_fma_f32 v28, v28, s40, -v6
  v_fma_f32 v29, v29, s40, -v6
  v_fma_f32 v30, v30, s40, -v6
  v_fma_f32 v31, v31, s40, -v6
  v_exp_f32 v24, v24
  v_exp_f32 v25, v25
  v_exp_f32 v26, v26
  v_exp_f32 v27, v27
  v_exp_f32 v28, v28
  v_exp_f32 v29, v29
  v_exp_f32 v30, v30
  v_exp_f32 v31, v31
  s_nop 0
  v_add_f32 v7, v7, v24
  v_add_f32 v7, v7, v25
  v_add_f32 v7, v7, v26
  v_add_f32 v7, v7, v27
  v_add_f32 v7, v7, v28
  v_add_f32 v7, v7, v29
  v_add_f32 v7, v7, v30
  v_add_f32 v7, v7, v31
  v_cvt_pk_bf16_f32 v36, v24, v25
  v_cvt_pk_bf16_f32 v37, v26, v27
  v_cvt_pk_bf16_f32 v38, v28, v29
  v_cvt_pk_bf16_f32 v39, v30, v31
  v_accvgpr_write_b32 a212, v36
  v_accvgpr_write_b32 a213, v37
  v_accvgpr_write_b32 a214, v38
  v_accvgpr_write_b32 a215, v39
  v_xor_b32 v5, 144, v1
  s_waitcnt vmcnt(4)
  buffer_load_dwordx4 v5, s[8:11], s47 offen offset:1024 nt lds
  v_xor_b32 v4, 160, v1
  s_waitcnt vmcnt(4)
  buffer_load_dwordx4 v4, s[8:11], s47 offen offset:2048 nt lds
  v_xor_b32 v5, 176, v1
  s_waitcnt vmcnt(4)
  buffer_load_dwordx4 v5, s[8:11], s47 offen offset:3072 nt lds
  s_add_u32 s44, s55, 786432
  s_add_u32 s45, s55, 802816
  s_add_u32 s46, s55, 819200
  s_add_u32 s47, s55, 835584
  v_mov_b32 v16, 0
  v_mov_b32 v17, 0
  v_mov_b32 v18, 0
  v_mov_b32 v19, 0
  v_mov_b32 v20, 0
  v_mov_b32 v21, 0
  v_mov_b32 v22, 0
  v_mov_b32 v23, 0
  v_mov_b32 v24, 0
  v_mov_b32 v25, 0
  v_mov_b32 v26, 0
  v_mov_b32 v27, 0
  v_mov_b32 v28, 0
  v_mov_b32 v29, 0
  v_mov_b32 v30, 0
  v_mov_b32 v31, 0
  s_add_u32 m0, s43, 0
  s_nop 0
  s_waitcnt vmcnt(4)
  buffer_load_dwordx4 v1, s[8:11], s44 offen offset:0 nt lds
  v_xor_b32 v5, 16, v1
  s_waitcnt vmcnt(4)
  buffer_load_dwordx4 v5, s[8:11], s44 offen offset:1024 nt lds
  v_xor_b32 v4, 32, v1
  s_waitcnt vmcnt(5)
  s_cbranch_vccnz L_w23
  s_waitcnt vmcnt(4)
L_w23:
  buffer_load_dwordx4 v4, s[8:11], s44 offen offset:2048 nt lds
  v_xor_b32 v5, 48, v1
  s_waitcnt vmcnt(4)
  buffer_load_dwordx4 v5, s[8:11], s44 offen offset:3072 nt lds
  s_add_u32 m0, s43, 4096
  v_xor_b32 v4, 128, v1
  s_waitcnt vmcnt(4)
  buffer_load_dwordx4 v4, s[8:11], s45 offen offset:0 nt lds
  ds_read_b128 a[64:67], v3 offset:16384
  ds_read_b128 a[68:71], v3 offset:16640
  v_xor_b32 v5, 32, v3
  ds_read_b128 a[72:75], v5 offset:16384
  ds_read_b128 a[76:79], v5 offset:16640
  v_xor_b32 v4, 64, v3
  ds_read_b128 a[80:83], v4 offset:16384
  ds_read_b128 a[84:87], v4 offset:16640
  v_xor_b32 v5, 96, v3
  ds_read_b128 a[88:91], v5 offset:16384
  ds_read_b128 a[92:95], v5 offset:16640
  v_xor_b32 v4, 128, v3
  ds_read_b128 a[96:99], v4 offset:16384
  ds_read_b128 a[100:103], v4 offset:16640
  v_xor_b32 v5, 160, v3
  ds_read_b128 a[104:107], v5 offset:16384
  ds_read_b128 a[108:111], v5 offset:16640
  v_xor_b32 v4, 192, v3
  ds_read_b128 a[112:115], v4 offset:16384
  ds_read_b128 a[116:119], v4 offset:16640
  v_xor_b32 v5, 224, v3
  ds_read_b128 a[120:123], v5 offset:16384
  ds_read_b128 a[124:127], v5 offset:16640
  s_waitcnt lgkmcnt(15)
  v_mfma_f32_32x32x16_bf16 v[16:31], a[64:67], a[0:3], v[16:31]
  s_waitcnt lgkmcnt(14)
  v_mfma_f32_32x32x16_bf16 v[16:31], a[68:71], a[32:35], v[16:31]
  v_xor_b32 v5, 144, v1
  s_waitcnt vmcnt(4)
  buffer_load_dwordx4 v5, s[8:11], s45 offen offset:1024 nt lds
  s_waitcnt lgkmcnt(13)
  v_mfma_f32_32x32x16_bf16 v[16:31], a[72:75], a[4:7], v[16:31]
  s_waitcnt lgkmcnt(12)
  v_mfma_f32_32x32x16_bf16 v[16:31], a[76:79], a[36:39], v[16:31]
  s_waitcnt lgkmcnt(11)
  v_mfma_f32_32x32x16_bf16 v[16:31], a[80:83], a[8:11], v[16:31]
  v_xor_b32 v4, 160, v1
  s_waitcnt vmcnt(4)
  buffer_load_dwordx4 v4, s[8:11], s45 offen offset:2048 nt lds
  s_waitcnt lgkmcnt(10)
  v_mfma_f32_32x32x16_bf16 v[16:31], a[84:87], a[40:43], v[16:31]
  s_waitcnt lgkmcnt(9)
  v_mfma_f32_32x32x16_bf16 v[16:31], a[88:91], a[12:15], v[16:31]
  s_waitcnt lgkmcnt(8)
  v_mfma_f32_32x32x16_bf16 v[16:31], a[92:95], a[44:47], v[16:31]
  v_xor_b32 v5, 176, v1
  s_waitcnt vmcnt(4)
  buffer_load_dwordx4 v5, s[8:11], s45 offen offset:3072 nt lds
  s_waitcnt lgkmcnt(7)
  v_mfma_f32_32x32x16_bf16 v[16:31], a[96:99], a[16:19], v[16:31]
  s_waitcnt lgkmcnt(6)
  v_mfma_f32_32x32x16_bf16 v[16:31], a[100:103], a[48:51], v[16:31]
  s_waitcnt lgkmcnt(5)
  v_mfma_f32_32x32x16_bf16 v[16:31], a[104:107], a[20:23], v[16:31]
  s_add_u32 m0, s43, 8192
  s_nop 0
  s_waitcnt vmcnt(4)
  buffer_load_dwordx4 v1, s[8:11], s46 offen offset:0 nt lds
  s_waitcnt lgkmcnt(4)
  v_mfma_f32_32x32x16_bf16 v[16:31], a[108:111], a[52:55], v[16:31]
  s_waitcnt lgkmcnt(3)
  v_mfma_f32_32x32x16_bf16 v[16:31], a[112:115], a[24:27], v[16:31]
  s_waitcnt lgkmcnt(2)
  v_mfma_f32_32x32x16_bf16 v[16:31], a[116:119], a[56:59], v[16:31]
  v_xor_b32 v5, 16, v1
  s_waitcnt vmcnt(4)
  buffer_load_dwordx4 v5, s[8:11], s46 offen offset:1024 nt lds
  s_waitcnt lgkmcnt(1)
  v_mfma_f32_32x32x16_bf16 v[16:31], a[120:123], a[28:31], v[16:31]
  s_waitcnt lgkmcnt(0)
  v_mfma_f32_32x32x16_bf16 v[16:31], a[124:127], a[60:63], v[16:31]
  v_xor_b32 v4, 32, v1
  s_waitcnt vmcnt(5)
  s_cbranch_vccnz L_w24
  s_waitcnt vmcnt(4)
L_w24:
  buffer_load_dwordx4 v4, s[8:11], s46 offen offset:2048 nt lds
  s_nop 7
  s_nop 3
  v_max3_f32 v8, v16, v17, v18
  v_max3_f32 v8, v8, v19, v20
  v_max3_f32 v8, v8, v21, v22
  v_max3_f32 v8, v8, v23, v24
  v_max3_f32 v8, v8, v25, v26
  v_max3_f32 v8, v8, v27, v28
  v_max3_f32 v8, v8, v29, v30
  v_max_f32 v8, v8, v31
  v_mul_f32 v8, s40, v8
  v_mov_b32 v9, v8
  s_nop 1
  v_permlane32_swap_b32 v8, v9
  s_nop 1
  v_max3_f32 v8, v8, v9, v6
  v_sub_f32 v10, v6, v8
  v_exp_f32 v10, v10
  v_mov_b32 v6, v8
  v_mov_b32 v11, v10
  v_mul_f32 v7, v7, v10
  v_mov_b32 v51, v10
  v_xor_b32 v5, 48, v1
  s_waitcnt vmcnt(4)
  buffer_load_dwordx4 v5, s[8:11], s46 offen offset:3072 nt lds
  v_fma_f32 v16, v16, s40, -v6
  v_fma_f32 v17, v17, s40, -v6
  v_fma_f32 v18, v18, s40, -v6
  v_fma_f32 v19, v19, s40, -v6
  v_fma_f32 v20, v20, s40, -v6
  v_fma_f32 v21, v21, s40, -v6
  v_fma_f32 v22, v22, s40, -v6
  v_fma_f32 v23, v23, s40, -v6
  v_exp_f32 v16, v16
  v_exp_f32 v17, v17
  v_exp_f32 v18, v18
  v_exp_f32 v19, v19
  v_exp_f32 v20, v20
  v_exp_f32 v21, v21
  v_exp_f32 v22, v22
  v_exp_f32 v23, v23
  s_nop 0
  v_add_f32 v7, v7, v16
  v_add_f32 v7, v7, v17
  v_add_f32 v7, v7, v18
  v_add_f32 v7, v7, v19
  v_add_f32 v7, v7, v20
  v_add_f32 v7, v7, v21
  v_add_f32 v7, v7, v22
  v_add_f32 v7, v7, v23
  v_cvt_pk_bf16_f32 v32, v16, v17
  v_cvt_pk_bf16_f32 v33, v18, v19
  v_cvt_pk_bf16_f32 v34, v20, v21
  v_cvt_pk_bf16_f32 v35, v22, v23
  v_accvgpr_write_b32 a216, v32
  v_accvgpr_write_b32 a217, v33
  v_accvgpr_write_b32 a218, v34
  v_accvgpr_write_b32 a219, v35
  s_add_u32 m0, s43, 12288
  v_xor_b32 v4, 128, v1
  s_waitcnt vmcnt(4)
  buffer_load_dwordx4 v4, s[8:11], s47 offen offset:0 nt lds
  v_fma_f32 v24, v24, s40, -v6
  v_fma_f32 v25, v25, s40, -v6
  v_fma_f32 v26, v26, s40, -v6
  v_fma_f32 v27, v27, s40, -v6
  v_fma_f32 v28, v28, s40, -v6
  v_fma_f32 v29, v29, s40, -v6
  v_fma_f32 v30, v30, s40, -v6
  v_fma_f32 v31, v31, s40, -v6
  v_exp_f32 v24, v24
  v_exp_f32 v25, v25
  v_exp_f32 v26, v26
  v_exp_f32 v27, v27
  v_exp_f32 v28, v28
  v_exp_f32 v29, v29
  v_exp_f32 v30, v30
  v_exp_f32 v31, v31
  s_nop 0
  v_add_f32 v7, v7, v24
  v_add_f32 v7, v7, v25
  v_add_f32 v7, v7, v26
  v_add_f32 v7, v7, v27
  v_add_f32 v7, v7, v28
  v_add_f32 v7, v7, v29
  v_add_f32 v7, v7, v30
  v_add_f32 v7, v7, v31
  v_cvt_pk_bf16_f32 v36, v24, v25
  v_cvt_pk_bf16_f32 v37, v26, v27
  v_cvt_pk_bf16_f32 v38, v28, v29
  v_cvt_pk_bf16_f32 v39, v30, v31
  v_accvgpr_write_b32 a220, v36
  v_accvgpr_write_b32 a221, v37
  v_accvgpr_write_b32 a222, v38
  v_accvgpr_write_b32 a223, v39
  v_xor_b32 v5, 144, v1
  s_waitcnt vmcnt(4)
  buffer_load_dwordx4 v5, s[8:11], s47 offen offset:1024 nt lds
  v_xor_b32 v4, 160, v1
  s_waitcnt vmcnt(4)
  buffer_load_dwordx4 v4, s[8:11], s47 offen offset:2048 nt lds
  v_xor_b32 v5, 176, v1
  s_waitcnt vmcnt(4)
  buffer_load_dwordx4 v5, s[8:11], s47 offen offset:3072 nt lds
  s_add_u32 s44, s55, 851968
  s_add_u32 s45, s55, 868352
  s_add_u32 s46, s55, 884736
  s_add_u32 s47, s55, 901120
  v_mov_b32 v16, 0
  v_mov_b32 v17, 0
  v_mov_b32 v18, 0
  v_mov_b32 v19, 0
  v_mov_b32 v20, 0
  v_mov_b32 v21, 0
  v_mov_b32 v22, 0
  v_mov_b32 v23, 0
  v_mov_b32 v24, 0
  v_mov_b32 v25, 0
  v_mov_b32 v26, 0
  v_mov_b32 v27, 0
  v_mov_b32 v28, 0
  v_mov_b32 v29, 0
  v_mov_b32 v30, 0
  v_mov_b32 v31, 0
  s_add_u32 m0, s43, 16384
  s_nop 0
  s_waitcnt vmcnt(4)
  buffer_load_dwordx4 v1, s[8:11], s44 offen offset:0 nt lds
  v_xor_b32 v5, 16, v1
  s_waitcnt vmcnt(4)
  buffer_load_dwordx4 v5, s[8:11], s44 offen offset:1024 nt lds
  v_xor_b32 v4, 32, v1
  s_waitcnt vmcnt(5)
  s_cbranch_vccnz L_w25
  s_waitcnt vmcnt(4)
L_w25:
  buffer_load_dwordx4 v4, s[8:11], s44 offen offset:2048 nt lds
  v_xor_b32 v5, 48, v1
  s_waitcnt vmcnt(4)
  buffer_load_dwordx4 v5, s[8:11], s44 offen offset:3072 nt lds
  s_add_u32 m0, s43, 20480
  v_xor_b32 v4, 128, v1
  s_waitcnt vmcnt(4)
  buffer_load_dwordx4 v4, s[8:11], s45 offen offset:0 nt lds
  ds_read_b128 a[64:67], v3 offset:0
  ds_read_b128 a[68:71], v3 offset:256
  v_xor_b32 v5, 32, v3
  ds_read_b128 a[72:75], v5 offset:0
  ds_read_b128 a[76:79], v5 offset:256
  v_xor_b32 v4, 64, v3
  ds_read_b128 a[80:83], v4 offset:0
  ds_read_b128 a[84:87], v4 offset:256
  v_xor_b32 v5, 96, v3
  ds_read_b128 a[88:91], v5 offset:0
  ds_read_b128 a[92:95], v5 offset:256
  v_xor_b32 v4, 128, v3
  ds_read_b128 a[96:99], v4 offset:0
  ds_read_b128 a[100:103], v4 offset:256
  v_xor_b32 v5, 160, v3
  ds_read_b128 a[104:107], v5 offset:0
  ds_read_b128 a[108:111], v5 offset:256
  v_xor_b32 v4, 192, v3
  ds_read_b128 a[112:115], v4 offset:0
  ds_read_b128 a[116:119], v4 offset:256
  v_xor_b32 v5, 224, v3
  ds_read_b128 a[120:123], v5 offset:0
  ds_read_b128 a[124:127], v5 offset:256
  s_waitcnt lgkmcnt(15)
  v_mfma_f32_32x32x16_bf16 v[16:31], a[64:67], a[0:3], v[16:31]
  s_waitcnt lgkmcnt(14)
  v_mfma_f32_32x32x16_bf16 v[16:31], a[68:71], a[32:35], v[16:31]
  v_xor_b32 v5, 144, v1
  s_waitcnt vmcnt(4)
  buffer_load_dwordx4 v5, s[8:11], s45 offen offset:1024 nt lds
  s_waitcnt lgkmcnt(13)
  v_mfma_f32_32x32x16_bf16 v[16:31], a[72:75], a[4:7], v[16:31]
  s_waitcnt lgkmcnt(12)
  v_mfma_f32_32x32x16_bf16 v[16:31], a[76:79], a[36:39], v[16:31]
  s_waitcnt lgkmcnt(11)
  v_mfma_f32_32x32x16_bf16 v[16:31], a[80:83], a[8:11], v[16:31]
  v_xor_b32 v4, 160, v1
  s_waitcnt vmcnt(4)
  buffer_load_dwordx4 v4, s[8:11], s45 offen offset:2048 nt lds
  s_waitcnt lgkmcnt(10)
  v_mfma_f32_32x32x16_bf16 v[16:31], a[84:87], a[40:43], v[16:31]
  s_waitcnt lgkmcnt(9)
  v_mfma_f32_32x32x16_bf16 v[16:31], a[88:91], a[12:15], v[16:31]
  s_waitcnt lgkmcnt(8)
  v_mfma_f32_32x32x16_bf16 v[16:31], a[92:95], a[44:47], v[16:31]
  v_xor_b32 v5, 176, v1
  s_waitcnt vmcnt(4)
  buffer_load_dwordx4 v5, s[8:11], s45 offen offset:3072 nt lds
  s_waitcnt lgkmcnt(7)
  v_mfma_f32_32x32x16_bf16 v[16:31], a[96:99], a[16:19], v[16:31]
  s_waitcnt lgkmcnt(6)
  v_mfma_f32_32x32x16_bf16 v[16:31], a[100:103], a[48:51], v[16:31]
  s_waitcnt lgkmcnt(5)
  v_mfma_f32_32x32x16_bf16 v[16:31], a[104:107], a[20:23], v[16:31]
  s_add_u32 m0, s43, 24576
  s_nop 0
  s_waitcnt vmcnt(4)
  buffer_load_dwordx4 v1, s[8:11], s46 offen offset:0 nt lds
  s_waitcnt lgkmcnt(4)
  v_mfma_f32_32x32x16_bf16 v[16:31], a[108:111], a[52:55], v[16:31]
  s_waitcnt lgkmcnt(3)
  v_mfma_f32_32x32x16_bf16 v[16:31], a[112:115], a[24:27], v[16:31]
  s_waitcnt lgkmcnt(2)
  v_mfma_f32_32x32x16_bf16 v[16:31], a[116:119], a[56:59], v[16:31]
  v_xor_b32 v5, 16, v1
  s_waitcnt vmcnt(4)
  buffer_load_dwordx4 v5, s[8:11], s46 offen offset:1024 nt lds
  s_waitcnt lgkmcnt(1)
  v_mfma_f32_32x32x16_bf16 v[16:31], a[120:123], a[28:31], v[16:31]
  s_waitcnt lgkmcnt(0)
  v_mfma_f32_32x32x16_bf16 v[16:31], a[124:127], a[60:63], v[16:31]
  v_xor_b32 v4, 32, v1
  s_waitcnt vmcnt(5)
  s_cbranch_vccnz L_w26
  s_waitcnt vmcnt(4)
L_w26:
  buffer_load_dwordx4 v4, s[8:11], s46 offen offset:2048 nt lds
  s_nop 7
  s_nop 3
  v_max3_f32 v8, v16, v17, v18
  v_max3_f32 v8, v8, v19, v20
  v_max3_f32 v8, v8, v21, v22
  v_max3_f32 v8, v8, v23, v24
  v_max3_f32 v8, v8, v25, v26
  v_max3_f32 v8, v8, v27, v28
  v_max3_f32 v8, v8, v29, v30
  v_max_f32 v8, v8, v31
  v_mul_f32 v8, s40, v8
  v_mov_b32 v9, v8
  s_nop 1
  v_permlane32_swap_b32 v8, v9
  s_nop 1
  v_max3_f32 v8, v8, v9, v6
  v_sub_f32 v10, v6, v8
  v_exp_f32 v10, v10
  v_mov_b32 v6, v8
  v_mov_b32 v11, v10
  v_mul_f32 v7, v7, v10
  v_mov_b32 v52, v10
  v_xor_b32 v5, 48, v1
  s_waitcnt vmcnt(4)
  buffer_load_dwordx4 v5, s[8:11], s46 offen offset:3072 nt lds
  v_fma_f32 v16, v16, s40, -v6
  v_fma_f32 v17, v17, s40, -v6
  v_fma_f32 v18, v18, s40, -v6
  v_fma_f32 v19, v19, s40, -v6
  v_fma_f32 v20, v20, s40, -v6
  v_fma_f32 v21, v21, s40, -v6
  v_fma_f32 v22, v22, s40, -v6
  v_fma_f32 v23, v23, s40, -v6
  v_exp_f32 v16, v16
  v_exp_f32 v17, v17
  v_exp_f32 v18, v18
  v_exp_f32 v19, v19
  v_exp_f32 v20, v20
  v_exp_f32 v21, v21
  v_exp_f32 v22, v22
  v_exp_f32 v23, v23
  s_nop 0
  v_add_f32 v7, v7, v16
  v_add_f32 v7, v7, v17
  v_add_f32 v7, v7, v18
  v_add_f32 v7, v7, v19
  v_add_f32 v7, v7, v20
  v_add_f32 v7, v7, v21
  v_add_f32 v7, v7, v22
  v_add_f32 v7, v7, v23
  v_cvt_pk_bf16_f32 v32, v16, v17
  v_cvt_pk_bf16_f32 v33, v18, v19
  v_cvt_pk_bf16_f32 v34, v20, v21
  v_cvt_pk_bf16_f32 v35, v22, v23
  v_accvgpr_write_b32 a224, v32
  v_accvgpr_write_b32 a225, v33
  v_accvgpr_write_b32 a226, v34
  v_accvgpr_write_b32 a227, v35
  s_add_u32 m0, s43, 28672
  v_xor_b32 v4, 128, v1
  s_waitcnt vmcnt(4)
  buffer_load_dwordx4 v4, s[8:11], s47 offen offset:0 nt lds
  v_fma_f32 v24, v24, s40, -v6
  v_fma_f32 v25, v25, s40, -v6
  v_fma_f32 v26, v26, s40, -v6
  v_fma_f32 v27, v27, s40, -v6
  v_fma_f32 v28, v28, s40, -v6
  v_fma_f32 v29, v29, s40, -v6
  v_fma_f32 v30, v30, s40, -v6
  v_fma_f32 v31, v31, s40, -v6
  v_exp_f32 v24, v24
  v_exp_f32 v25, v25
  v_exp_f32 v26, v26
  v_exp_f32 v27, v27
  v_exp_f32 v28, v28
  v_exp_f32 v29, v29
  v_exp_f32 v30, v30
  v_exp_f32 v31, v31
  s_nop 0
  v_add_f32 v7, v7, v24
  v_add_f32 v7, v7, v25
  v_add_f32 v7, v7, v26
  v_add_f32 v7, v7, v27
  v_add_f32 v7, v7, v28
  v_add_f32 v7, v7, v29
  v_add_f32 v7, v7, v30
  v_add_f32 v7, v7, v31
  v_cvt_pk_bf16_f32 v36, v24, v25
  v_cvt_pk_bf16_f32 v37, v26, v27
  v_cvt_pk_bf16_f32 v38, v28, v29
  v_cvt_pk_bf16_f32 v39, v30, v31
  v_accvgpr_write_b32 a228, v36
  v_accvgpr_write_b32 a229, v37
  v_accvgpr_write_b32 a230, v38
  v_accvgpr_write_b32 a231, v39
  v_xor_b32 v5, 144, v1
  s_waitcnt vmcnt(4)
  buffer_load_dwordx4 v5, s[8:11], s47 offen offset:1024 nt lds
  v_xor_b32 v4, 160, v1
  s_waitcnt vmcnt(4)
  buffer_load_dwordx4 v4, s[8:11], s47 offen offset:2048 nt lds
  v_xor_b32 v5, 176, v1
  s_waitcnt vmcnt(4)
  buffer_load_dwordx4 v5, s[8:11], s47 offen offset:3072 nt lds
  s_add_u32 s44, s55, 917504
  s_add_u32 s45, s55, 933888
  s_add_u32 s46, s55, 950272
  s_add_u32 s47, s55, 966656
  v_mov_b32 v16, 0
  v_mov_b32 v17, 0
  v_mov_b32 v18, 0
  v_mov_b32 v19, 0
  v_mov_b32 v20, 0
  v_mov_b32 v21, 0
  v_mov_b32 v22, 0
  v_mov_b32 v23, 0
  v_mov_b32 v24, 0
  v_mov_b32 v25, 0
  v_mov_b32 v26, 0
  v_mov_b32 v27, 0
  v_mov_b32 v28, 0
  v_mov_b32 v29, 0
  v_mov_b32 v30, 0
  v_mov_b32 v31, 0
  s_add_u32 m0, s43, 0
  s_nop 0
  s_waitcnt vmcnt(4)
  buffer_load_dwordx4 v1, s[8:11], s44 offen offset:0 nt lds
  v_xor_b32 v5, 16, v1
  s_waitcnt vmcnt(4)
  buffer_load_dwordx4 v5, s[8:11], s44 offen offset:1024 nt lds
  v_xor_b32 v4, 32, v1
  s_waitcnt vmcnt(5)
  s_cbranch_vccnz L_w27
  s_waitcnt vmcnt(4)
L_w27:
  buffer_load_dwordx4 v4, s[8:11], s44 offen offset:2048 nt lds
  v_xor_b32 v5, 48, v1
  s_waitcnt vmcnt(4)
  buffer_load_dwordx4 v5, s[8:11], s44 offen offset:3072 nt lds
  s_add_u32 m0, s43, 4096
  v_xor_b32 v4, 128, v1
  s_waitcnt vmcnt(4)
  buffer_load_dwordx4 v4, s[8:11], s45 offen offset:0 nt lds
  ds_read_b128 a[64:67], v3 offset:16384
  ds_read_b128 a[68:71], v3 offset:16640
  v_xor_b32 v5, 32, v3
  ds_read_b128 a[72:75], v5 offset:16384
  ds_read_b128 a[76:79], v5 offset:16640
  v_xor_b32 v4, 64, v3
  ds_read_b128 a[80:83], v4 offset:16384
  ds_read_b128 a[84:87], v4 offset:16640
  v_xor_b32 v5, 96, v3
  ds_read_b128 a[88:91], v5 offset:16384
  ds_read_b128 a[92:95], v5 offset:16640
  v_xor_b32 v4, 128, v3
  ds_read_b128 a[96:99], v4 offset:16384
  ds_read_b128 a[100:103], v4 offset:16640
  v_xor_b32 v5, 160, v3
  ds_read_b128 a[104:107], v5 offset:16384
  ds_read_b128 a[108:111], v5 offset:16640
  v_xor_b32 v4, 192, v3
  ds_read_b128 a[112:115], v4 offset:16384
  ds_read_b128 a[116:119], v4 offset:16640
  v_xor_b32 v5, 224, v3
  ds_read_b128 a[120:123], v5 offset:16384
  ds_read_b128 a[124:127], v5 offset:16640
  s_waitcnt lgkmcnt(15)
  v_mfma_f32_32x32x16_bf16 v[16:31], a[64:67], a[0:3], v[16:31]
  s_waitcnt lgkmcnt(14)
  v_mfma_f32_32x32x16_bf16 v[16:31], a[68:71], a[32:35], v[16:31]
  v_xor_b32 v5, 144, v1
  s_waitcnt vmcnt(4)
  buffer_load_dwordx4 v5, s[8:11], s45 offen offset:1024 nt lds
  s_waitcnt lgkmcnt(13)
  v_mfma_f32_32x32x16_bf16 v[16:31], a[72:75], a[4:7], v[16:31]
  s_waitcnt lgkmcnt(12)
  v_mfma_f32_32x32x16_bf16 v[16:31], a[76:79], a[36:39], v[16:31]
  s_waitcnt lgkmcnt(11)
  v_mfma_f32_32x32x16_bf16 v[16:31], a[80:83], a[8:11], v[16:31]
  v_xor_b32 v4, 160, v1
  s_waitcnt vmcnt(4)
  buffer_load_dwordx4 v4, s[8:11], s45 offen offset:2048 nt lds
  s_waitcnt lgkmcnt(10)
  v_mfma_f32_32x32x16_bf16 v[16:31], a[84:87], a[40:43], v[16:31]
  s_waitcnt lgkmcnt(9)
  v_mfma_f32_32x32x16_bf16 v[16:31], a[88:91], a[12:15], v[16:31]
  s_waitcnt lgkmcnt(8)
  v_mfma_f32_32x32x16_bf16 v[16:31], a[92:95], a[44:47], v[16:31]
  v_xor_b32 v5, 176, v1
  s_waitcnt vmcnt(4)
  buffer_load_dwordx4 v5, s[8:11], s45 offen offset:3072 nt lds
  s_waitcnt lgkmcnt(7)
  v_mfma_f32_32x32x16_bf16 v[16:31], a[96:99], a[16:19], v[16:31]
  s_waitcnt lgkmcnt(6)
  v_mfma_f32_32x32x16_bf16 v[16:31], a[100:103], a[48:51], v[16:31]
  s_waitcnt lgkmcnt(5)
  v_mfma_f32_32x32x16_bf16 v[16:31], a[104:107], a[20:23], v[16:31]
  s_add_u32 m0, s43, 8192
  s_nop 0
  s_waitcnt vmcnt(4)
  buffer_load_dwordx4 v1, s[8:11], s46 offen offset:0 nt lds
  s_waitcnt lgkmcnt(4)
  v_mfma_f32_32x32x16_bf16 v[16:31], a[108:111], a[52:55], v[16:31]
  s_waitcnt lgkmcnt(3)
  v_mfma_f32_32x32x16_bf16 v[16:31], a[112:115], a[24:27], v[16:31]
  s_waitcnt lgkmcnt(2)
  v_mfma_f32_32x32x16_bf16 v[16:31], a[116:119], a[56:59], v[16:31]
  v_xor_b32 v5, 16, v1
  s_waitcnt vmcnt(4)
  buffer_load_dwordx4 v5, s[8:11], s46 offen offset:1024 nt lds
  s_waitcnt lgkmcnt(1)
  v_mfma_f32_32x32x16_bf16 v[16:31], a[120:123], a[28:31], v[16:31]
  s_waitcnt lgkmcnt(0)
  v_mfma_f32_32x32x16_bf16 v[16:31], a[124:127], a[60:63], v[16:31]
  v_xor_b32 v4, 32, v1
  s_waitcnt vmcnt(5)
  s_cbranch_vccnz L_w28
  s_waitcnt vmcnt(4)
L_w28:
  buffer_load_dwordx4 v4, s[8:11], s46 offen offset:2048 nt lds
  s_nop 7
  s_nop 3
  v_max3_f32 v8, v16, v17, v18
  v_max3_f32 v8, v8, v19, v20
  v_max3_f32 v8, v8, v21, v22
  v_max3_f32 v8, v8, v23, v24
  v_max3_f32 v8, v8, v25, v26
  v_max3_f32 v8, v8, v27, v28
  v_max3_f32 v8, v8, v29, v30
  v_max_f32 v8, v8, v31
  v_mul_f32 v8, s40, v8
  v_mov_b32 v9, v8
  s_nop 1
  v_permlane32_swap_b32 v8, v9
  s_nop 1
  v_max3_f32 v8, v8, v9, v6
  v_sub_f32 v10, v6, v8
  v_exp_f32 v10, v10
  v_mov_b32 v6, v8
  v_mov_b32 v11, v10
  v_mul_f32 v7, v7, v10
  v_mov_b32 v53, v10
  v_xor_b32 v5, 48, v1
  s_waitcnt vmcnt(4)
  buffer_load_dwordx4 v5, s[8:11], s46 offen offset:3072 nt lds
  v_fma_f32 v16, v16, s40, -v6
  v_fma_f32 v17, v17, s40, -v6
  v_fma_f32 v18, v18, s40, -v6
  v_fma_f32 v19, v19, s40, -v6
  v_fma_f32 v20, v20, s40, -v6
  v_fma_f32 v21, v21, s40, -v6
  v_fma_f32 v22, v22, s40, -v6
  v_fma_f32 v23, v23, s40, -v6
  v_exp_f32 v16, v16
  v_exp_f32 v17, v17
  v_exp_f32 v18, v18
  v_exp_f32 v19, v19
  v_exp_f32 v20, v20
  v_exp_f32 v21, v21
  v_exp_f32 v22, v22
  v_exp_f32 v23, v23
  s_nop 0
  v_add_f32 v7, v7, v16
  v_add_f32 v7, v7, v17
  v_add_f32 v7, v7, v18
  v_add_f32 v7, v7, v19
  v_add_f32 v7, v7, v20
  v_add_f32 v7, v7, v21
  v_add_f32 v7, v7, v22
  v_add_f32 v7, v7, v23
  v_cvt_pk_bf16_f32 v32, v16, v17
  v_cvt_pk_bf16_f32 v33, v18, v19
  v_cvt_pk_bf16_f32 v34, v20, v21
  v_cvt_pk_bf16_f32 v35, v22, v23
  v_accvgpr_write_b32 a232, v32
  v_accvgpr_write_b32 a233, v33
  v_accvgpr_write_b32 a234, v34
  v_accvgpr_write_b32 a235, v35
  s_add_u32 m0, s43, 12288
  v_xor_b32 v4, 128, v1
  s_waitcnt vmcnt(4)
  buffer_load_dwordx4 v4, s[8:11], s47 offen offset:0 nt lds
  v_fma_f32 v24, v24, s40, -v6
  v_fma_f32 v25, v25, s40, -v6
  v_fma_f32 v26, v26, s40, -v6
  v_fma_f32 v27, v27, s40, -v6
  v_fma_f32 v28, v28, s40, -v6
  v_fma_f32 v29, v29, s40, -v6
  v_fma_f32 v30, v30, s40, -v6
  v_fma_f32 v31, v31, s40, -v6
  v_exp_f32 v24, v24
  v_exp_f32 v25, v25
  v_exp_f32 v26, v26
  v_exp_f32 v27, v27
  v_exp_f32 v28, v28
  v_exp_f32 v29, v29
  v_exp_f32 v30, v30
  v_exp_f32 v31, v31
  s_nop 0
  v_add_f32 v7, v7, v24
  v_add_f32 v7, v7, v25
  v_add_f32 v7, v7, v26
  v_add_f32 v7, v7, v27
  v_add_f32 v7, v7, v28
  v_add_f32 v7, v7, v29
  v_add_f32 v7, v7, v30
  v_add_f32 v7, v7, v31
  v_cvt_pk_bf16_f32 v36, v24, v25
  v_cvt_pk_bf16_f32 v37, v26, v27
  v_cvt_pk_bf16_f32 v38, v28, v29
  v_cvt_pk_bf16_f32 v39, v30, v31
  v_accvgpr_write_b32 a236, v36
  v_accvgpr_write_b32 a237, v37
  v_accvgpr_write_b32 a238, v38
  v_accvgpr_write_b32 a239, v39
  v_xor_b32 v5, 144, v1
  s_waitcnt vmcnt(4)
  buffer_load_dwordx4 v5, s[8:11], s47 offen offset:1024 nt lds
  v_xor_b32 v4, 160, v1
  s_waitcnt vmcnt(4)
  buffer_load_dwordx4 v4, s[8:11], s47 offen offset:2048 nt lds
  v_xor_b32 v5, 176, v1
  s_waitcnt vmcnt(4)
  buffer_load_dwordx4 v5, s[8:11], s47 offen offset:3072 nt lds
  s_add_u32 s44, s55, 983040
  s_add_u32 s45, s55, 999424
  s_add_u32 s46, s55, 1015808
  s_add_u32 s47, s55, 1032192
  v_mov_b32 v16, 0
  v_mov_b32 v17, 0
  v_mov_b32 v18, 0
  v_mov_b32 v19, 0
  v_mov_b32 v20, 0
  v_mov_b32 v21, 0
  v_mov_b32 v22, 0
  v_mov_b32 v23, 0
  v_mov_b32 v24, 0
  v_mov_b32 v25, 0
  v_mov_b32 v26, 0
  v_mov_b32 v27, 0
  v_mov_b32 v28, 0
  v_mov_b32 v29, 0
  v_mov_b32 v30, 0
  v_mov_b32 v31, 0
  s_add_u32 m0, s43, 16384
  s_nop 0
  s_waitcnt vmcnt(4)
  buffer_load_dwordx4 v1, s[8:11], s44 offen offset:0 nt lds
  v_xor_b32 v5, 16, v1
  s_waitcnt vmcnt(4)
  buffer_load_dwordx4 v5, s[8:11], s44 offen offset:1024 nt lds
  v_xor_b32 v4, 32, v1
  s_waitcnt vmcnt(5)
  s_cbranch_vccnz L_w29
  s_waitcnt vmcnt(4)
L_w29:
  buffer_load_dwordx4 v4, s[8:11], s44 offen offset:2048 nt lds
  v_xor_b32 v5, 48, v1
  s_waitcnt vmcnt(4)
  buffer_load_dwordx4 v5, s[8:11], s44 offen offset:3072 nt lds
  s_add_u32 m0, s43, 20480
  v_xor_b32 v4, 128, v1
  s_waitcnt vmcnt(4)
  buffer_load_dwordx4 v4, s[8:11], s45 offen offset:0 nt lds
  ds_read_b128 a[64:67], v3 offset:0
  ds_read_b128 a[68:71], v3 offset:256
  v_xor_b32 v5, 32, v3
  ds_read_b128 a[72:75], v5 offset:0
  ds_read_b128 a[76:79], v5 offset:256
  v_xor_b32 v4, 64, v3
  ds_read_b128 a[80:83], v4 offset:0
  ds_read_b128 a[84:87], v4 offset:256
  v_xor_b32 v5, 96, v3
  ds_read_b128 a[88:91], v5 offset:0
  ds_read_b128 a[92:95], v5 offset:256
  v_xor_b32 v4, 128, v3
  ds_read_b128 a[96:99], v4 offset:0
  ds_read_b128 a[100:103], v4 offset:256
  v_xor_b32 v5, 160, v3
  ds_read_b128 a[104:107], v5 offset:0
  ds_read_b128 a[108:111], v5 offset:256
  v_xor_b32 v4, 192, v3
  ds_read_b128 a[112:115], v4 offset:0
  ds_read_b128 a[116:119], v4 offset:256
  v_xor_b32 v5, 224, v3
  ds_read_b128 a[120:123], v5 offset:0
  ds_read_b128 a[124:127], v5 offset:256
  s_waitcnt lgkmcnt(15)
  v_mfma_f32_32x32x16_bf16 v[16:31], a[64:67], a[0:3], v[16:31]
  s_waitcnt lgkmcnt(14)
  v_mfma_f32_32x32x16_bf16 v[16:31], a[68:71], a[32:35], v[16:31]
  v_xor_b32 v5, 144, v1
  s_waitcnt vmcnt(4)
  buffer_load_dwordx4 v5, s[8:11], s45 offen offset:1024 nt lds
  s_waitcnt lgkmcnt(13)
  v_mfma_f32_32x32x16_bf16 v[16:31], a[72:75], a[4:7], v[16:31]
  s_waitcnt lgkmcnt(12)
  v_mfma_f32_32x32x16_bf16 v[16:31], a[76:79], a[36:39], v[16:31]
  s_waitcnt lgkmcnt(11)
  v_mfma_f32_32x32x16_bf16 v[16:31], a[80:83], a[8:11], v[16:31]
  v_xor_b32 v4, 160, v1
  s_waitcnt vmcnt(4)
  buffer_load_dwordx4 v4, s[8:11], s45 offen offset:2048 nt lds
  s_waitcnt lgkmcnt(10)
  v_mfma_f32_32x32x16_bf16 v[16:31], a[84:87], a[40:43], v[16:31]
  s_waitcnt lgkmcnt(9)
  v_mfma_f32_32x32x16_bf16 v[16:31], a[88:91], a[12:15], v[16:31]
  s_waitcnt lgkmcnt(8)
  v_mfma_f32_32x32x16_bf16 v[16:31], a[92:95], a[44:47], v[16:31]
  v_xor_b32 v5, 176, v1
  s_waitcnt vmcnt(4)
  buffer_load_dwordx4 v5, s[8:11], s45 offen offset:3072 nt lds
  s_waitcnt lgkmcnt(7)
  v_mfma_f32_32x32x16_bf16 v[16:31], a[96:99], a[16:19], v[16:31]
  s_waitcnt lgkmcnt(6)
  v_mfma_f32_32x32x16_bf16 v[16:31], a[100:103], a[48:51], v[16:31]
  s_waitcnt lgkmcnt(5)
  v_mfma_f32_32x32x16_bf16 v[16:31], a[104:107], a[20:23], v[16:31]
  s_add_u32 m0, s43, 24576
  s_nop 0
  s_waitcnt vmcnt(4)
  buffer_load_dwordx4 v1, s[8:11], s46 offen offset:0 nt lds
  s_waitcnt lgkmcnt(4)
  v_mfma_f32_32x32x16_bf16 v[16:31], a[108:111], a[52:55], v[16:31]
  s_waitcnt lgkmcnt(3)
  v_mfma_f32_32x32x16_bf16 v[16:31], a[112:115], a[24:27], v[16:31]
  s_waitcnt lgkmcnt(2)
  v_mfma_f32_32x32x16_bf16 v[16:31], a[116:119], a[56:59], v[16:31]
  v_xor_b32 v5, 16, v1
  s_waitcnt vmcnt(4)
  buffer_load_dwordx4 v5, s[8:11], s46 offen offset:1024 nt lds
  s_waitcnt lgkmcnt(1)
  v_mfma_f32_32x32x16_bf16 v[16:31], a[120:123], a[28:31], v[16:31]
  s_waitcnt lgkmcnt(0)
  v_mfma_f32_32x32x16_bf16 v[16:31], a[124:127], a[60:63], v[16:31]
  v_xor_b32 v4, 32, v1
  s_waitcnt vmcnt(5)
  s_cbranch_vccnz L_w30
  s_waitcnt vmcnt(4)
L_w30:
  buffer_load_dwordx4 v4, s[8:11], s46 offen offset:2048 nt lds
  s_nop 7
  s_nop 3
  v_max3_f32 v8, v16, v17, v18
  v_max3_f32 v8, v8, v19, v20
  v_max3_f32 v8, v8, v21, v22
  v_max3_f32 v8, v8, v23, v24
  v_max3_f32 v8, v8, v25, v26
  v_max3_f32 v8, v8, v27, v28
  v_max3_f32 v8, v8, v29, v30
  v_max_f32 v8, v8, v31
  v_mul_f32 v8, s40, v8
  v_mov_b32 v9, v8
  s_nop 1
  v_permlane32_swap_b32 v8, v9
  s_nop 1
  v_max3_f32 v8, v8, v9, v6
  v_sub_f32 v10, v6, v8
  v_exp_f32 v10, v10
  v_mov_b32 v6, v8
  v_mov_b32 v11, v10
  v_mul_f32 v7, v7, v10
  v_mov_b32 v54, v10
  v_xor_b32 v5, 48, v1
  s_waitcnt vmcnt(4)
  buffer_load_dwordx4 v5, s[8:11], s46 offen offset:3072 nt lds
  v_fma_f32 v16, v16, s40, -v6
  v_fma_f32 v17, v17, s40, -v6
  v_fma_f32 v18, v18, s40, -v6
  v_fma_f32 v19, v19, s40, -v6
  v_fma_f32 v20, v20, s40, -v6
  v_fma_f32 v21, v21, s40, -v6
  v_fma_f32 v22, v22, s40, -v6
  v_fma_f32 v23, v23, s40, -v6
  v_exp_f32 v16, v16
  v_exp_f32 v17, v17
  v_exp_f32 v18, v18
  v_exp_f32 v19, v19
  v_exp_f32 v20, v20
  v_exp_f32 v21, v21
  v_exp_f32 v22, v22
  v_exp_f32 v23, v23
  s_nop 0
  v_add_f32 v7, v7, v16
  v_add_f32 v7, v7, v17
  v_add_f32 v7, v7, v18
  v_add_f32 v7, v7, v19
  v_add_f32 v7, v7, v20
  v_add_f32 v7, v7, v21
  v_add_f32 v7, v7, v22
  v_add_f32 v7, v7, v23
  v_cvt_pk_bf16_f32 v32, v16, v17
  v_cvt_pk_bf16_f32 v33, v18, v19
  v_cvt_pk_bf16_f32 v34, v20, v21
  v_cvt_pk_bf16_f32 v35, v22, v23
  v_accvgpr_write_b32 a240, v32
  v_accvgpr_write_b32 a241, v33
  v_accvgpr_write_b32 a242, v34
  v_accvgpr_write_b32 a243, v35
  s_add_u32 m0, s43, 28672
  v_xor_b32 v4, 128, v1
  s_waitcnt vmcnt(4)
  buffer_load_dwordx4 v4, s[8:11], s47 offen offset:0 nt lds
  v_fma_f32 v24, v24, s40, -v6
  v_fma_f32 v25, v25, s40, -v6
  v_fma_f32 v26, v26, s40, -v6
  v_fma_f32 v27, v27, s40, -v6
  v_fma_f32 v28, v28, s40, -v6
  v_fma_f32 v29, v29, s40, -v6
  v_fma_f32 v30, v30, s40, -v6
  v_fma_f32 v31, v31, s40, -v6
  v_exp_f32 v24, v24
  v_exp_f32 v25, v25
  v_exp_f32 v26, v26
  v_exp_f32 v27, v27
  v_exp_f32 v28, v28
  v_exp_f32 v29, v29
  v_exp_f32 v30, v30
  v_exp_f32 v31, v31
  s_nop 0
  v_add_f32 v7, v7, v24
  v_add_f32 v7, v7, v25
  v_add_f32 v7, v7, v26
  v_add_f32 v7, v7, v27
  v_add_f32 v7, v7, v28
  v_add_f32 v7, v7, v29
  v_add_f32 v7, v7, v30
  v_add_f32 v7, v7, v31
  v_cvt_pk_bf16_f32 v36, v24, v25
  v_cvt_pk_bf16_f32 v37, v26, v27
  v_cvt_pk_bf16_f32 v38, v28, v29
  v_cvt_pk_bf16_f32 v39, v30, v31
  v_accvgpr_write_b32 a244, v36
  v_accvgpr_write_b32 a245, v37
  v_accvgpr_write_b32 a246, v38
  v_accvgpr_write_b32 a247, v39
  v_xor_b32 v5, 144, v1
  s_waitcnt vmcnt(4)
  buffer_load_dwordx4 v5, s[8:11], s47 offen offset:1024 nt lds
  v_xor_b32 v4, 160, v1
  s_waitcnt vmcnt(4)
  buffer_load_dwordx4 v4, s[8:11], s47 offen offset:2048 nt lds
  v_xor_b32 v5, 176, v1
  s_waitcnt vmcnt(4)
  buffer_load_dwordx4 v5, s[8:11], s47 offen offset:3072 nt lds
  s_add_u32 s44, s55, 0
  s_add_u32 s45, s55, 16384
  s_add_u32 s46, s55, 32768
  s_add_u32 s47, s55, 49152
  v_mov_b32 v16, 0
  v_mov_b32 v17, 0
  v_mov_b32 v18, 0
  v_mov_b32 v19, 0
  v_mov_b32 v20, 0
  v_mov_b32 v21, 0
  v_mov_b32 v22, 0
  v_mov_b32 v23, 0
  v_mov_b32 v24, 0
  v_mov_b32 v25, 0
  v_mov_b32 v26, 0
  v_mov_b32 v27, 0
  v_mov_b32 v28, 0
  v_mov_b32 v29, 0
  v_mov_b32 v30, 0
  v_mov_b32 v31, 0
  s_waitcnt vmcnt(4)
  buffer_load_dwordx4 v[64:67], v2, s[12:15], s44 offen offset:0 nt
  s_waitcnt vmcnt(4)
  buffer_load_dwordx4 v[68:71], v2, s[12:15], s44 offen offset:1024 nt
  s_waitcnt vmcnt(5)
  s_cbranch_vccnz L_w31
  s_waitcnt vmcnt(4)
L_w31:
  buffer_load_dwordx4 v[72:75], v2, s[12:15], s44 offen offset:2048 nt
  s_waitcnt vmcnt(4)
  buffer_load_dwordx4 v[76:79], v2, s[12:15], s44 offen offset:3072 nt
  s_waitcnt vmcnt(4)
  buffer_load_dwordx4 v[80:83], v2, s[12:15], s45 offen offset:0 nt
  ds_read_b128 a[64:67], v3 offset:16384
  ds_read_b128 a[68:71], v3 offset:16640
  v_xor_b32 v5, 32, v3
  ds_read_b128 a[72:75], v5 offset:16384
  ds_read_b128 a[76:79], v5 offset:16640
  v_xor_b32 v4, 64, v3
  ds_read_b128 a[80:83], v4 offset:16384
  ds_read_b128 a[84:87], v4 offset:16640
  v_xor_b32 v5, 96, v3
  ds_read_b128 a[88:91], v5 offset:16384
  ds_read_b128 a[92:95], v5 offset:16640
  v_xor_b32 v4, 128, v3
  ds_read_b128 a[96:99], v4 offset:16384
  ds_read_b128 a[100:103], v4 offset:16640
  v_xor_b32 v5, 160, v3
  ds_read_b128 a[104:107], v5 offset:16384
  ds_read_b128 a[108:111], v5 offset:16640
  v_xor_b32 v4, 192, v3
  ds_read_b128 a[112:115], v4 offset:16384
  ds_read_b128 a[116:119], v4 offset:16640
  v_xor_b32 v5, 224, v3
  ds_read_b128 a[120:123], v5 offset:16384
  ds_read_b128 a[124:127], v5 offset:16640
  s_waitcnt lgkmcnt(15)
  v_mfma_f32_32x32x16_bf16 v[16:31], a[64:67], a[0:3], v[16:31]
  s_waitcnt lgkmcnt(14)
  v_mfma_f32_32x32x16_bf16 v[16:31], a[68:71], a[32:35], v[16:31]
  s_waitcnt lgkmcnt(13)
  v_mfma_f32_32x32x16_bf16 v[16:31], a[72:75], a[4:7], v[16:31]
  s_waitcnt lgkmcnt(12)
  v_mfma_f32_32x32x16_bf16 v[16:31], a[76:79], a[36:39], v[16:31]
  s_waitcnt lgkmcnt(11)
  v_mfma_f32_32x32x16_bf16 v[16:31], a[80:83], a[8:11], v[16:31]
  s_waitcnt vmcnt(4)
  buffer_load_dwordx4 v[84:87], v2, s[12:15], s45 offen offset:1024 nt
  s_waitcnt lgkmcnt(10)
  v_mfma_f32_32x32x16_bf16 v[16:31], a[84:87], a[40:43], v[16:31]
  s_waitcnt lgkmcnt(9)
  v_mfma_f32_32x32x16_bf16 v[16:31], a[88:91], a[12:15], v[16:31]
  s_waitcnt lgkmcnt(8)
  v_mfma_f32_32x32x16_bf16 v[16:31], a[92:95], a[44:47], v[16:31]
  s_waitcnt vmcnt(4)
  buffer_load_dwordx4 v[88:91], v2, s[12:15], s45 offen offset:2048 nt
  s_waitcnt lgkmcnt(7)
  v_mfma_f32_32x32x16_bf16 v[16:31], a[96:99], a[16:19], v[16:31]
  s_waitcnt lgkmcnt(6)
  v_mfma_f32_32x32x16_bf16 v[16:31], a[100:103], a[48:51], v[16:31]
  s_waitcnt lgkmcnt(5)
  v_mfma_f32_32x32x16_bf16 v[16:31], a[104:107], a[20:23], v[16:31]
  s_waitcnt vmcnt(4)
  buffer_load_dwordx4 v[92:95], v2, s[12:15], s45 offen offset:3072 nt
  s_waitcnt lgkmcnt(4)
  v_mfma_f32_32x32x16_bf16 v[16:31], a[108:111], a[52:55], v[16:31]
  s_waitcnt lgkmcnt(3)
  v_mfma_f32_32x32x16_bf16 v[16:31], a[112:115], a[24:27], v[16:31]
  s_waitcnt lgkmcnt(2)
  v_mfma_f32_32x32x16_bf16 v[16:31], a[116:119], a[56:59], v[16:31]
  s_waitcnt vmcnt(4)
  buffer_load_dwordx4 v[96:99], v2, s[12:15], s46 offen offset:0 nt
  s_waitcnt lgkmcnt(1)
  v_mfma_f32_32x32x16_bf16 v[16:31], a[120:123], a[28:31], v[16:31]
  s_waitcnt lgkmcnt(0)
  v_mfma_f32_32x32x16_bf16 v[16:31], a[124:127], a[60:63], v[16:31]
  s_waitcnt vmcnt(4)
  buffer_load_dwordx4 v[100:103], v2, s[12:15], s46 offen offset:1024 nt
  s_nop 7
  s_nop 3
  v_max3_f32 v8, v16, v17, v18
  v_max3_f32 v8, v8, v19, v20
  v_max3_f32 v8, v8, v21, v22
  v_max3_f32 v8, v8, v23, v24
  v_max3_f32 v8, v8, v25, v26
  v_max3_f32 v8, v8, v27, v28
  v_max3_f32 v8, v8, v29, v30
  v_max_f32 v8, v8, v31
  v_mul_f32 v8, s40, v8
  v_mov_b32 v9, v8
  s_nop 1
  v_permlane32_swap_b32 v8, v9
  s_nop 1
  v_max3_f32 v8, v8, v9, v6
  v_sub_f32 v10, v6, v8
  v_exp_f32 v10, v10
  v_mov_b32 v6, v8
  v_mov_b32 v11, v10
  v_mul_f32 v7, v7, v10
  v_mov_b32 v55, v10
  s_waitcnt vmcnt(5)
  s_cbranch_vccnz L_w32
  s_waitcnt vmcnt(4)
L_w32:
  buffer_load_dwordx4 v[104:107], v2, s[12:15], s46 offen offset:2048 nt
  v_fma_f32 v16, v16, s40, -v6
  v_fma_f32 v17, v17, s40, -v6
  v_fma_f32 v18, v18, s40, -v6
  v_fma_f32 v19, v19, s40, -v6
  v_fma_f32 v20, v20, s40, -v6
  v_fma_f32 v21, v21, s40, -v6
  v_fma_f32 v22, v22, s40, -v6
  v_fma_f32 v23, v23, s40, -v6
  v_exp_f32 v16, v16
  v_exp_f32 v17, v17
  v_exp_f32 v18, v18
  v_exp_f32 v19, v19
  v_exp_f32 v20, v20
  v_exp_f32 v21, v21
  v_exp_f32 v22, v22
  v_exp_f32 v23, v23
  s_nop 0
  v_add_f32 v7, v7, v16
  v_add_f32 v7, v7, v17
  v_add_f32 v7, v7, v18
  v_add_f32 v7, v7, v19
  v_add_f32 v7, v7, v20
  v_add_f32 v7, v7, v21
  v_add_f32 v7, v7, v22
  v_add_f32 v7, v7, v23
  v_cvt_pk_bf16_f32 v32, v16, v17
  v_cvt_pk_bf16_f32 v33, v18, v19
  v_cvt_pk_bf16_f32 v34, v20, v21
  v_cvt_pk_bf16_f32 v35, v22, v23
  v_accvgpr_write_b32 a248, v32
  v_accvgpr_write_b32 a249, v33
  v_accvgpr_write_b32 a250, v34
  v_accvgpr_write_b32 a251, v35
  s_waitcnt vmcnt(4)
  buffer_load_dwordx4 v[108:111], v2, s[12:15], s46 offen offset:3072 nt
  v_fma_f32 v24, v24, s40, -v6
  v_fma_f32 v25, v25, s40, -v6
  v_fma_f32 v26, v26, s40, -v6
  v_fma_f32 v27, v27, s40, -v6
  v_fma_f32 v28, v28, s40, -v6
  v_fma_f32 v29, v29, s40, -v6
  v_fma_f32 v30, v30, s40, -v6
  v_fma_f32 v31, v31, s40, -v6
  v_exp_f32 v24, v24
  v_exp_f32 v25, v25
  v_exp_f32 v26, v26
  v_exp_f32 v27, v27
  v_exp_f32 v28, v28
  v_exp_f32 v29, v29
  v_exp_f32 v30, v30
  v_exp_f32 v31, v31
  s_nop 0
  v_add_f32 v7, v7, v24
  v_add_f32 v7, v7, v25
  v_add_f32 v7, v7, v26
  v_add_f32 v7, v7, v27
  v_add_f32 v7, v7, v28
  v_add_f32 v7, v7, v29
  v_add_f32 v7, v7, v30
  v_add_f32 v7, v7, v31
  v_cvt_pk_bf16_f32 v36, v24, v25
  v_cvt_pk_bf16_f32 v37, v26, v27
  v_cvt_pk_bf16_f32 v38, v28, v29
  v_cvt_pk_bf16_f32 v39, v30, v31
  v_accvgpr_write_b32 a252, v36
  v_accvgpr_write_b32 a253, v37
  v_accvgpr_write_b32 a254, v38
  v_accvgpr_write_b32 a255, v39
  s_waitcnt vmcnt(4)
  buffer_load_dwordx4 v[112:115], v2, s[12:15], s47 offen offset:0 nt
  v_mov_b32 v16, v40
  v_mov_b32 v17, v41
  v_mov_b32 v18, v42
  v_mov_b32 v19, v43
  v_mov_b32 v20, v44
  v_mov_b32 v21, v45
  v_mov_b32 v22, v46
  v_mov_b32 v23, v47
  v_mov_b32 v24, v48
  v_mov_b32 v25, v49
  v_mov_b32 v26, v50
  v_mov_b32 v27, v51
  v_mov_b32 v28, v52
  v_mov_b32 v29, v53
  v_mov_b32 v30, v54
  v_mov_b32 v31, v55
  v_perm_b32 v40, v68, v64, s41
  v_perm_b32 v41, v76, v72, s41
  v_perm_b32 v42, v84, v80, s41
  v_perm_b32 v43, v92, v88, s41
  v_pk_mul_f32 v[128:129], v[128:129], v[16:17] op_sel_hi:[1,0]
  v_pk_mul_f32 v[130:131], v[130:131], v[16:17] op_sel_hi:[1,0]
  v_pk_mul_f32 v[132:133], v[132:133], v[16:17] op_sel_hi:[1,0]
  v_pk_mul_f32 v[134:135], v[134:135], v[16:17] op_sel_hi:[1,0]
  v_pk_mul_f32 v[136:137], v[136:137], v[16:17] op_sel_hi:[1,0]
  v_pk_mul_f32 v[138:139], v[138:139], v[16:17] op_sel_hi:[1,0]
  v_pk_mul_f32 v[140:141], v[140:141], v[16:17] op_sel_hi:[1,0]
  v_pk_mul_f32 v[142:143], v[142:143], v[16:17] op_sel_hi:[1,0]
  s_nop 1
  v_mfma_f32_32x32x16_bf16 v[128:143], v[40:43], a[128:131], v[128:143]
  v_perm_b32 v44, v68, v64, s42
  v_perm_b32 v45, v76, v72, s42
  v_perm_b32 v46, v84, v80, s42
  v_perm_b32 v47, v92, v88, s42
  v_pk_mul_f32 v[144:145], v[144:145], v[16:17] op_sel_hi:[1,0]
  v_pk_mul_f32 v[146:147], v[146:147], v[16:17] op_sel_hi:[1,0]
  v_pk_mul_f32 v[148:149], v[148:149], v[16:17] op_sel_hi:[1,0]
  v_pk_mul_f32 v[150:151], v[150:151], v[16:17] op_sel_hi:[1,0]
  v_pk_mul_f32 v[152:153], v[152:153], v[16:17] op_sel_hi:[1,0]
  v_pk_mul_f32 v[154:155], v[154:155], v[16:17] op_sel_hi:[1,0]
  v_pk_mul_f32 v[156:157], v[156:157], v[16:17] op_sel_hi:[1,0]
  v_pk_mul_f32 v[158:159], v[158:159], v[16:17] op_sel_hi:[1,0]
  s_nop 1
  v_mfma_f32_32x32x16_bf16 v[144:159], v[44:47], a[128:131], v[144:159]
  s_waitcnt vmcnt(4)
  buffer_load_dwordx4 v[116:119], v2, s[12:15], s47 offen offset:1024 nt
  v_perm_b32 v48, v69, v65, s41
  v_perm_b32 v49, v77, v73, s41
  v_perm_b32 v50, v85, v81, s41
  v_perm_b32 v51, v93, v89, s41
  v_pk_mul_f32 v[160:161], v[160:161], v[16:17] op_sel_hi:[1,0]
  v_pk_mul_f32 v[162:163], v[162:163], v[16:17] op_sel_hi:[1,0]
  v_pk_mul_f32 v[164:165], v[164:165], v[16:17] op_sel_hi:[1,0]
  v_pk_mul_f32 v[166:167], v[166:167], v[16:17] op_sel_hi:[1,0]
  v_pk_mul_f32 v[168:169], v[168:169], v[16:17] op_sel_hi:[1,0]
  v_pk_mul_f32 v[170:171], v[170:171], v[16:17] op_sel_hi:[1,0]
  v_pk_mul_f32 v[172:173], v[172:173], v[16:17] op_sel_hi:[1,0]
  v_pk_mul_f32 v[174:175], v[174:175], v[16:17] op_sel_hi:[1,0]
  s_nop 1
  v_mfma_f32_32x32x16_bf16 v[160:175], v[48:51], a[128:131], v[160:175]
  v_perm_b32 v52, v69, v65, s42
  v_perm_b32 v53, v77, v73, s42
  v_perm_b32 v54, v85, v81, s42
  v_perm_b32 v55, v93, v89, s42
  v_pk_mul_f32 v[176:177], v[176:177], v[16:17] op_sel_hi:[1,0]
  v_pk_mul_f32 v[178:179], v[178:179], v[16:17] op_sel_hi:[1,0]
  v_pk_mul_f32 v[180:181], v[180:181], v[16:17] op_sel_hi:[1,0]
  v_pk_mul_f32 v[182:183], v[182:183], v[16:17] op_sel_hi:[1,0]
  v_pk_mul_f32 v[184:185], v[184:185], v[16:17] op_sel_hi:[1,0]
  v_pk_mul_f32 v[186:187], v[186:187], v[16:17] op_sel_hi:[1,0]
  v_pk_mul_f32 v[188:189], v[188:189], v[16:17] op_sel_hi:[1,0]
  v_pk_mul_f32 v[190:191], v[190:191], v[16:17] op_sel_hi:[1,0]
  s_nop 1
  v_mfma_f32_32x32x16_bf16 v[176:191], v[52:55], a[128:131], v[176:191]
  s_waitcnt vmcnt(4)
  buffer_load_dwordx4 v[120:123], v2, s[12:15], s47 offen offset:2048 nt
  v_perm_b32 v40, v70, v66, s41
  v_perm_b32 v41, v78, v74, s41
  v_perm_b32 v42, v86, v82, s41
  v_perm_b32 v43, v94, v90, s41
  v_pk_mul_f32 v[192:193], v[192:193], v[16:17] op_sel_hi:[1,0]
  v_pk_mul_f32 v[194:195], v[194:195], v[16:17] op_sel_hi:[1,0]
  v_pk_mul_f32 v[196:197], v[196:197], v[16:17] op_sel_hi:[1,0]
  v_pk_mul_f32 v[198:199], v[198:199], v[16:17] op_sel_hi:[1,0]
  v_pk_mul_f32 v[200:201], v[200:201], v[16:17] op_sel_hi:[1,0]
  v_pk_mul_f32 v[202:203], v[202:203], v[16:17] op_sel_hi:[1,0]
  v_pk_mul_f32 v[204:205], v[204:205], v[16:17] op_sel_hi:[1,0]
  v_pk_mul_f32 v[206:207], v[206:207], v[16:17] op_sel_hi:[1,0]
  s_nop 1
  v_mfma_f32_32x32x16_bf16 v[192:207], v[40:43], a[128:131], v[192:207]
  v_perm_b32 v44, v70, v66, s42
  v_perm_b32 v45, v78, v74, s42
  v_perm_b32 v46, v86, v82, s42
  v_perm_b32 v47, v94, v90, s42
  v_pk_mul_f32 v[208:209], v[208:209], v[16:17] op_sel_hi:[1,0]
  v_pk_mul_f32 v[210:211], v[210:211], v[16:17] op_sel_hi:[1,0]
  v_pk_mul_f32 v[212:213], v[212:213], v[16:17] op_sel_hi:[1,0]
  v_pk_mul_f32 v[214:215], v[214:215], v[16:17] op_sel_hi:[1,0]
  v_pk_mul_f32 v[216:217], v[216:217], v[16:17] op_sel_hi:[1,0]
  v_pk_mul_f32 v[218:219], v[218:219], v[16:17] op_sel_hi:[1,0]
  v_pk_mul_f32 v[220:221], v[220:221], v[16:17] op_sel_hi:[1,0]
  v_pk_mul_f32 v[222:223], v[222:223], v[16:17] op_sel_hi:[1,0]
  s_nop 1
  v_mfma_f32_32x32x16_bf16 v[208:223], v[44:47], a[128:131], v[208:223]
  s_waitcnt vmcnt(4)
  buffer_load_dwordx4 v[124:127], v2, s[12:15], s47 offen offset:3072 nt
  v_perm_b32 v48, v71, v67, s41
  v_perm_b32 v49, v79, v75, s41
  v_perm_b32 v50, v87, v83, s41
  v_perm_b32 v51, v95, v91, s41
  v_pk_mul_f32 v[224:225], v[224:225], v[16:17] op_sel_hi:[1,0]
  v_pk_mul_f32 v[226:227], v[226:227], v[16:17] op_sel_hi:[1,0]
  v_pk_mul_f32 v[228:229], v[228:229], v[16:17] op_sel_hi:[1,0]
  v_pk_mul_f32 v[230:231], v[230:231], v[16:17] op_sel_hi:[1,0]
  v_pk_mul_f32 v[232:233], v[232:233], v[16:17] op_sel_hi:[1,0]
  v_pk_mul_f32 v[234:235], v[234:235], v[16:17] op_sel_hi:[1,0]
  v_pk_mul_f32 v[236:237], v[236:237], v[16:17] op_sel_hi:[1,0]
  v_pk_mul_f32 v[238:239], v[238:239], v[16:17] op_sel_hi:[1,0]
  s_nop 1
  v_mfma_f32_32x32x16_bf16 v[224:239], v[48:51], a[128:131], v[224:239]
  v_perm_b32 v52, v71, v67, s42
  v_perm_b32 v53, v79, v75, s42
  v_perm_b32 v54, v87, v83, s42
  v_perm_b32 v55, v95, v91, s42
  v_pk_mul_f32 v[240:241], v[240:241], v[16:17] op_sel_hi:[1,0]
  v_pk_mul_f32 v[242:243], v[242:243], v[16:17] op_sel_hi:[1,0]
  v_pk_mul_f32 v[244:245], v[244:245], v[16:17] op_sel_hi:[1,0]
  v_pk_mul_f32 v[246:247], v[246:247], v[16:17] op_sel_hi:[1,0]
  v_pk_mul_f32 v[248:249], v[248:249], v[16:17] op_sel_hi:[1,0]
  v_pk_mul_f32 v[250:251], v[250:251], v[16:17] op_sel_hi:[1,0]
  v_pk_mul_f32 v[252:253], v[252:253], v[16:17] op_sel_hi:[1,0]
  v_pk_mul_f32 v[254:255], v[254:255], v[16:17] op_sel_hi:[1,0]
  s_nop 1
  v_mfma_f32_32x32x16_bf16 v[240:255], v[52:55], a[128:131], v[240:255]
  s_add_u32 s44, s55, 65536
  s_add_u32 s45, s55, 81920
  s_add_u32 s46, s55, 98304
  s_add_u32 s47, s55, 114688
  s_waitcnt vmcnt(4)
  buffer_load_dwordx4 v[64:67], v2, s[12:15], s44 offen offset:0 nt
  s_waitcnt vmcnt(4)
  buffer_load_dwordx4 v[68:71], v2, s[12:15], s44 offen offset:1024 nt
  s_waitcnt vmcnt(5)
  s_cbranch_vccnz L_w33
  s_waitcnt vmcnt(4)
L_w33:
  buffer_load_dwordx4 v[72:75], v2, s[12:15], s44 offen offset:2048 nt
  s_waitcnt vmcnt(4)
  buffer_load_dwordx4 v[76:79], v2, s[12:15], s44 offen offset:3072 nt
  s_waitcnt vmcnt(4)
  buffer_load_dwordx4 v[80:83], v2, s[12:15], s45 offen offset:0 nt
  v_perm_b32 v40, v100, v96, s41
  v_perm_b32 v41, v108, v104, s41
  v_perm_b32 v42, v116, v112, s41
  v_perm_b32 v43, v124, v120, s41
  s_nop 1
  v_mfma_f32_32x32x16_bf16 v[128:143], v[40:43], a[132:135], v[128:143]
  v_perm_b32 v44, v100, v96, s42
  v_perm_b32 v45, v108, v104, s42
  v_perm_b32 v46, v116, v112, s42
  v_perm_b32 v47, v124, v120, s42
  s_nop 1
  v_mfma_f32_32x32x16_bf16 v[144:159], v[44:47], a[132:135], v[144:159]
  s_waitcnt vmcnt(4)
  buffer_load_dwordx4 v[84:87], v2, s[12:15], s45 offen offset:1024 nt
  v_perm_b32 v48, v101, v97, s41
  v_perm_b32 v49, v109, v105, s41
  v_perm_b32 v50, v117, v113, s41
  v_perm_b32 v51, v125, v121, s41
  s_nop 1
  v_mfma_f32_32x32x16_bf16 v[160:175], v[48:51], a[132:135], v[160:175]
  v_perm_b32 v52, v101, v97, s42
  v_perm_b32 v53, v109, v105, s42
  v_perm_b32 v54, v117, v113, s42
  v_perm_b32 v55, v125, v121, s42
  s_nop 1
  v_mfma_f32_32x32x16_bf16 v[176:191], v[52:55], a[132:135], v[176:191]
  s_waitcnt vmcnt(4)
  buffer_load_dwordx4 v[88:91], v2, s[12:15], s45 offen offset:2048 nt
  v_perm_b32 v40, v102, v98, s41
  v_perm_b32 v41, v110, v106, s41
  v_perm_b32 v42, v118, v114, s41
  v_perm_b32 v43, v126, v122, s41
  s_nop 1
  v_mfma_f32_32x32x16_bf16 v[192:207], v[40:43], a[132:135], v[192:207]
  v_perm_b32 v44, v102, v98, s42
  v_perm_b32 v45, v110, v106, s42
  v_perm_b32 v46, v118, v114, s42
  v_perm_b32 v47, v126, v122, s42
  s_nop 1
  v_mfma_f32_32x32x16_bf16 v[208:223], v[44:47], a[132:135], v[208:223]
  s_waitcnt vmcnt(4)
  buffer_load_dwordx4 v[92:95], v2, s[12:15], s45 offen offset:3072 nt
  v_perm_b32 v48, v103, v99, s41
  v_perm_b32 v49, v111, v107, s41
  v_perm_b32 v50, v119, v115, s41
  v_perm_b32 v51, v127, v123, s41
  s_nop 1
  v_mfma_f32_32x32x16_bf16 v[224:239], v[48:51], a[132:135], v[224:239]
  v_perm_b32 v52, v103, v99, s42
  v_perm_b32 v53, v111, v107, s42
  v_perm_b32 v54, v119, v115, s42
  v_perm_b32 v55, v127, v123, s42
  s_nop 1
  v_mfma_f32_32x32x16_bf16 v[240:255], v[52:55], a[132:135], v[240:255]
  s_waitcnt vmcnt(4)
  buffer_load_dwordx4 v[96:99], v2, s[12:15], s46 offen offset:0 nt
  s_waitcnt vmcnt(4)
  buffer_load_dwordx4 v[100:103], v2, s[12:15], s46 offen offset:1024 nt
  s_waitcnt vmcnt(5)
  s_cbranch_vccnz L_w34
  s_waitcnt vmcnt(4)
L_w34:
  buffer_load_dwordx4 v[104:107], v2, s[12:15], s46 offen offset:2048 nt
  s_waitcnt vmcnt(4)
  buffer_load_dwordx4 v[108:111], v2, s[12:15], s46 offen offset:3072 nt
  s_waitcnt vmcnt(4)
  buffer_load_dwordx4 v[112:115], v2, s[12:15], s47 offen offset:0 nt
  v_perm_b32 v40, v68, v64, s41
  v_perm_b32 v41, v76, v72, s41
  v_perm_b32 v42, v84, v80, s41
  v_perm_b32 v43, v92, v88, s41
  v_pk_mul_f32 v[128:129], v[128:129], v[16:17] op_sel:[0,1] op_sel_hi:[1,1]
  v_pk_mul_f32 v[130:131], v[130:131], v[16:17] op_sel:[0,1] op_sel_hi:[1,1]
  v_pk_mul_f32 v[132:133], v[132:133], v[16:17] op_sel:[0,1] op_sel_hi:[1,1]
  v_pk_mul_f32 v[134:135], v[134:135], v[16:17] op_sel:[0,1] op_sel_hi:[1,1]
  v_pk_mul_f32 v[136:137], v[136:137], v[16:17] op_sel:[0,1] op_sel_hi:[1,1]
  v_pk_mul_f32 v[138:139], v[138:139], v[16:17] op_sel:[0,1] op_sel_hi:[1,1]
  v_pk_mul_f32 v[140:141], v[140:141], v[16:17] op_sel:[0,1] op_sel_hi:[1,1]
  v_pk_mul_f32 v[142:143], v[142:143], v[16:17] op_sel:[0,1] op_sel_hi:[1,1]
  s_nop 1
  v_mfma_f32_32x32x16_bf16 v[128:143], v[40:43], a[136:139], v[128:143]
  v_perm_b32 v44, v68, v64, s42
  v_perm_b32 v45, v76, v72, s42
  v_perm_b32 v46, v84, v80, s42
  v_perm_b32 v47, v92, v88, s42
  v_pk_mul_f32 v[144:145], v[144:145], v[16:17] op_sel:[0,1] op_sel_hi:[1,1]
  v_pk_mul_f32 v[146:147], v[146:147], v[16:17] op_sel:[0,1] op_sel_hi:[1,1]
  v_pk_mul_f32 v[148:149], v[148:149], v[16:17] op_sel:[0,1] op_sel_hi:[1,1]
  v_pk_mul_f32 v[150:151], v[150:151], v[16:17] op_sel:[0,1] op_sel_hi:[1,1]
  v_pk_mul_f32 v[152:153], v[152:153], v[16:17] op_sel:[0,1] op_sel_hi:[1,1]
  v_pk_mul_f32 v[154:155], v[154:155], v[16:17] op_sel:[0,1] op_sel_hi:[1,1]
  v_pk_mul_f32 v[156:157], v[156:157], v[16:17] op_sel:[0,1] op_sel_hi:[1,1]
  v_pk_mul_f32 v[158:159], v[158:159], v[16:17] op_sel:[0,1] op_sel_hi:[1,1]
  s_nop 1
  v_mfma_f32_32x32x16_bf16 v[144:159], v[44:47], a[136:139], v[144:159]
  s_waitcnt vmcnt(4)
  buffer_load_dwordx4 v[116:119], v2, s[12:15], s47 offen offset:1024 nt
  v_perm_b32 v48, v69, v65, s41
  v_perm_b32 v49, v77, v73, s41
  v_perm_b32 v50, v85, v81, s41
  v_perm_b32 v51, v93, v89, s41
  v_pk_mul_f32 v[160:161], v[160:161], v[16:17] op_sel:[0,1] op_sel_hi:[1,1]
  v_pk_mul_f32 v[162:163], v[162:163], v[16:17] op_sel:[0,1] op_sel_hi:[1,1]
  v_pk_mul_f32 v[164:165], v[164:165], v[16:17] op_sel:[0,1] op_sel_hi:[1,1]
  v_pk_mul_f32 v[166:167], v[166:167], v[16:17] op_sel:[0,1] op_sel_hi:[1,1]
  v_pk_mul_f32 v[168:169], v[168:169], v[16:17] op_sel:[0,1] op_sel_hi:[1,1]
  v_pk_mul_f32 v[170:171], v[170:171], v[16:17] op_sel:[0,1] op_sel_hi:[1,1]
  v_pk_mul_f32 v[172:173], v[172:173], v[16:17] op_sel:[0,1] op_sel_hi:[1,1]
  v_pk_mul_f32 v[174:175], v[174:175], v[16:17] op_sel:[0,1] op_sel_hi:[1,1]
  s_nop 1
  v_mfma_f32_32x32x16_bf16 v[160:175], v[48:51], a[136:139], v[160:175]
  v_perm_b32 v52, v69, v65, s42
  v_perm_b32 v53, v77, v73, s42
  v_perm_b32 v54, v85, v81, s42
  v_perm_b32 v55, v93, v89, s42
  v_pk_mul_f32 v[176:177], v[176:177], v[16:17] op_sel:[0,1] op_sel_hi:[1,1]
  v_pk_mul_f32 v[178:179], v[178:179], v[16:17] op_sel:[0,1] op_sel_hi:[1,1]
  v_pk_mul_f32 v[180:181], v[180:181], v[16:17] op_sel:[0,1] op_sel_hi:[1,1]
  v_pk_mul_f32 v[182:183], v[182:183], v[16:17] op_sel:[0,1] op_sel_hi:[1,1]
  v_pk_mul_f32 v[184:185], v[184:185], v[16:17] op_sel:[0,1] op_sel_hi:[1,1]
  v_pk_mul_f32 v[186:187], v[186:187], v[16:17] op_sel:[0,1] op_sel_hi:[1,1]
  v_pk_mul_f32 v[188:189], v[188:189], v[16:17] op_sel:[0,1] op_sel_hi:[1,1]
  v_pk_mul_f32 v[190:191], v[190:191], v[16:17] op_sel:[0,1] op_sel_hi:[1,1]
  s_nop 1
  v_mfma_f32_32x32x16_bf16 v[176:191], v[52:55], a[136:139], v[176:191]
  s_waitcnt vmcnt(4)
  buffer_load_dwordx4 v[120:123], v2, s[12:15], s47 offen offset:2048 nt
  v_perm_b32 v40, v70, v66, s41
  v_perm_b32 v41, v78, v74, s41
  v_perm_b32 v42, v86, v82, s41
  v_perm_b32 v43, v94, v90, s41
  v_pk_mul_f32 v[192:193], v[192:193], v[16:17] op_sel:[0,1] op_sel_hi:[1,1]
  v_pk_mul_f32 v[194:195], v[194:195], v[16:17] op_sel:[0,1] op_sel_hi:[1,1]
  v_pk_mul_f32 v[196:197], v[196:197], v[16:17] op_sel:[0,1] op_sel_hi:[1,1]
  v_pk_mul_f32 v[198:199], v[198:199], v[16:17] op_sel:[0,1] op_sel_hi:[1,1]
  v_pk_mul_f32 v[200:201], v[200:201], v[16:17] op_sel:[0,1] op_sel_hi:[1,1]
  v_pk_mul_f32 v[202:203], v[202:203], v[16:17] op_sel:[0,1] op_sel_hi:[1,1]
  v_pk_mul_f32 v[204:205], v[204:205], v[16:17] op_sel:[0,1] op_sel_hi:[1,1]
  v_pk_mul_f32 v[206:207], v[206:207], v[16:17] op_sel:[0,1] op_sel_hi:[1,1]
  s_nop 1
  v_mfma_f32_32x32x16_bf16 v[192:207], v[40:43], a[136:139], v[192:207]
  v_perm_b32 v44, v70, v66, s42
  v_perm_b32 v45, v78, v74, s42
  v_perm_b32 v46, v86, v82, s42
  v_perm_b32 v47, v94, v90, s42
  v_pk_mul_f32 v[208:209], v[208:209], v[16:17] op_sel:[0,1] op_sel_hi:[1,1]
  v_pk_mul_f32 v[210:211], v[210:211], v[16:17] op_sel:[0,1] op_sel_hi:[1,1]
  v_pk_mul_f32 v[212:213], v[212:213], v[16:17] op_sel:[0,1] op_sel_hi:[1,1]
  v_pk_mul_f32 v[214:215], v[214:215], v[16:17] op_sel:[0,1] op_sel_hi:[1,1]
  v_pk_mul_f32 v[216:217], v[216:217], v[16:17] op_sel:[0,1] op_sel_hi:[1,1]
  v_pk_mul_f32 v[218:219], v[218:219], v[16:17] op_sel:[0,1] op_sel_hi:[1,1]
  v_pk_mul_f32 v[220:221], v[220:221], v[16:17] op_sel:[0,1] op_sel_hi:[1,1]
  v_pk_mul_f32 v[222:223], v[222:223], v[16:17] op_sel:[0,1] op_sel_hi:[1,1]
  s_nop 1
  v_mfma_f32_32x32x16_bf16 v[208:223], v[44:47], a[136:139], v[208:223]
  s_waitcnt vmcnt(4)
  buffer_load_dwordx4 v[124:127], v2, s[12:15], s47 offen offset:3072 nt
  v_perm_b32 v48, v71, v67, s41
  v_perm_b32 v49, v79, v75, s41
  v_perm_b32 v50, v87, v83, s41
  v_perm_b32 v51, v95, v91, s41
  v_pk_mul_f32 v[224:225], v[224:225], v[16:17] op_sel:[0,1] op_sel_hi:[1,1]
  v_pk_mul_f32 v[226:227], v[226:227], v[16:17] op_sel:[0,1] op_sel_hi:[1,1]
  v_pk_mul_f32 v[228:229], v[228:229], v[16:17] op_sel:[0,1] op_sel_hi:[1,1]
  v_pk_mul_f32 v[230:231], v[230:231], v[16:17] op_sel:[0,1] op_sel_hi:[1,1]
  v_pk_mul_f32 v[232:233], v[232:233], v[16:17] op_sel:[0,1] op_sel_hi:[1,1]
  v_pk_mul_f32 v[234:235], v[234:235], v[16:17] op_sel:[0,1] op_sel_hi:[1,1]
  v_pk_mul_f32 v[236:237], v[236:237], v[16:17] op_sel:[0,1] op_sel_hi:[1,1]
  v_pk_mul_f32 v[238:239], v[238:239], v[16:17] op_sel:[0,1] op_sel_hi:[1,1]
  s_nop 1
  v_mfma_f32_32x32x16_bf16 v[224:239], v[48:51], a[136:139], v[224:239]
  v_perm_b32 v52, v71, v67, s42
  v_perm_b32 v53, v79, v75, s42
  v_perm_b32 v54, v87, v83, s42
  v_perm_b32 v55, v95, v91, s42
  v_pk_mul_f32 v[240:241], v[240:241], v[16:17] op_sel:[0,1] op_sel_hi:[1,1]
  v_pk_mul_f32 v[242:243], v[242:243], v[16:17] op_sel:[0,1] op_sel_hi:[1,1]
  v_pk_mul_f32 v[244:245], v[244:245], v[16:17] op_sel:[0,1] op_sel_hi:[1,1]
  v_pk_mul_f32 v[246:247], v[246:247], v[16:17] op_sel:[0,1] op_sel_hi:[1,1]
  v_pk_mul_f32 v[248:249], v[248:249], v[16:17] op_sel:[0,1] op_sel_hi:[1,1]
  v_pk_mul_f32 v[250:251], v[250:251], v[16:17] op_sel:[0,1] op_sel_hi:[1,1]
  v_pk_mul_f32 v[252:253], v[252:253], v[16:17] op_sel:[0,1] op_sel_hi:[1,1]
  v_pk_mul_f32 v[254:255], v[254:255], v[16:17] op_sel:[0,1] op_sel_hi:[1,1]
  s_nop 1
  v_mfma_f32_32x32x16_bf16 v[240:255], v[52:55], a[136:139], v[240:255]
  s_add_u32 s44, s55, 131072
  s_add_u32 s45, s55, 147456
  s_add_u32 s46, s55, 163840
  s_add_u32 s47, s55, 180224
  s_waitcnt vmcnt(4)
  buffer_load_dwordx4 v[64:67], v2, s[12:15], s44 offen offset:0 nt
  s_waitcnt vmcnt(4)
  buffer_load_dwordx4 v[68:71], v2, s[12:15], s44 offen offset:1024 nt
  s_waitcnt vmcnt(5)
  s_cbranch_vccnz L_w35
  s_waitcnt vmcnt(4)
L_w35:
  buffer_load_dwordx4 v[72:75], v2, s[12:15], s44 offen offset:2048 nt
  s_waitcnt vmcnt(4)
  buffer_load_dwordx4 v[76:79], v2, s[12:15], s44 offen offset:3072 nt
  s_waitcnt vmcnt(4)
  buffer_load_dwordx4 v[80:83], v2, s[12:15], s45 offen offset:0 nt
  v_perm_b32 v40, v100, v96, s41
  v_perm_b32 v41, v108, v104, s41
  v_perm_b32 v42, v116, v112, s41
  v_perm_b32 v43, v124, v120, s41
  s_nop 1
  v_mfma_f32_32x32x16_bf16 v[128:143], v[40:43], a[140:143], v[128:143]
  v_perm_b32 v44, v100, v96, s42
  v_perm_b32 v45, v108, v104, s42
  v_perm_b32 v46, v116, v112, s42
  v_perm_b32 v47, v124, v120, s42
  s_nop 1
  v_mfma_f32_32x32x16_bf16 v[144:159], v[44:47], a[140:143], v[144:159]
  s_waitcnt vmcnt(4)
  buffer_load_dwordx4 v[84:87], v2, s[12:15], s45 offen offset:1024 nt
  v_perm_b32 v48, v101, v97, s41
  v_perm_b32 v49, v109, v105, s41
  v_perm_b32 v50, v117, v113, s41
  v_perm_b32 v51, v125, v121, s41
  s_nop 1
  v_mfma_f32_32x32x16_bf16 v[160:175], v[48:51], a[140:143], v[160:175]
  v_perm_b32 v52, v101, v97, s42
  v_perm_b32 v53, v109, v105, s42
  v_perm_b32 v54, v117, v113, s42
  v_perm_b32 v55, v125, v121, s42
  s_nop 1
  v_mfma_f32_32x32x16_bf16 v[176:191], v[52:55], a[140:143], v[176:191]
  s_waitcnt vmcnt(4)
  buffer_load_dwordx4 v[88:91], v2, s[12:15], s45 offen offset:2048 nt
  v_perm_b32 v40, v102, v98, s41
  v_perm_b32 v41, v110, v106, s41
  v_perm_b32 v42, v118, v114, s41
  v_perm_b32 v43, v126, v122, s41
  s_nop 1
  v_mfma_f32_32x32x16_bf16 v[192:207], v[40:43], a[140:143], v[192:207]
  v_perm_b32 v44, v102, v98, s42
  v_perm_b32 v45, v110, v106, s42
  v_perm_b32 v46, v118, v114, s42
  v_perm_b32 v47, v126, v122, s42
  s_nop 1
  v_mfma_f32_32x32x16_bf16 v[208:223], v[44:47], a[140:143], v[208:223]
  s_waitcnt vmcnt(4)
  buffer_load_dwordx4 v[92:95], v2, s[12:15], s45 offen offset:3072 nt
  v_perm_b32 v48, v103, v99, s41
  v_perm_b32 v49, v111, v107, s41
  v_perm_b32 v50, v119, v115, s41
  v_perm_b32 v51, v127, v123, s41
  s_nop 1
  v_mfma_f32_32x32x16_bf16 v[224:239], v[48:51], a[140:143], v[224:239]
  v_perm_b32 v52, v103, v99, s42
  v_perm_b32 v53, v111, v107, s42
  v_perm_b32 v54, v119, v115, s42
  v_perm_b32 v55, v127, v123, s42
  s_nop 1
  v_mfma_f32_32x32x16_bf16 v[240:255], v[52:55], a[140:143], v[240:255]
  s_waitcnt vmcnt(4)
  buffer_load_dwordx4 v[96:99], v2, s[12:15], s46 offen offset:0 nt
  s_waitcnt vmcnt(4)
  buffer_load_dwordx4 v[100:103], v2, s[12:15], s46 offen offset:1024 nt
  s_waitcnt vmcnt(5)
  s_cbranch_vccnz L_w36
  s_waitcnt vmcnt(4)
L_w36:
  buffer_load_dwordx4 v[104:107], v2, s[12:15], s46 offen offset:2048 nt
  s_waitcnt vmcnt(4)
  buffer_load_dwordx4 v[108:111], v2, s[12:15], s46 offen offset:3072 nt
  s_waitcnt vmcnt(4)
  buffer_load_dwordx4 v[112:115], v2, s[12:15], s47 offen offset:0 nt
  v_perm_b32 v40, v68, v64, s41
  v_perm_b32 v41, v76, v72, s41
  v_perm_b32 v42, v84, v80, s41
  v_perm_b32 v43, v92, v88, s41
  v_pk_mul_f32 v[128:129], v[128:129], v[18:19] op_sel_hi:[1,0]
  v_pk_mul_f32 v[130:131], v[130:131], v[18:19] op_sel_hi:[1,0]
  v_pk_mul_f32 v[132:133], v[132:133], v[18:19] op_sel_hi:[1,0]
  v_pk_mul_f32 v[134:135], v[134:135], v[18:19] op_sel_hi:[1,0]
  v_pk_mul_f32 v[136:137], v[136:137], v[18:19] op_sel_hi:[1,0]
  v_pk_mul_f32 v[138:139], v[138:139], v[18:19] op_sel_hi:[1,0]
  v_pk_mul_f32 v[140:141], v[140:141], v[18:19] op_sel_hi:[1,0]
  v_pk_mul_f32 v[142:143], v[142:143], v[18:19] op_sel_hi:[1,0]
  s_nop 1
  v_mfma_f32_32x32x16_bf16 v[128:143], v[40:43], a[144:147], v[128:143]
  v_perm_b32 v44, v68, v64, s42
  v_perm_b32 v45, v76, v72, s42
  v_perm_b32 v46, v84, v80, s42
  v_perm_b32 v47, v92, v88, s42
  v_pk_mul_f32 v[144:145], v[144:145], v[18:19] op_sel_hi:[1,0]
  v_pk_mul_f32 v[146:147], v[146:147], v[18:19] op_sel_hi:[1,0]
  v_pk_mul_f32 v[148:149], v[148:149], v[18:19] op_sel_hi:[1,0]
  v_pk_mul_f32 v[150:151], v[150:151], v[18:19] op_sel_hi:[1,0]
  v_pk_mul_f32 v[152:153], v[152:153], v[18:19] op_sel_hi:[1,0]
  v_pk_mul_f32 v[154:155], v[154:155], v[18:19] op_sel_hi:[1,0]
  v_pk_mul_f32 v[156:157], v[156:157], v[18:19] op_sel_hi:[1,0]
  v_pk_mul_f32 v[158:159], v[158:159], v[18:19] op_sel_hi:[1,0]
  s_nop 1
  v_mfma_f32_32x32x16_bf16 v[144:159], v[44:47], a[144:147], v[144:159]
  s_waitcnt vmcnt(4)
  buffer_load_dwordx4 v[116:119], v2, s[12:15], s47 offen offset:1024 nt
  v_perm_b32 v48, v69, v65, s41
  v_perm_b32 v49, v77, v73, s41
  v_perm_b32 v50, v85, v81, s41
  v_perm_b32 v51, v93, v89, s41
  v_pk_mul_f32 v[160:161], v[160:161], v[18:19] op_sel_hi:[1,0]
  v_pk_mul_f32 v[162:163], v[162:163], v[18:19] op_sel_hi:[1,0]
  v_pk_mul_f32 v[164:165], v[164:165], v[18:19] op_sel_hi:[1,0]
  v_pk_mul_f32 v[166:167], v[166:167], v[18:19] op_sel_hi:[1,0]
  v_pk_mul_f32 v[168:169], v[168:169], v[18:19] op_sel_hi:[1,0]
  v_pk_mul_f32 v[170:171], v[170:171], v[18:19] op_sel_hi:[1,0]
  v_pk_mul_f32 v[172:173], v[172:173], v[18:19] op_sel_hi:[1,0]
  v_pk_mul_f32 v[174:175], v[174:175], v[18:19] op_sel_hi:[1,0]
  s_nop 1
  v_mfma_f32_32x32x16_bf16 v[160:175], v[48:51], a[144:147], v[160:175]
  v_perm_b32 v52, v69, v65, s42
  v_perm_b32 v53, v77, v73, s42
  v_perm_b32 v54, v85, v81, s42
  v_perm_b32 v55, v93, v89, s42
  v_pk_mul_f32 v[176:177], v[176:177], v[18:19] op_sel_hi:[1,0]
  v_pk_mul_f32 v[178:179], v[178:179], v[18:19] op_sel_hi:[1,0]
  v_pk_mul_f32 v[180:181], v[180:181], v[18:19] op_sel_hi:[1,0]
  v_pk_mul_f32 v[182:183], v[182:183], v[18:19] op_sel_hi:[1,0]
  v_pk_mul_f32 v[184:185], v[184:185], v[18:19] op_sel_hi:[1,0]
  v_pk_mul_f32 v[186:187], v[186:187], v[18:19] op_sel_hi:[1,0]
  v_pk_mul_f32 v[188:189], v[188:189], v[18:19] op_sel_hi:[1,0]
  v_pk_mul_f32 v[190:191], v[190:191], v[18:19] op_sel_hi:[1,0]
  s_nop 1
  v_mfma_f32_32x32x16_bf16 v[176:191], v[52:55], a[144:147], v[176:191]
  s_waitcnt vmcnt(4)
  buffer_load_dwordx4 v[120:123], v2, s[12:15], s47 offen offset:2048 nt
  v_perm_b32 v40, v70, v66, s41
  v_perm_b32 v41, v78, v74, s41
  v_perm_b32 v42, v86, v82, s41
  v_perm_b32 v43, v94, v90, s41
  v_pk_mul_f32 v[192:193], v[192:193], v[18:19] op_sel_hi:[1,0]
  v_pk_mul_f32 v[194:195], v[194:195], v[18:19] op_sel_hi:[1,0]
  v_pk_mul_f32 v[196:197], v[196:197], v[18:19] op_sel_hi:[1,0]
  v_pk_mul_f32 v[198:199], v[198:199], v[18:19] op_sel_hi:[1,0]
  v_pk_mul_f32 v[200:201], v[200:201], v[18:19] op_sel_hi:[1,0]
  v_pk_mul_f32 v[202:203], v[202:203], v[18:19] op_sel_hi:[1,0]
  v_pk_mul_f32 v[204:205], v[204:205], v[18:19] op_sel_hi:[1,0]
  v_pk_mul_f32 v[206:207], v[206:207], v[18:19] op_sel_hi:[1,0]
  s_nop 1
  v_mfma_f32_32x32x16_bf16 v[192:207], v[40:43], a[144:147], v[192:207]
  v_perm_b32 v44, v70, v66, s42
  v_perm_b32 v45, v78, v74, s42
  v_perm_b32 v46, v86, v82, s42
  v_perm_b32 v47, v94, v90, s42
  v_pk_mul_f32 v[208:209], v[208:209], v[18:19] op_sel_hi:[1,0]
  v_pk_mul_f32 v[210:211], v[210:211], v[18:19] op_sel_hi:[1,0]
  v_pk_mul_f32 v[212:213], v[212:213], v[18:19] op_sel_hi:[1,0]
  v_pk_mul_f32 v[214:215], v[214:215], v[18:19] op_sel_hi:[1,0]
  v_pk_mul_f32 v[216:217], v[216:217], v[18:19] op_sel_hi:[1,0]
  v_pk_mul_f32 v[218:219], v[218:219], v[18:19] op_sel_hi:[1,0]
  v_pk_mul_f32 v[220:221], v[220:221], v[18:19] op_sel_hi:[1,0]
  v_pk_mul_f32 v[222:223], v[222:223], v[18:19] op_sel_hi:[1,0]
  s_nop 1
  v_mfma_f32_32x32x16_bf16 v[208:223], v[44:47], a[144:147], v[208:223]
  s_waitcnt vmcnt(4)
  buffer_load_dwordx4 v[124:127], v2, s[12:15], s47 offen offset:3072 nt
  v_perm_b32 v48, v71, v67, s41
  v_perm_b32 v49, v79, v75, s41
  v_perm_b32 v50, v87, v83, s41
  v_perm_b32 v51, v95, v91, s41
  v_pk_mul_f32 v[224:225], v[224:225], v[18:19] op_sel_hi:[1,0]
  v_pk_mul_f32 v[226:227], v[226:227], v[18:19] op_sel_hi:[1,0]
  v_pk_mul_f32 v[228:229], v[228:229], v[18:19] op_sel_hi:[1,0]
  v_pk_mul_f32 v[230:231], v[230:231], v[18:19] op_sel_hi:[1,0]
  v_pk_mul_f32 v[232:233], v[232:233], v[18:19] op_sel_hi:[1,0]
  v_pk_mul_f32 v[234:235], v[234:235], v[18:19] op_sel_hi:[1,0]
  v_pk_mul_f32 v[236:237], v[236:237], v[18:19] op_sel_hi:[1,0]
  v_pk_mul_f32 v[238:239], v[238:239], v[18:19] op_sel_hi:[1,0]
  s_nop 1
  v_mfma_f32_32x32x16_bf16 v[224:239], v[48:51], a[144:147], v[224:239]
  v_perm_b32 v52, v71, v67, s42
  v_perm_b32 v53, v79, v75, s42
  v_perm_b32 v54, v87, v83, s42
  v_perm_b32 v55, v95, v91, s42
  v_pk_mul_f32 v[240:241], v[240:241], v[18:19] op_sel_hi:[1,0]
  v_pk_mul_f32 v[242:243], v[242:243], v[18:19] op_sel_hi:[1,0]
  v_pk_mul_f32 v[244:245], v[244:245], v[18:19] op_sel_hi:[1,0]
  v_pk_mul_f32 v[246:247], v[246:247], v[18:19] op_sel_hi:[1,0]
  v_pk_mul_f32 v[248:249], v[248:249], v[18:19] op_sel_hi:[1,0]
  v_pk_mul_f32 v[250:251], v[250:251], v[18:19] op_sel_hi:[1,0]
  v_pk_mul_f32 v[252:253], v[252:253], v[18:19] op_sel_hi:[1,0]
  v_pk_mul_f32 v[254:255], v[254:255], v[18:19] op_sel_hi:[1,0]
  s_nop 1
  v_mfma_f32_32x32x16_bf16 v[240:255], v[52:55], a[144:147], v[240:255]
  s_add_u32 s44, s55, 196608
  s_add_u32 s45, s55, 212992
  s_add_u32 s46, s55, 229376
  s_add_u32 s47, s55, 245760
  s_waitcnt vmcnt(4)
  buffer_load_dwordx4 v[64:67], v2, s[12:15], s44 offen offset:0 nt
  s_waitcnt vmcnt(4)
  buffer_load_dwordx4 v[68:71], v2, s[12:15], s44 offen offset:1024 nt
  s_waitcnt vmcnt(5)
  s_cbranch_vccnz L_w37
  s_waitcnt vmcnt(4)
L_w37:
  buffer_load_dwordx4 v[72:75], v2, s[12:15], s44 offen offset:2048 nt
  s_waitcnt vmcnt(4)
  buffer_load_dwordx4 v[76:79], v2, s[12:15], s44 offen offset:3072 nt
  s_waitcnt vmcnt(4)
  buffer_load_dwordx4 v[80:83], v2, s[12:15], s45 offen offset:0 nt
  v_perm_b32 v40, v100, v96, s41
  v_perm_b32 v41, v108, v104, s41
  v_perm_b32 v42, v116, v112, s41
  v_perm_b32 v43, v124, v120, s41
  s_nop 1
  v_mfma_f32_32x32x16_bf16 v[128:143], v[40:43], a[148:151], v[128:143]
  v_perm_b32 v44, v100, v96, s42
  v_perm_b32 v45, v108, v104, s42
  v_perm_b32 v46, v116, v112, s42
  v_perm_b32 v47, v124, v120, s42
  s_nop 1
  v_mfma_f32_32x32x16_bf16 v[144:159], v[44:47], a[148:151], v[144:159]
  s_waitcnt vmcnt(4)
  buffer_load_dwordx4 v[84:87], v2, s[12:15], s45 offen offset:1024 nt
  v_perm_b32 v48, v101, v97, s41
  v_perm_b32 v49, v109, v105, s41
  v_perm_b32 v50, v117, v113, s41
  v_perm_b32 v51, v125, v121, s41
  s_nop 1
  v_mfma_f32_32x32x16_bf16 v[160:175], v[48:51], a[148:151], v[160:175]
  v_perm_b32 v52, v101, v97, s42
  v_perm_b32 v53, v109, v105, s42
  v_perm_b32 v54, v117, v113, s42
  v_perm_b32 v55, v125, v121, s42
  s_nop 1
  v_mfma_f32_32x32x16_bf16 v[176:191], v[52:55], a[148:151], v[176:191]
  s_waitcnt vmcnt(4)
  buffer_load_dwordx4 v[88:91], v2, s[12:15], s45 offen offset:2048 nt
  v_perm_b32 v40, v102, v98, s41
  v_perm_b32 v41, v110, v106, s41
  v_perm_b32 v42, v118, v114, s41
  v_perm_b32 v43, v126, v122, s41
  s_nop 1
  v_mfma_f32_32x32x16_bf16 v[192:207], v[40:43], a[148:151], v[192:207]
  v_perm_b32 v44, v102, v98, s42
  v_perm_b32 v45, v110, v106, s42
  v_perm_b32 v46, v118, v114, s42
  v_perm_b32 v47, v126, v122, s42
  s_nop 1
  v_mfma_f32_32x32x16_bf16 v[208:223], v[44:47], a[148:151], v[208:223]
  s_waitcnt vmcnt(4)
  buffer_load_dwordx4 v[92:95], v2, s[12:15], s45 offen offset:3072 nt
  v_perm_b32 v48, v103, v99, s41
  v_perm_b32 v49, v111, v107, s41
  v_perm_b32 v50, v119, v115, s41
  v_perm_b32 v51, v127, v123, s41
  s_nop 1
  v_mfma_f32_32x32x16_bf16 v[224:239], v[48:51], a[148:151], v[224:239]
  v_perm_b32 v52, v103, v99, s42
  v_perm_b32 v53, v111, v107, s42
  v_perm_b32 v54, v119, v115, s42
  v_perm_b32 v55, v127, v123, s42
  s_nop 1
  v_mfma_f32_32x32x16_bf16 v[240:255], v[52:55], a[148:151], v[240:255]
  s_waitcnt vmcnt(4)
  buffer_load_dwordx4 v[96:99], v2, s[12:15], s46 offen offset:0 nt
  s_waitcnt vmcnt(4)
  buffer_load_dwordx4 v[100:103], v2, s[12:15], s46 offen offset:1024 nt
  s_waitcnt vmcnt(5)
  s_cbranch_vccnz L_w38
  s_waitcnt vmcnt(4)
L_w38:
  buffer_load_dwordx4 v[104:107], v2, s[12:15], s46 offen offset:2048 nt
  s_waitcnt vmcnt(4)
  buffer_load_dwordx4 v[108:111], v2, s[12:15], s46 offen offset:3072 nt
  s_waitcnt vmcnt(4)
  buffer_load_dwordx4 v[112:115], v2, s[12:15], s47 offen offset:0 nt
  v_perm_b32 v40, v68, v64, s41
  v_perm_b32 v41, v76, v72, s41
  v_perm_b32 v42, v84, v80, s41
  v_perm_b32 v43, v92, v88, s41
  v_pk_mul_f32 v[128:129], v[128:129], v[18:19] op_sel:[0,1] op_sel_hi:[1,1]
  v_pk_mul_f32 v[130:131], v[130:131], v[18:19] op_sel:[0,1] op_sel_hi:[1,1]
  v_pk_mul_f32 v[132:133], v[132:133], v[18:19] op_sel:[0,1] op_sel_hi:[1,1]
  v_pk_mul_f32 v[134:135], v[134:135], v[18:19] op_sel:[0,1] op_sel_hi:[1,1]
  v_pk_mul_f32 v[136:137], v[136:137], v[18:19] op_sel:[0,1] op_sel_hi:[1,1]
  v_pk_mul_f32 v[138:139], v[138:139], v[18:19] op_sel:[0,1] op_sel_hi:[1,1]
  v_pk_mul_f32 v[140:141], v[140:141], v[18:19] op_sel:[0,1] op_sel_hi:[1,1]
  v_pk_mul_f32 v[142:143], v[142:143], v[18:19] op_sel:[0,1] op_sel_hi:[1,1]
  s_nop 1
  v_mfma_f32_32x32x16_bf16 v[128:143], v[40:43], a[152:155], v[128:143]
  v_perm_b32 v44, v68, v64, s42
  v_perm_b32 v45, v76, v72, s42
  v_perm_b32 v46, v84, v80, s42
  v_perm_b32 v47, v92, v88, s42
  v_pk_mul_f32 v[144:145], v[144:145], v[18:19] op_sel:[0,1] op_sel_hi:[1,1]
  v_pk_mul_f32 v[146:147], v[146:147], v[18:19] op_sel:[0,1] op_sel_hi:[1,1]
  v_pk_mul_f32 v[148:149], v[148:149], v[18:19] op_sel:[0,1] op_sel_hi:[1,1]
  v_pk_mul_f32 v[150:151], v[150:151], v[18:19] op_sel:[0,1] op_sel_hi:[1,1]
  v_pk_mul_f32 v[152:153], v[152:153], v[18:19] op_sel:[0,1] op_sel_hi:[1,1]
  v_pk_mul_f32 v[154:155], v[154:155], v[18:19] op_sel:[0,1] op_sel_hi:[1,1]
  v_pk_mul_f32 v[156:157], v[156:157], v[18:19] op_sel:[0,1] op_sel_hi:[1,1]
  v_pk_mul_f32 v[158:159], v[158:159], v[18:19] op_sel:[0,1] op_sel_hi:[1,1]
  s_nop 1
  v_mfma_f32_32x32x16_bf16 v[144:159], v[44:47], a[152:155], v[144:159]
  s_waitcnt vmcnt(4)
  buffer_load_dwordx4 v[116:119], v2, s[12:15], s47 offen offset:1024 nt
  v_perm_b32 v48, v69, v65, s41
  v_perm_b32 v49, v77, v73, s41
  v_perm_b32 v50, v85, v81, s41
  v_perm_b32 v51, v93, v89, s41
  v_pk_mul_f32 v[160:161], v[160:161], v[18:19] op_sel:[0,1] op_sel_hi:[1,1]
  v_pk_mul_f32 v[162:163], v[162:163], v[18:19] op_sel:[0,1] op_sel_hi:[1,1]
  v_pk_mul_f32 v[164:165], v[164:165], v[18:19] op_sel:[0,1] op_sel_hi:[1,1]
  v_pk_mul_f32 v[166:167], v[166:167], v[18:19] op_sel:[0,1] op_sel_hi:[1,1]
  v_pk_mul_f32 v[168:169], v[168:169], v[18:19] op_sel:[0,1] op_sel_hi:[1,1]
  v_pk_mul_f32 v[170:171], v[170:171], v[18:19] op_sel:[0,1] op_sel_hi:[1,1]
  v_pk_mul_f32 v[172:173], v[172:173], v[18:19] op_sel:[0,1] op_sel_hi:[1,1]
  v_pk_mul_f32 v[174:175], v[174:175], v[18:19] op_sel:[0,1] op_sel_hi:[1,1]
  s_nop 1
  v_mfma_f32_32x32x16_bf16 v[160:175], v[48:51], a[152:155], v[160:175]
  v_perm_b32 v52, v69, v65, s42
  v_perm_b32 v53, v77, v73, s42
  v_perm_b32 v54, v85, v81, s42
  v_perm_b32 v55, v93, v89, s42
  v_pk_mul_f32 v[176:177], v[176:177], v[18:19] op_sel:[0,1] op_sel_hi:[1,1]
  v_pk_mul_f32 v[178:179], v[178:179], v[18:19] op_sel:[0,1] op_sel_hi:[1,1]
  v_pk_mul_f32 v[180:181], v[180:181], v[18:19] op_sel:[0,1] op_sel_hi:[1,1]
  v_pk_mul_f32 v[182:183], v[182:183], v[18:19] op_sel:[0,1] op_sel_hi:[1,1]
  v_pk_mul_f32 v[184:185], v[184:185], v[18:19] op_sel:[0,1] op_sel_hi:[1,1]
  v_pk_mul_f32 v[186:187], v[186:187], v[18:19] op_sel:[0,1] op_sel_hi:[1,1]
  v_pk_mul_f32 v[188:189], v[188:189], v[18:19] op_sel:[0,1] op_sel_hi:[1,1]
  v_pk_mul_f32 v[190:191], v[190:191], v[18:19] op_sel:[0,1] op_sel_hi:[1,1]
  s_nop 1
  v_mfma_f32_32x32x16_bf16 v[176:191], v[52:55], a[152:155], v[176:191]
  s_waitcnt vmcnt(4)
  buffer_load_dwordx4 v[120:123], v2, s[12:15], s47 offen offset:2048 nt
  v_perm_b32 v40, v70, v66, s41
  v_perm_b32 v41, v78, v74, s41
  v_perm_b32 v42, v86, v82, s41
  v_perm_b32 v43, v94, v90, s41
  v_pk_mul_f32 v[192:193], v[192:193], v[18:19] op_sel:[0,1] op_sel_hi:[1,1]
  v_pk_mul_f32 v[194:195], v[194:195], v[18:19] op_sel:[0,1] op_sel_hi:[1,1]
  v_pk_mul_f32 v[196:197], v[196:197], v[18:19] op_sel:[0,1] op_sel_hi:[1,1]
  v_pk_mul_f32 v[198:199], v[198:199], v[18:19] op_sel:[0,1] op_sel_hi:[1,1]
  v_pk_mul_f32 v[200:201], v[200:201], v[18:19] op_sel:[0,1] op_sel_hi:[1,1]
  v_pk_mul_f32 v[202:203], v[202:203], v[18:19] op_sel:[0,1] op_sel_hi:[1,1]
  v_pk_mul_f32 v[204:205], v[204:205], v[18:19] op_sel:[0,1] op_sel_hi:[1,1]
  v_pk_mul_f32 v[206:207], v[206:207], v[18:19] op_sel:[0,1] op_sel_hi:[1,1]
  s_nop 1
  v_mfma_f32_32x32x16_bf16 v[192:207], v[40:43], a[152:155], v[192:207]
  v_perm_b32 v44, v70, v66, s42
  v_perm_b32 v45, v78, v74, s42
  v_perm_b32 v46, v86, v82, s42
  v_perm_b32 v47, v94, v90, s42
  v_pk_mul_f32 v[208:209], v[208:209], v[18:19] op_sel:[0,1] op_sel_hi:[1,1]
  v_pk_mul_f32 v[210:211], v[210:211], v[18:19] op_sel:[0,1] op_sel_hi:[1,1]
  v_pk_mul_f32 v[212:213], v[212:213], v[18:19] op_sel:[0,1] op_sel_hi:[1,1]
  v_pk_mul_f32 v[214:215], v[214:215], v[18:19] op_sel:[0,1] op_sel_hi:[1,1]
  v_pk_mul_f32 v[216:217], v[216:217], v[18:19] op_sel:[0,1] op_sel_hi:[1,1]
  v_pk_mul_f32 v[218:219], v[218:219], v[18:19] op_sel:[0,1] op_sel_hi:[1,1]
  v_pk_mul_f32 v[220:221], v[220:221], v[18:19] op_sel:[0,1] op_sel_hi:[1,1]
  v_pk_mul_f32 v[222:223], v[222:223], v[18:19] op_sel:[0,1] op_sel_hi:[1,1]
  s_nop 1
  v_mfma_f32_32x32x16_bf16 v[208:223], v[44:47], a[152:155], v[208:223]
  s_waitcnt vmcnt(4)
  buffer_load_dwordx4 v[124:127], v2, s[12:15], s47 offen offset:3072 nt
  v_perm_b32 v48, v71, v67, s41
  v_perm_b32 v49, v79, v75, s41
  v_perm_b32 v50, v87, v83, s41
  v_perm_b32 v51, v95, v91, s41
  v_pk_mul_f32 v[224:225], v[224:225], v[18:19] op_sel:[0,1] op_sel_hi:[1,1]
  v_pk_mul_f32 v[226:227], v[226:227], v[18:19] op_sel:[0,1] op_sel_hi:[1,1]
  v_pk_mul_f32 v[228:229], v[228:229], v[18:19] op_sel:[0,1] op_sel_hi:[1,1]
  v_pk_mul_f32 v[230:231], v[230:231], v[18:19] op_sel:[0,1] op_sel_hi:[1,1]
  v_pk_mul_f32 v[232:233], v[232:233], v[18:19] op_sel:[0,1] op_sel_hi:[1,1]
  v_pk_mul_f32 v[234:235], v[234:235], v[18:19] op_sel:[0,1] op_sel_hi:[1,1]
  v_pk_mul_f32 v[236:237], v[236:237], v[18:19] op_sel:[0,1] op_sel_hi:[1,1]
  v_pk_mul_f32 v[238:239], v[238:239], v[18:19] op_sel:[0,1] op_sel_hi:[1,1]
  s_nop 1
  v_mfma_f32_32x32x16_bf16 v[224:239], v[48:51], a[152:155], v[224:239]
  v_perm_b32 v52, v71, v67, s42
  v_perm_b32 v53, v79, v75, s42
  v_perm_b32 v54, v87, v83, s42
  v_perm_b32 v55, v95, v91, s42
  v_pk_mul_f32 v[240:241], v[240:241], v[18:19] op_sel:[0,1] op_sel_hi:[1,1]
  v_pk_mul_f32 v[242:243], v[242:243], v[18:19] op_sel:[0,1] op_sel_hi:[1,1]
  v_pk_mul_f32 v[244:245], v[244:245], v[18:19] op_sel:[0,1] op_sel_hi:[1,1]
  v_pk_mul_f32 v[246:247], v[246:247], v[18:19] op_sel:[0,1] op_sel_hi:[1,1]
  v_pk_mul_f32 v[248:249], v[248:249], v[18:19] op_sel:[0,1] op_sel_hi:[1,1]
  v_pk_mul_f32 v[250:251], v[250:251], v[18:19] op_sel:[0,1] op_sel_hi:[1,1]
  v_pk_mul_f32 v[252:253], v[252:253], v[18:19] op_sel:[0,1] op_sel_hi:[1,1]
  v_pk_mul_f32 v[254:255], v[254:255], v[18:19] op_sel:[0,1] op_sel_hi:[1,1]
  s_nop 1
  v_mfma_f32_32x32x16_bf16 v[240:255], v[52:55], a[152:155], v[240:255]
  s_add_u32 s44, s55, 262144
  s_add_u32 s45, s55, 278528
  s_add_u32 s46, s55, 294912
  s_add_u32 s47, s55, 311296
  s_waitcnt vmcnt(4)
  buffer_load_dwordx4 v[64:67], v2, s[12:15], s44 offen offset:0 nt
  s_waitcnt vmcnt(4)
  buffer_load_dwordx4 v[68:71], v2, s[12:15], s44 offen offset:1024 nt
  s_waitcnt vmcnt(5)
  s_cbranch_vccnz L_w39
  s_waitcnt vmcnt(4)
L_w39:
  buffer_load_dwordx4 v[72:75], v2, s[12:15], s44 offen offset:2048 nt
  s_waitcnt vmcnt(4)
  buffer_load_dwordx4 v[76:79], v2, s[12:15], s44 offen offset:3072 nt
  s_waitcnt vmcnt(4)
  buffer_load_dwordx4 v[80:83], v2, s[12:15], s45 offen offset:0 nt
  v_perm_b32 v40, v100, v96, s41
  v_perm_b32 v41, v108, v104, s41
  v_perm_b32 v42, v116, v112, s41
  v_perm_b32 v43, v124, v120, s41
  s_nop 1
  v_mfma_f32_32x32x16_bf16 v[128:143], v[40:43], a[156:159], v[128:143]
  v_perm_b32 v44, v100, v96, s42
  v_perm_b32 v45, v108, v104, s42
  v_perm_b32 v46, v116, v112, s42
  v_perm_b32 v47, v124, v120, s42
  s_nop 1
  v_mfma_f32_32x32x16_bf16 v[144:159], v[44:47], a[156:159], v[144:159]
  s_waitcnt vmcnt(4)
  buffer_load_dwordx4 v[84:87], v2, s[12:15], s45 offen offset:1024 nt
  v_perm_b32 v48, v101, v97, s41
  v_perm_b32 v49, v109, v105, s41
  v_perm_b32 v50, v117, v113, s41
  v_perm_b32 v51, v125, v121, s41
  s_nop 1
  v_mfma_f32_32x32x16_bf16 v[160:175], v[48:51], a[156:159], v[160:175]
  v_perm_b32 v52, v101, v97, s42
  v_perm_b32 v53, v109, v105, s42
  v_perm_b32 v54, v117, v113, s42
  v_perm_b32 v55, v125, v121, s42
  s_nop 1
  v_mfma_f32_32x32x16_bf16 v[176:191], v[52:55], a[156:159], v[176:191]
  s_waitcnt vmcnt(4)
  buffer_load_dwordx4 v[88:91], v2, s[12:15], s45 offen offset:2048 nt
  v_perm_b32 v40, v102, v98, s41
  v_perm_b32 v41, v110, v106, s41
  v_perm_b32 v42, v118, v114, s41
  v_perm_b32 v43, v126, v122, s41
  s_nop 1
  v_mfma_f32_32x32x16_bf16 v[192:207], v[40:43], a[156:159], v[192:207]
  v_perm_b32 v44, v102, v98, s42
  v_perm_b32 v45, v110, v106, s42
  v_perm_b32 v46, v118, v114, s42
  v_perm_b32 v47, v126, v122, s42
  s_nop 1
  v_mfma_f32_32x32x16_bf16 v[208:223], v[44:47], a[156:159], v[208:223]
  s_waitcnt vmcnt(4)
  buffer_load_dwordx4 v[92:95], v2, s[12:15], s45 offen offset:3072 nt
  v_perm_b32 v48, v103, v99, s41
  v_perm_b32 v49, v111, v107, s41
  v_perm_b32 v50, v119, v115, s41
  v_perm_b32 v51, v127, v123, s41
  s_nop 1
  v_mfma_f32_32x32x16_bf16 v[224:239], v[48:51], a[156:159], v[224:239]
  v_perm_b32 v52, v103, v99, s42
  v_perm_b32 v53, v111, v107, s42
  v_perm_b32 v54, v119, v115, s42
  v_perm_b32 v55, v127, v123, s42
  s_nop 1
  v_mfma_f32_32x32x16_bf16 v[240:255], v[52:55], a[156:159], v[240:255]
  s_waitcnt vmcnt(4)
  buffer_load_dwordx4 v[96:99], v2, s[12:15], s46 offen offset:0 nt
  s_waitcnt vmcnt(4)
  buffer_load_dwordx4 v[100:103], v2, s[12:15], s46 offen offset:1024 nt
  s_waitcnt vmcnt(5)
  s_cbranch_vccnz L_w40
  s_waitcnt vmcnt(4)
L_w40:
  buffer_load_dwordx4 v[104:107], v2, s[12:15], s46 offen offset:2048 nt
  s_waitcnt vmcnt(4)
  buffer_load_dwordx4 v[108:111], v2, s[12:15], s46 offen offset:3072 nt
  s_waitcnt vmcnt(4)
  buffer_load_dwordx4 v[112:115], v2, s[12:15], s47 offen offset:0 nt
  v_perm_b32 v40, v68, v64, s41
  v_perm_b32 v41, v76, v72, s41
  v_perm_b32 v42, v84, v80, s41
  v_perm_b32 v43, v92, v88, s41
  v_pk_mul_f32 v[128:129], v[128:129], v[20:21] op_sel_hi:[1,0]
  v_pk_mul_f32 v[130:131], v[130:131], v[20:21] op_sel_hi:[1,0]
  v_pk_mul_f32 v[132:133], v[132:133], v[20:21] op_sel_hi:[1,0]
  v_pk_mul_f32 v[134:135], v[134:135], v[20:21] op_sel_hi:[1,0]
  v_pk_mul_f32 v[136:137], v[136:137], v[20:21] op_sel_hi:[1,0]
  v_pk_mul_f32 v[138:139], v[138:139], v[20:21] op_sel_hi:[1,0]
  v_pk_mul_f32 v[140:141], v[140:141], v[20:21] op_sel_hi:[1,0]
  v_pk_mul_f32 v[142:143], v[142:143], v[20:21] op_sel_hi:[1,0]
  s_nop 1
  v_mfma_f32_32x32x16_bf16 v[128:143], v[40:43], a[160:163], v[128:143]
  v_perm_b32 v44, v68, v64, s42
  v_perm_b32 v45, v76, v72, s42
  v_perm_b32 v46, v84, v80, s42
  v_perm_b32 v47, v92, v88, s42
  v_pk_mul_f32 v[144:145], v[144:145], v[20:21] op_sel_hi:[1,0]
  v_pk_mul_f32 v[146:147], v[146:147], v[20:21] op_sel_hi:[1,0]
  v_pk_mul_f32 v[148:149], v[148:149], v[20:21] op_sel_hi:[1,0]
  v_pk_mul_f32 v[150:151], v[150:151], v[20:21] op_sel_hi:[1,0]
  v_pk_mul_f32 v[152:153], v[152:153], v[20:21] op_sel_hi:[1,0]
  v_pk_mul_f32 v[154:155], v[154:155], v[20:21] op_sel_hi:[1,0]
  v_pk_mul_f32 v[156:157], v[156:157], v[20:21] op_sel_hi:[1,0]
  v_pk_mul_f32 v[158:159], v[158:159], v[20:21] op_sel_hi:[1,0]
  s_nop 1
  v_mfma_f32_32x32x16_bf16 v[144:159], v[44:47], a[160:163], v[144:159]
  s_waitcnt vmcnt(4)
  buffer_load_dwordx4 v[116:119], v2, s[12:15], s47 offen offset:1024 nt
  v_perm_b32 v48, v69, v65, s41
  v_perm_b32 v49, v77, v73, s41
  v_perm_b32 v50, v85, v81, s41
  v_perm_b32 v51, v93, v89, s41
  v_pk_mul_f32 v[160:161], v[160:161], v[20:21] op_sel_hi:[1,0]
  v_pk_mul_f32 v[162:163], v[162:163], v[20:21] op_sel_hi:[1,0]
  v_pk_mul_f32 v[164:165], v[164:165], v[20:21] op_sel_hi:[1,0]
  v_pk_mul_f32 v[166:167], v[166:167], v[20:21] op_sel_hi:[1,0]
  v_pk_mul_f32 v[168:169], v[168:169], v[20:21] op_sel_hi:[1,0]
  v_pk_mul_f32 v[170:171], v[170:171], v[20:21] op_sel_hi:[1,0]
  v_pk_mul_f32 v[172:173], v[172:173], v[20:21] op_sel_hi:[1,0]
  v_pk_mul_f32 v[174:175], v[174:175], v[20:21] op_sel_hi:[1,0]
  s_nop 1
  v_mfma_f32_32x32x16_bf16 v[160:175], v[48:51], a[160:163], v[160:175]
  v_perm_b32 v52, v69, v65, s42
  v_perm_b32 v53, v77, v73, s42
  v_perm_b32 v54, v85, v81, s42
  v_perm_b32 v55, v93, v89, s42
  v_pk_mul_f32 v[176:177], v[176:177], v[20:21] op_sel_hi:[1,0]
  v_pk_mul_f32 v[178:179], v[178:179], v[20:21] op_sel_hi:[1,0]
  v_pk_mul_f32 v[180:181], v[180:181], v[20:21] op_sel_hi:[1,0]
  v_pk_mul_f32 v[182:183], v[182:183], v[20:21] op_sel_hi:[1,0]
  v_pk_mul_f32 v[184:185], v[184:185], v[20:21] op_sel_hi:[1,0]
  v_pk_mul_f32 v[186:187], v[186:187], v[20:21] op_sel_hi:[1,0]
  v_pk_mul_f32 v[188:189], v[188:189], v[20:21] op_sel_hi:[1,0]
  v_pk_mul_f32 v[190:191], v[190:191], v[20:21] op_sel_hi:[1,0]
  s_nop 1
  v_mfma_f32_32x32x16_bf16 v[176:191], v[52:55], a[160:163], v[176:191]
  s_waitcnt vmcnt(4)
  buffer_load_dwordx4 v[120:123], v2, s[12:15], s47 offen offset:2048 nt
  v_perm_b32 v40, v70, v66, s41
  v_perm_b32 v41, v78, v74, s41
  v_perm_b32 v42, v86, v82, s41
  v_perm_b32 v43, v94, v90, s41
  v_pk_mul_f32 v[192:193], v[192:193], v[20:21] op_sel_hi:[1,0]
  v_pk_mul_f32 v[194:195], v[194:195], v[20:21] op_sel_hi:[1,0]
  v_pk_mul_f32 v[196:197], v[196:197], v[20:21] op_sel_hi:[1,0]
  v_pk_mul_f32 v[198:199], v[198:199], v[20:21] op_sel_hi:[1,0]
  v_pk_mul_f32 v[200:201], v[200:201], v[20:21] op_sel_hi:[1,0]
  v_pk_mul_f32 v[202:203], v[202:203], v[20:21] op_sel_hi:[1,0]
  v_pk_mul_f32 v[204:205], v[204:205], v[20:21] op_sel_hi:[1,0]
  v_pk_mul_f32 v[206:207], v[206:207], v[20:21] op_sel_hi:[1,0]
  s_nop 1
  v_mfma_f32_32x32x16_bf16 v[192:207], v[40:43], a[160:163], v[192:207]
  v_perm_b32 v44, v70, v66, s42
  v_perm_b32 v45, v78, v74, s42
  v_perm_b32 v46, v86, v82, s42
  v_perm_b32 v47, v94, v90, s42
  v_pk_mul_f32 v[208:209], v[208:209], v[20:21] op_sel_hi:[1,0]
  v_pk_mul_f32 v[210:211], v[210:211], v[20:21] op_sel_hi:[1,0]
  v_pk_mul_f32 v[212:213], v[212:213], v[20:21] op_sel_hi:[1,0]
  v_pk_mul_f32 v[214:215], v[214:215], v[20:21] op_sel_hi:[1,0]
  v_pk_mul_f32 v[216:217], v[216:217], v[20:21] op_sel_hi:[1,0]
  v_pk_mul_f32 v[218:219], v[218:219], v[20:21] op_sel_hi:[1,0]
  v_pk_mul_f32 v[220:221], v[220:221], v[20:21] op_sel_hi:[1,0]
  v_pk_mul_f32 v[222:223], v[222:223], v[20:21] op_sel_hi:[1,0]
  s_nop 1
  v_mfma_f32_32x32x16_bf16 v[208:223], v[44:47], a[160:163], v[208:223]
  s_waitcnt vmcnt(4)
  buffer_load_dwordx4 v[124:127], v2, s[12:15], s47 offen offset:3072 nt
  v_perm_b32 v48, v71, v67, s41
  v_perm_b32 v49, v79, v75, s41
  v_perm_b32 v50, v87, v83, s41
  v_perm_b32 v51, v95, v91, s41
  v_pk_mul_f32 v[224:225], v[224:225], v[20:21] op_sel_hi:[1,0]
  v_pk_mul_f32 v[226:227], v[226:227], v[20:21] op_sel_hi:[1,0]
  v_pk_mul_f32 v[228:229], v[228:229], v[20:21] op_sel_hi:[1,0]
  v_pk_mul_f32 v[230:231], v[230:231], v[20:21] op_sel_hi:[1,0]
  v_pk_mul_f32 v[232:233], v[232:233], v[20:21] op_sel_hi:[1,0]
  v_pk_mul_f32 v[234:235], v[234:235], v[20:21] op_sel_hi:[1,0]
  v_pk_mul_f32 v[236:237], v[236:237], v[20:21] op_sel_hi:[1,0]
  v_pk_mul_f32 v[238:239], v[238:239], v[20:21] op_sel_hi:[1,0]
  s_nop 1
  v_mfma_f32_32x32x16_bf16 v[224:239], v[48:51], a[160:163], v[224:239]
  v_perm_b32 v52, v71, v67, s42
  v_perm_b32 v53, v79, v75, s42
  v_perm_b32 v54, v87, v83, s42
  v_perm_b32 v55, v95, v91, s42
  v_pk_mul_f32 v[240:241], v[240:241], v[20:21] op_sel_hi:[1,0]
  v_pk_mul_f32 v[242:243], v[242:243], v[20:21] op_sel_hi:[1,0]
  v_pk_mul_f32 v[244:245], v[244:245], v[20:21] op_sel_hi:[1,0]
  v_pk_mul_f32 v[246:247], v[246:247], v[20:21] op_sel_hi:[1,0]
  v_pk_mul_f32 v[248:249], v[248:249], v[20:21] op_sel_hi:[1,0]
  v_pk_mul_f32 v[250:251], v[250:251], v[20:21] op_sel_hi:[1,0]
  v_pk_mul_f32 v[252:253], v[252:253], v[20:21] op_sel_hi:[1,0]
  v_pk_mul_f32 v[254:255], v[254:255], v[20:21] op_sel_hi:[1,0]
  s_nop 1
  v_mfma_f32_32x32x16_bf16 v[240:255], v[52:55], a[160:163], v[240:255]
  s_add_u32 s44, s55, 327680
  s_add_u32 s45, s55, 344064
  s_add_u32 s46, s55, 360448
  s_add_u32 s47, s55, 376832
  s_waitcnt vmcnt(4)
  buffer_load_dwordx4 v[64:67], v2, s[12:15], s44 offen offset:0 nt
  s_waitcnt vmcnt(4)
  buffer_load_dwordx4 v[68:71], v2, s[12:15], s44 offen offset:1024 nt
  s_waitcnt vmcnt(5)
  s_cbranch_vccnz L_w41
  s_waitcnt vmcnt(4)
L_w41:
  buffer_load_dwordx4 v[72:75], v2, s[12:15], s44 offen offset:2048 nt
  s_waitcnt vmcnt(4)
  buffer_load_dwordx4 v[76:79], v2, s[12:15], s44 offen offset:3072 nt
  s_waitcnt vmcnt(4)
  buffer_load_dwordx4 v[80:83], v2, s[12:15], s45 offen offset:0 nt
  v_perm_b32 v40, v100, v96, s41
  v_perm_b32 v41, v108, v104, s41
  v_perm_b32 v42, v116, v112, s41
  v_perm_b32 v43, v124, v120, s41
  s_nop 1
  v_mfma_f32_32x32x16_bf16 v[128:143], v[40:43], a[164:167], v[128:143]
  v_perm_b32 v44, v100, v96, s42
  v_perm_b32 v45, v108, v104, s42
  v_perm_b32 v46, v116, v112, s42
  v_perm_b32 v47, v124, v120, s42
  s_nop 1
  v_mfma_f32_32x32x16_bf16 v[144:159], v[44:47], a[164:167], v[144:159]
  s_waitcnt vmcnt(4)
  buffer_load_dwordx4 v[84:87], v2, s[12:15], s45 offen offset:1024 nt
  v_perm_b32 v48, v101, v97, s41
  v_perm_b32 v49, v109, v105, s41
  v_perm_b32 v50, v117, v113, s41
  v_perm_b32 v51, v125, v121, s41
  s_nop 1
  v_mfma_f32_32x32x16_bf16 v[160:175], v[48:51], a[164:167], v[160:175]
  v_perm_b32 v52, v101, v97, s42
  v_perm_b32 v53, v109, v105, s42
  v_perm_b32 v54, v117, v113, s42
  v_perm_b32 v55, v125, v121, s42
  s_nop 1
  v_mfma_f32_32x32x16_bf16 v[176:191], v[52:55], a[164:167], v[176:191]
  s_waitcnt vmcnt(4)
  buffer_load_dwordx4 v[88:91], v2, s[12:15], s45 offen offset:2048 nt
  v_perm_b32 v40, v102, v98, s41
  v_perm_b32 v41, v110, v106, s41
  v_perm_b32 v42, v118, v114, s41
  v_perm_b32 v43, v126, v122, s41
  s_nop 1
  v_mfma_f32_32x32x16_bf16 v[192:207], v[40:43], a[164:167], v[192:207]
  v_perm_b32 v44, v102, v98, s42
  v_perm_b32 v45, v110, v106, s42
  v_perm_b32 v46, v118, v114, s42
  v_perm_b32 v47, v126, v122, s42
  s_nop 1
  v_mfma_f32_32x32x16_bf16 v[208:223], v[44:47], a[164:167], v[208:223]
  s_waitcnt vmcnt(4)
  buffer_load_dwordx4 v[92:95], v2, s[12:15], s45 offen offset:3072 nt
  v_perm_b32 v48, v103, v99, s41
  v_perm_b32 v49, v111, v107, s41
  v_perm_b32 v50, v119, v115, s41
  v_perm_b32 v51, v127, v123, s41
  s_nop 1
  v_mfma_f32_32x32x16_bf16 v[224:239], v[48:51], a[164:167], v[224:239]
  v_perm_b32 v52, v103, v99, s42
  v_perm_b32 v53, v111, v107, s42
  v_perm_b32 v54, v119, v115, s42
  v_perm_b32 v55, v127, v123, s42
  s_nop 1
  v_mfma_f32_32x32x16_bf16 v[240:255], v[52:55], a[164:167], v[240:255]
  s_waitcnt vmcnt(4)
  buffer_load_dwordx4 v[96:99], v2, s[12:15], s46 offen offset:0 nt
  s_waitcnt vmcnt(4)
  buffer_load_dwordx4 v[100:103], v2, s[12:15], s46 offen offset:1024 nt
  s_waitcnt vmcnt(5)
  s_cbranch_vccnz L_w42
  s_waitcnt vmcnt(4)
L_w42:
  buffer_load_dwordx4 v[104:107], v2, s[12:15], s46 offen offset:2048 nt
  s_waitcnt vmcnt(4)
  buffer_load_dwordx4 v[108:111], v2, s[12:15], s46 offen offset:3072 nt
  s_waitcnt vmcnt(4)
  buffer_load_dwordx4 v[112:115], v2, s[12:15], s47 offen offset:0 nt
  v_perm_b32 v40, v68, v64, s41
  v_perm_b32 v41, v76, v72, s41
  v_perm_b32 v42, v84, v80, s41
  v_perm_b32 v43, v92, v88, s41
  v_pk_mul_f32 v[128:129], v[128:129], v[20:21] op_sel:[0,1] op_sel_hi:[1,1]
  v_pk_mul_f32 v[130:131], v[130:131], v[20:21] op_sel:[0,1] op_sel_hi:[1,1]
  v_pk_mul_f32 v[132:133], v[132:133], v[20:21] op_sel:[0,1] op_sel_hi:[1,1]
  v_pk_mul_f32 v[134:135], v[134:135], v[20:21] op_sel:[0,1] op_sel_hi:[1,1]
  v_pk_mul_f32 v[136:137], v[136:137], v[20:21] op_sel:[0,1] op_sel_hi:[1,1]
  v_pk_mul_f32 v[138:139], v[138:139], v[20:21] op_sel:[0,1] op_sel_hi:[1,1]
  v_pk_mul_f32 v[140:141], v[140:141], v[20:21] op_sel:[0,1] op_sel_hi:[1,1]
  v_pk_mul_f32 v[142:143], v[142:143], v[20:21] op_sel:[0,1] op_sel_hi:[1,1]
  s_nop 1
  v_mfma_f32_32x32x16_bf16 v[128:143], v[40:43], a[168:171], v[128:143]
  v_perm_b32 v44, v68, v64, s42
  v_perm_b32 v45, v76, v72, s42
  v_perm_b32 v46, v84, v80, s42
  v_perm_b32 v47, v92, v88, s42
  v_pk_mul_f32 v[144:145], v[144:145], v[20:21] op_sel:[0,1] op_sel_hi:[1,1]
  v_pk_mul_f32 v[146:147], v[146:147], v[20:21] op_sel:[0,1] op_sel_hi:[1,1]
  v_pk_mul_f32 v[148:149], v[148:149], v[20:21] op_sel:[0,1] op_sel_hi:[1,1]
  v_pk_mul_f32 v[150:151], v[150:151], v[20:21] op_sel:[0,1] op_sel_hi:[1,1]
  v_pk_mul_f32 v[152:153], v[152:153], v[20:21] op_sel:[0,1] op_sel_hi:[1,1]
  v_pk_mul_f32 v[154:155], v[154:155], v[20:21] op_sel:[0,1] op_sel_hi:[1,1]
  v_pk_mul_f32 v[156:157], v[156:157], v[20:21] op_sel:[0,1] op_sel_hi:[1,1]
  v_pk_mul_f32 v[158:159], v[158:159], v[20:21] op_sel:[0,1] op_sel_hi:[1,1]
  s_nop 1
  v_mfma_f32_32x32x16_bf16 v[144:159], v[44:47], a[168:171], v[144:159]
  s_waitcnt vmcnt(4)
  buffer_load_dwordx4 v[116:119], v2, s[12:15], s47 offen offset:1024 nt
  v_perm_b32 v48, v69, v65, s41
  v_perm_b32 v49, v77, v73, s41
  v_perm_b32 v50, v85, v81, s41
  v_perm_b32 v51, v93, v89, s41
  v_pk_mul_f32 v[160:161], v[160:161], v[20:21] op_sel:[0,1] op_sel_hi:[1,1]
  v_pk_mul_f32 v[162:163], v[162:163], v[20:21] op_sel:[0,1] op_sel_hi:[1,1]
  v_pk_mul_f32 v[164:165], v[164:165], v[20:21] op_sel:[0,1] op_sel_hi:[1,1]
  v_pk_mul_f32 v[166:167], v[166:167], v[20:21] op_sel:[0,1] op_sel_hi:[1,1]
  v_pk_mul_f32 v[168:169], v[168:169], v[20:21] op_sel:[0,1] op_sel_hi:[1,1]
  v_pk_mul_f32 v[170:171], v[170:171], v[20:21] op_sel:[0,1] op_sel_hi:[1,1]
  v_pk_mul_f32 v[172:173], v[172:173], v[20:21] op_sel:[0,1] op_sel_hi:[1,1]
  v_pk_mul_f32 v[174:175], v[174:175], v[20:21] op_sel:[0,1] op_sel_hi:[1,1]
  s_nop 1
  v_mfma_f32_32x32x16_bf16 v[160:175], v[48:51], a[168:171], v[160:175]
  v_perm_b32 v52, v69, v65, s42
  v_perm_b32 v53, v77, v73, s42
  v_perm_b32 v54, v85, v81, s42
  v_perm_b32 v55, v93, v89, s42
  v_pk_mul_f32 v[176:177], v[176:177], v[20:21] op_sel:[0,1] op_sel_hi:[1,1]
  v_pk_mul_f32 v[178:179], v[178:179], v[20:21] op_sel:[0,1] op_sel_hi:[1,1]
  v_pk_mul_f32 v[180:181], v[180:181], v[20:21] op_sel:[0,1] op_sel_hi:[1,1]
  v_pk_mul_f32 v[182:183], v[182:183], v[20:21] op_sel:[0,1] op_sel_hi:[1,1]
  v_pk_mul_f32 v[184:185], v[184:185], v[20:21] op_sel:[0,1] op_sel_hi:[1,1]
  v_pk_mul_f32 v[186:187], v[186:187], v[20:21] op_sel:[0,1] op_sel_hi:[1,1]
  v_pk_mul_f32 v[188:189], v[188:189], v[20:21] op_sel:[0,1] op_sel_hi:[1,1]
  v_pk_mul_f32 v[190:191], v[190:191], v[20:21] op_sel:[0,1] op_sel_hi:[1,1]
  s_nop 1
  v_mfma_f32_32x32x16_bf16 v[176:191], v[52:55], a[168:171], v[176:191]
  s_waitcnt vmcnt(4)
  buffer_load_dwordx4 v[120:123], v2, s[12:15], s47 offen offset:2048 nt
  v_perm_b32 v40, v70, v66, s41
  v_perm_b32 v41, v78, v74, s41
  v_perm_b32 v42, v86, v82, s41
  v_perm_b32 v43, v94, v90, s41
  v_pk_mul_f32 v[192:193], v[192:193], v[20:21] op_sel:[0,1] op_sel_hi:[1,1]
  v_pk_mul_f32 v[194:195], v[194:195], v[20:21] op_sel:[0,1] op_sel_hi:[1,1]
  v_pk_mul_f32 v[196:197], v[196:197], v[20:21] op_sel:[0,1] op_sel_hi:[1,1]
  v_pk_mul_f32 v[198:199], v[198:199], v[20:21] op_sel:[0,1] op_sel_hi:[1,1]
  v_pk_mul_f32 v[200:201], v[200:201], v[20:21] op_sel:[0,1] op_sel_hi:[1,1]
  v_pk_mul_f32 v[202:203], v[202:203], v[20:21] op_sel:[0,1] op_sel_hi:[1,1]
  v_pk_mul_f32 v[204:205], v[204:205], v[20:21] op_sel:[0,1] op_sel_hi:[1,1]
  v_pk_mul_f32 v[206:207], v[206:207], v[20:21] op_sel:[0,1] op_sel_hi:[1,1]
  s_nop 1
  v_mfma_f32_32x32x16_bf16 v[192:207], v[40:43], a[168:171], v[192:207]
  v_perm_b32 v44, v70, v66, s42
  v_perm_b32 v45, v78, v74, s42
  v_perm_b32 v46, v86, v82, s42
  v_perm_b32 v47, v94, v90, s42
  v_pk_mul_f32 v[208:209], v[208:209], v[20:21] op_sel:[0,1] op_sel_hi:[1,1]
  v_pk_mul_f32 v[210:211], v[210:211], v[20:21] op_sel:[0,1] op_sel_hi:[1,1]
  v_pk_mul_f32 v[212:213], v[212:213], v[20:21] op_sel:[0,1] op_sel_hi:[1,1]
  v_pk_mul_f32 v[214:215], v[214:215], v[20:21] op_sel:[0,1] op_sel_hi:[1,1]
  v_pk_mul_f32 v[216:217], v[216:217], v[20:21] op_sel:[0,1] op_sel_hi:[1,1]
  v_pk_mul_f32 v[218:219], v[218:219], v[20:21] op_sel:[0,1] op_sel_hi:[1,1]
  v_pk_mul_f32 v[220:221], v[220:221], v[20:21] op_sel:[0,1] op_sel_hi:[1,1]
  v_pk_mul_f32 v[222:223], v[222:223], v[20:21] op_sel:[0,1] op_sel_hi:[1,1]
  s_nop 1
  v_mfma_f32_32x32x16_bf16 v[208:223], v[44:47], a[168:171], v[208:223]
  s_waitcnt vmcnt(4)
  buffer_load_dwordx4 v[124:127], v2, s[12:15], s47 offen offset:3072 nt
  v_perm_b32 v48, v71, v67, s41
  v_perm_b32 v49, v79, v75, s41
  v_perm_b32 v50, v87, v83, s41
  v_perm_b32 v51, v95, v91, s41
  v_pk_mul_f32 v[224:225], v[224:225], v[20:21] op_sel:[0,1] op_sel_hi:[1,1]
  v_pk_mul_f32 v[226:227], v[226:227], v[20:21] op_sel:[0,1] op_sel_hi:[1,1]
  v_pk_mul_f32 v[228:229], v[228:229], v[20:21] op_sel:[0,1] op_sel_hi:[1,1]
  v_pk_mul_f32 v[230:231], v[230:231], v[20:21] op_sel:[0,1] op_sel_hi:[1,1]
  v_pk_mul_f32 v[232:233], v[232:233], v[20:21] op_sel:[0,1] op_sel_hi:[1,1]
  v_pk_mul_f32 v[234:235], v[234:235], v[20:21] op_sel:[0,1] op_sel_hi:[1,1]
  v_pk_mul_f32 v[236:237], v[236:237], v[20:21] op_sel:[0,1] op_sel_hi:[1,1]
  v_pk_mul_f32 v[238:239], v[238:239], v[20:21] op_sel:[0,1] op_sel_hi:[1,1]
  s_nop 1
  v_mfma_f32_32x32x16_bf16 v[224:239], v[48:51], a[168:171], v[224:239]
  v_perm_b32 v52, v71, v67, s42
  v_perm_b32 v53, v79, v75, s42
  v_perm_b32 v54, v87, v83, s42
  v_perm_b32 v55, v95, v91, s42
  v_pk_mul_f32 v[240:241], v[240:241], v[20:21] op_sel:[0,1] op_sel_hi:[1,1]
  v_pk_mul_f32 v[242:243], v[242:243], v[20:21] op_sel:[0,1] op_sel_hi:[1,1]
  v_pk_mul_f32 v[244:245], v[244:245], v[20:21] op_sel:[0,1] op_sel_hi:[1,1]
  v_pk_mul_f32 v[246:247], v[246:247], v[20:21] op_sel:[0,1] op_sel_hi:[1,1]
  v_pk_mul_f32 v[248:249], v[248:249], v[20:21] op_sel:[0,1] op_sel_hi:[1,1]
  v_pk_mul_f32 v[250:251], v[250:251], v[20:21] op_sel:[0,1] op_sel_hi:[1,1]
  v_pk_mul_f32 v[252:253], v[252:253], v[20:21] op_sel:[0,1] op_sel_hi:[1,1]
  v_pk_mul_f32 v[254:255], v[254:255], v[20:21] op_sel:[0,1] op_sel_hi:[1,1]
  s_nop 1
  v_mfma_f32_32x32x16_bf16 v[240:255], v[52:55], a[168:171], v[240:255]
  s_add_u32 s44, s55, 393216
  s_add_u32 s45, s55, 409600
  s_add_u32 s46, s55, 425984
  s_add_u32 s47, s55, 442368
  s_waitcnt vmcnt(4)
  buffer_load_dwordx4 v[64:67], v2, s[12:15], s44 offen offset:0 nt
  s_waitcnt vmcnt(4)
  buffer_load_dwordx4 v[68:71], v2, s[12:15], s44 offen offset:1024 nt
  s_waitcnt vmcnt(5)
  s_cbranch_vccnz L_w43
  s_waitcnt vmcnt(4)
L_w43:
  buffer_load_dwordx4 v[72:75], v2, s[12:15], s44 offen offset:2048 nt
  s_waitcnt vmcnt(4)
  buffer_load_dwordx4 v[76:79], v2, s[12:15], s44 offen offset:3072 nt
  s_waitcnt vmcnt(4)
  buffer_load_dwordx4 v[80:83], v2, s[12:15], s45 offen offset:0 nt
  v_perm_b32 v40, v100, v96, s41
  v_perm_b32 v41, v108, v104, s41
  v_perm_b32 v42, v116, v112, s41
  v_perm_b32 v43, v124, v120, s41
  s_nop 1
  v_mfma_f32_32x32x16_bf16 v[128:143], v[40:43], a[172:175], v[128:143]
  v_perm_b32 v44, v100, v96, s42
  v_perm_b32 v45, v108, v104, s42
  v_perm_b32 v46, v116, v112, s42
  v_perm_b32 v47, v124, v120, s42
  s_nop 1
  v_mfma_f32_32x32x16_bf16 v[144:159], v[44:47], a[172:175], v[144:159]
  s_waitcnt vmcnt(4)
  buffer_load_dwordx4 v[84:87], v2, s[12:15], s45 offen offset:1024 nt
  v_perm_b32 v48, v101, v97, s41
  v_perm_b32 v49, v109, v105, s41
  v_perm_b32 v50, v117, v113, s41
  v_perm_b32 v51, v125, v121, s41
  s_nop 1
  v_mfma_f32_32x32x16_bf16 v[160:175], v[48:51], a[172:175], v[160:175]
  v_perm_b32 v52, v101, v97, s42
  v_perm_b32 v53, v109, v105, s42
  v_perm_b32 v54, v117, v113, s42
  v_perm_b32 v55, v125, v121, s42
  s_nop 1
  v_mfma_f32_32x32x16_bf16 v[176:191], v[52:55], a[172:175], v[176:191]
  s_waitcnt vmcnt(4)
  buffer_load_dwordx4 v[88:91], v2, s[12:15], s45 offen offset:2048 nt
  v_perm_b32 v40, v102, v98, s41
  v_perm_b32 v41, v110, v106, s41
  v_perm_b32 v42, v118, v114, s41
  v_perm_b32 v43, v126, v122, s41
  s_nop 1
  v_mfma_f32_32x32x16_bf16 v[192:207], v[40:43], a[172:175], v[192:207]
  v_perm_b32 v44, v102, v98, s42
  v_perm_b32 v45, v110, v106, s42
  v_perm_b32 v46, v118, v114, s42
  v_perm_b32 v47, v126, v122, s42
  s_nop 1
  v_mfma_f32_32x32x16_bf16 v[208:223], v[44:47], a[172:175], v[208:223]
  s_waitcnt vmcnt(4)
  buffer_load_dwordx4 v[92:95], v2, s[12:15], s45 offen offset:3072 nt
  v_perm_b32 v48, v103, v99, s41
  v_perm_b32 v49, v111, v107, s41
  v_perm_b32 v50, v119, v115, s41
  v_perm_b32 v51, v127, v123, s41
  s_nop 1
  v_mfma_f32_32x32x16_bf16 v[224:239], v[48:51], a[172:175], v[224:239]
  v_perm_b32 v52, v103, v99, s42
  v_perm_b32 v53, v111, v107, s42
  v_perm_b32 v54, v119, v115, s42
  v_perm_b32 v55, v127, v123, s42
  s_nop 1
  v_mfma_f32_32x32x16_bf16 v[240:255], v[52:55], a[172:175], v[240:255]
  s_waitcnt vmcnt(4)
  buffer_load_dwordx4 v[96:99], v2, s[12:15], s46 offen offset:0 nt
  s_waitcnt vmcnt(4)
  buffer_load_dwordx4 v[100:103], v2, s[12:15], s46 offen offset:1024 nt
  s_waitcnt vmcnt(5)
  s_cbranch_vccnz L_w44
  s_waitcnt vmcnt(4)
L_w44:
  buffer_load_dwordx4 v[104:107], v2, s[12:15], s46 offen offset:2048 nt
  s_waitcnt vmcnt(4)
  buffer_load_dwordx4 v[108:111], v2, s[12:15], s46 offen offset:3072 nt
  s_waitcnt vmcnt(4)
  buffer_load_dwordx4 v[112:115], v2, s[12:15], s47 offen offset:0 nt
  v_perm_b32 v40, v68, v64, s41
  v_perm_b32 v41, v76, v72, s41
  v_perm_b32 v42, v84, v80, s41
  v_perm_b32 v43, v92, v88, s41
  v_pk_mul_f32 v[128:129], v[128:129], v[22:23] op_sel_hi:[1,0]
  v_pk_mul_f32 v[130:131], v[130:131], v[22:23] op_sel_hi:[1,0]
  v_pk_mul_f32 v[132:133], v[132:133], v[22:23] op_sel_hi:[1,0]
  v_pk_mul_f32 v[134:135], v[134:135], v[22:23] op_sel_hi:[1,0]
  v_pk_mul_f32 v[136:137], v[136:137], v[22:23] op_sel_hi:[1,0]
  v_pk_mul_f32 v[138:139], v[138:139], v[22:23] op_sel_hi:[1,0]
  v_pk_mul_f32 v[140:141], v[140:141], v[22:23] op_sel_hi:[1,0]
  v_pk_mul_f32 v[142:143], v[142:143], v[22:23] op_sel_hi:[1,0]
  s_nop 1
  v_mfma_f32_32x32x16_bf16 v[128:143], v[40:43], a[176:179], v[128:143]
  v_perm_b32 v44, v68, v64, s42
  v_perm_b32 v45, v76, v72, s42
  v_perm_b32 v46, v84, v80, s42
  v_perm_b32 v47, v92, v88, s42
  v_pk_mul_f32 v[144:145], v[144:145], v[22:23] op_sel_hi:[1,0]
  v_pk_mul_f32 v[146:147], v[146:147], v[22:23] op_sel_hi:[1,0]
  v_pk_mul_f32 v[148:149], v[148:149], v[22:23] op_sel_hi:[1,0]
  v_pk_mul_f32 v[150:151], v[150:151], v[22:23] op_sel_hi:[1,0]
  v_pk_mul_f32 v[152:153], v[152:153], v[22:23] op_sel_hi:[1,0]
  v_pk_mul_f32 v[154:155], v[154:155], v[22:23] op_sel_hi:[1,0]
  v_pk_mul_f32 v[156:157], v[156:157], v[22:23] op_sel_hi:[1,0]
  v_pk_mul_f32 v[158:159], v[158:159], v[22:23] op_sel_hi:[1,0]
  s_nop 1
  v_mfma_f32_32x32x16_bf16 v[144:159], v[44:47], a[176:179], v[144:159]
  s_waitcnt vmcnt(4)
  buffer_load_dwordx4 v[116:119], v2, s[12:15], s47 offen offset:1024 nt
  v_perm_b32 v48, v69, v65, s41
  v_perm_b32 v49, v77, v73, s41
  v_perm_b32 v50, v85, v81, s41
  v_perm_b32 v51, v93, v89, s41
  v_pk_mul_f32 v[160:161], v[160:161], v[22:23] op_sel_hi:[1,0]
  v_pk_mul_f32 v[162:163], v[162:163], v[22:23] op_sel_hi:[1,0]
  v_pk_mul_f32 v[164:165], v[164:165], v[22:23] op_sel_hi:[1,0]
  v_pk_mul_f32 v[166:167], v[166:167], v[22:23] op_sel_hi:[1,0]
  v_pk_mul_f32 v[168:169], v[168:169], v[22:23] op_sel_hi:[1,0]
  v_pk_mul_f32 v[170:171], v[170:171], v[22:23] op_sel_hi:[1,0]
  v_pk_mul_f32 v[172:173], v[172:173], v[22:23] op_sel_hi:[1,0]
  v_pk_mul_f32 v[174:175], v[174:175], v[22:23] op_sel_hi:[1,0]
  s_nop 1
  v_mfma_f32_32x32x16_bf16 v[160:175], v[48:51], a[176:179], v[160:175]
  v_perm_b32 v52, v69, v65, s42
  v_perm_b32 v53, v77, v73, s42
  v_perm_b32 v54, v85, v81, s42
  v_perm_b32 v55, v93, v89, s42
  v_pk_mul_f32 v[176:177], v[176:177], v[22:23] op_sel_hi:[1,0]
  v_pk_mul_f32 v[178:179], v[178:179], v[22:23] op_sel_hi:[1,0]
  v_pk_mul_f32 v[180:181], v[180:181], v[22:23] op_sel_hi:[1,0]
  v_pk_mul_f32 v[182:183], v[182:183], v[22:23] op_sel_hi:[1,0]
  v_pk_mul_f32 v[184:185], v[184:185], v[22:23] op_sel_hi:[1,0]
  v_pk_mul_f32 v[186:187], v[186:187], v[22:23] op_sel_hi:[1,0]
  v_pk_mul_f32 v[188:189], v[188:189], v[22:23] op_sel_hi:[1,0]
  v_pk_mul_f32 v[190:191], v[190:191], v[22:23] op_sel_hi:[1,0]
  s_nop 1
  v_mfma_f32_32x32x16_bf16 v[176:191], v[52:55], a[176:179], v[176:191]
  s_waitcnt vmcnt(4)
  buffer_load_dwordx4 v[120:123], v2, s[12:15], s47 offen offset:2048 nt
  v_perm_b32 v40, v70, v66, s41
  v_perm_b32 v41, v78, v74, s41
  v_perm_b32 v42, v86, v82, s41
  v_perm_b32 v43, v94, v90, s41
  v_pk_mul_f32 v[192:193], v[192:193], v[22:23] op_sel_hi:[1,0]
  v_pk_mul_f32 v[194:195], v[194:195], v[22:23] op_sel_hi:[1,0]
  v_pk_mul_f32 v[196:197], v[196:197], v[22:23] op_sel_hi:[1,0]
  v_pk_mul_f32 v[198:199], v[198:199], v[22:23] op_sel_hi:[1,0]
  v_pk_mul_f32 v[200:201], v[200:201], v[22:23] op_sel_hi:[1,0]
  v_pk_mul_f32 v[202:203], v[202:203], v[22:23] op_sel_hi:[1,0]
  v_pk_mul_f32 v[204:205], v[204:205], v[22:23] op_sel_hi:[1,0]
  v_pk_mul_f32 v[206:207], v[206:207], v[22:23] op_sel_hi:[1,0]
  s_nop 1
  v_mfma_f32_32x32x16_bf16 v[192:207], v[40:43], a[176:179], v[192:207]
  v_perm_b32 v44, v70, v66, s42
  v_perm_b32 v45, v78, v74, s42
  v_perm_b32 v46, v86, v82, s42
  v_perm_b32 v47, v94, v90, s42
  v_pk_mul_f32 v[208:209], v[208:209], v[22:23] op_sel_hi:[1,0]
  v_pk_mul_f32 v[210:211], v[210:211], v[22:23] op_sel_hi:[1,0]
  v_pk_mul_f32 v[212:213], v[212:213], v[22:23] op_sel_hi:[1,0]
  v_pk_mul_f32 v[214:215], v[214:215], v[22:23] op_sel_hi:[1,0]
  v_pk_mul_f32 v[216:217], v[216:217], v[22:23] op_sel_hi:[1,0]
  v_pk_mul_f32 v[218:219], v[218:219], v[22:23] op_sel_hi:[1,0]
  v_pk_mul_f32 v[220:221], v[220:221], v[22:23] op_sel_hi:[1,0]
  v_pk_mul_f32 v[222:223], v[222:223], v[22:23] op_sel_hi:[1,0]
  s_nop 1
  v_mfma_f32_32x32x16_bf16 v[208:223], v[44:47], a[176:179], v[208:223]
  s_waitcnt vmcnt(4)
  buffer_load_dwordx4 v[124:127], v2, s[12:15], s47 offen offset:3072 nt
  v_perm_b32 v48, v71, v67, s41
  v_perm_b32 v49, v79, v75, s41
  v_perm_b32 v50, v87, v83, s41
  v_perm_b32 v51, v95, v91, s41
  v_pk_mul_f32 v[224:225], v[224:225], v[22:23] op_sel_hi:[1,0]
  v_pk_mul_f32 v[226:227], v[226:227], v[22:23] op_sel_hi:[1,0]
  v_pk_mul_f32 v[228:229], v[228:229], v[22:23] op_sel_hi:[1,0]
  v_pk_mul_f32 v[230:231], v[230:231], v[22:23] op_sel_hi:[1,0]
  v_pk_mul_f32 v[232:233], v[232:233], v[22:23] op_sel_hi:[1,0]
  v_pk_mul_f32 v[234:235], v[234:235], v[22:23] op_sel_hi:[1,0]
  v_pk_mul_f32 v[236:237], v[236:237], v[22:23] op_sel_hi:[1,0]
  v_pk_mul_f32 v[238:239], v[238:239], v[22:23] op_sel_hi:[1,0]
  s_nop 1
  v_mfma_f32_32x32x16_bf16 v[224:239], v[48:51], a[176:179], v[224:239]
  v_perm_b32 v52, v71, v67, s42
  v_perm_b32 v53, v79, v75, s42
  v_perm_b32 v54, v87, v83, s42
  v_perm_b32 v55, v95, v91, s42
  v_pk_mul_f32 v[240:241], v[240:241], v[22:23] op_sel_hi:[1,0]
  v_pk_mul_f32 v[242:243], v[242:243], v[22:23] op_sel_hi:[1,0]
  v_pk_mul_f32 v[244:245], v[244:245], v[22:23] op_sel_hi:[1,0]
  v_pk_mul_f32 v[246:247], v[246:247], v[22:23] op_sel_hi:[1,0]
  v_pk_mul_f32 v[248:249], v[248:249], v[22:23] op_sel_hi:[1,0]
  v_pk_mul_f32 v[250:251], v[250:251], v[22:23] op_sel_hi:[1,0]
  v_pk_mul_f32 v[252:253], v[252:253], v[22:23] op_sel_hi:[1,0]
  v_pk_mul_f32 v[254:255], v[254:255], v[22:23] op_sel_hi:[1,0]
  s_nop 1
  v_mfma_f32_32x32x16_bf16 v[240:255], v[52:55], a[176:179], v[240:255]
  s_add_u32 s44, s55, 458752
  s_add_u32 s45, s55, 475136
  s_add_u32 s46, s55, 491520
  s_add_u32 s47, s55, 507904
  s_waitcnt vmcnt(4)
  buffer_load_dwordx4 v[64:67], v2, s[12:15], s44 offen offset:0 nt
  s_waitcnt vmcnt(4)
  buffer_load_dwordx4 v[68:71], v2, s[12:15], s44 offen offset:1024 nt
  s_waitcnt vmcnt(5)
  s_cbranch_vccnz L_w45
  s_waitcnt vmcnt(4)
L_w45:
  buffer_load_dwordx4 v[72:75], v2, s[12:15], s44 offen offset:2048 nt
  s_waitcnt vmcnt(4)
  buffer_load_dwordx4 v[76:79], v2, s[12:15], s44 offen offset:3072 nt
  s_waitcnt vmcnt(4)
  buffer_load_dwordx4 v[80:83], v2, s[12:15], s45 offen offset:0 nt
  v_perm_b32 v40, v100, v96, s41
  v_perm_b32 v41, v108, v104, s41
  v_perm_b32 v42, v116, v112, s41
  v_perm_b32 v43, v124, v120, s41
  s_nop 1
  v_mfma_f32_32x32x16_bf16 v[128:143], v[40:43], a[180:183], v[128:143]
  v_perm_b32 v44, v100, v96, s42
  v_perm_b32 v45, v108, v104, s42
  v_perm_b32 v46, v116, v112, s42
  v_perm_b32 v47, v124, v120, s42
  s_nop 1
  v_mfma_f32_32x32x16_bf16 v[144:159], v[44:47], a[180:183], v[144:159]
  s_waitcnt vmcnt(4)
  buffer_load_dwordx4 v[84:87], v2, s[12:15], s45 offen offset:1024 nt
  v_perm_b32 v48, v101, v97, s41
  v_perm_b32 v49, v109, v105, s41
  v_perm_b32 v50, v117, v113, s41
  v_perm_b32 v51, v125, v121, s41
  s_nop 1
  v_mfma_f32_32x32x16_bf16 v[160:175], v[48:51], a[180:183], v[160:175]
  v_perm_b32 v52, v101, v97, s42
  v_perm_b32 v53, v109, v105, s42
  v_perm_b32 v54, v117, v113, s42
  v_perm_b32 v55, v125, v121, s42
  s_nop 1
  v_mfma_f32_32x32x16_bf16 v[176:191], v[52:55], a[180:183], v[176:191]
  s_waitcnt vmcnt(4)
  buffer_load_dwordx4 v[88:91], v2, s[12:15], s45 offen offset:2048 nt
  v_perm_b32 v40, v102, v98, s41
  v_perm_b32 v41, v110, v106, s41
  v_perm_b32 v42, v118, v114, s41
  v_perm_b32 v43, v126, v122, s41
  s_nop 1
  v_mfma_f32_32x32x16_bf16 v[192:207], v[40:43], a[180:183], v[192:207]
  v_perm_b32 v44, v102, v98, s42
  v_perm_b32 v45, v110, v106, s42
  v_perm_b32 v46, v118, v114, s42
  v_perm_b32 v47, v126, v122, s42
  s_nop 1
  v_mfma_f32_32x32x16_bf16 v[208:223], v[44:47], a[180:183], v[208:223]
  s_waitcnt vmcnt(4)
  buffer_load_dwordx4 v[92:95], v2, s[12:15], s45 offen offset:3072 nt
  v_perm_b32 v48, v103, v99, s41
  v_perm_b32 v49, v111, v107, s41
  v_perm_b32 v50, v119, v115, s41
  v_perm_b32 v51, v127, v123, s41
  s_nop 1
  v_mfma_f32_32x32x16_bf16 v[224:239], v[48:51], a[180:183], v[224:239]
  v_perm_b32 v52, v103, v99, s42
  v_perm_b32 v53, v111, v107, s42
  v_perm_b32 v54, v119, v115, s42
  v_perm_b32 v55, v127, v123, s42
  s_nop 1
  v_mfma_f32_32x32x16_bf16 v[240:255], v[52:55], a[180:183], v[240:255]
  s_waitcnt vmcnt(4)
  buffer_load_dwordx4 v[96:99], v2, s[12:15], s46 offen offset:0 nt
  s_waitcnt vmcnt(4)
  buffer_load_dwordx4 v[100:103], v2, s[12:15], s46 offen offset:1024 nt
  s_waitcnt vmcnt(5)
  s_cbranch_vccnz L_w46
  s_waitcnt vmcnt(4)
L_w46:
  buffer_load_dwordx4 v[104:107], v2, s[12:15], s46 offen offset:2048 nt
  s_waitcnt vmcnt(4)
  buffer_load_dwordx4 v[108:111], v2, s[12:15], s46 offen offset:3072 nt
  s_waitcnt vmcnt(4)
  buffer_load_dwordx4 v[112:115], v2, s[12:15], s47 offen offset:0 nt
  v_perm_b32 v40, v68, v64, s41
  v_perm_b32 v41, v76, v72, s41
  v_perm_b32 v42, v84, v80, s41
  v_perm_b32 v43, v92, v88, s41
  v_pk_mul_f32 v[128:129], v[128:129], v[22:23] op_sel:[0,1] op_sel_hi:[1,1]
  v_pk_mul_f32 v[130:131], v[130:131], v[22:23] op_sel:[0,1] op_sel_hi:[1,1]
  v_pk_mul_f32 v[132:133], v[132:133], v[22:23] op_sel:[0,1] op_sel_hi:[1,1]
  v_pk_mul_f32 v[134:135], v[134:135], v[22:23] op_sel:[0,1] op_sel_hi:[1,1]
  v_pk_mul_f32 v[136:137], v[136:137], v[22:23] op_sel:[0,1] op_sel_hi:[1,1]
  v_pk_mul_f32 v[138:139], v[138:139], v[22:23] op_sel:[0,1] op_sel_hi:[1,1]
  v_pk_mul_f32 v[140:141], v[140:141], v[22:23] op_sel:[0,1] op_sel_hi:[1,1]
  v_pk_mul_f32 v[142:143], v[142:143], v[22:23] op_sel:[0,1] op_sel_hi:[1,1]
  s_nop 1
  v_mfma_f32_32x32x16_bf16 v[128:143], v[40:43], a[184:187], v[128:143]
  v_perm_b32 v44, v68, v64, s42
  v_perm_b32 v45, v76, v72, s42
  v_perm_b32 v46, v84, v80, s42
  v_perm_b32 v47, v92, v88, s42
  v_pk_mul_f32 v[144:145], v[144:145], v[22:23] op_sel:[0,1] op_sel_hi:[1,1]
  v_pk_mul_f32 v[146:147], v[146:147], v[22:23] op_sel:[0,1] op_sel_hi:[1,1]
  v_pk_mul_f32 v[148:149], v[148:149], v[22:23] op_sel:[0,1] op_sel_hi:[1,1]
  v_pk_mul_f32 v[150:151], v[150:151], v[22:23] op_sel:[0,1] op_sel_hi:[1,1]
  v_pk_mul_f32 v[152:153], v[152:153], v[22:23] op_sel:[0,1] op_sel_hi:[1,1]
  v_pk_mul_f32 v[154:155], v[154:155], v[22:23] op_sel:[0,1] op_sel_hi:[1,1]
  v_pk_mul_f32 v[156:157], v[156:157], v[22:23] op_sel:[0,1] op_sel_hi:[1,1]
  v_pk_mul_f32 v[158:159], v[158:159], v[22:23] op_sel:[0,1] op_sel_hi:[1,1]
  s_nop 1
  v_mfma_f32_32x32x16_bf16 v[144:159], v[44:47], a[184:187], v[144:159]
  s_waitcnt vmcnt(4)
  buffer_load_dwordx4 v[116:119], v2, s[12:15], s47 offen offset:1024 nt
  v_perm_b32 v48, v69, v65, s41
  v_perm_b32 v49, v77, v73, s41
  v_perm_b32 v50, v85, v81, s41
  v_perm_b32 v51, v93, v89, s41
  v_pk_mul_f32 v[160:161], v[160:161], v[22:23] op_sel:[0,1] op_sel_hi:[1,1]
  v_pk_mul_f32 v[162:163], v[162:163], v[22:23] op_sel:[0,1] op_sel_hi:[1,1]
  v_pk_mul_f32 v[164:165], v[164:165], v[22:23] op_sel:[0,1] op_sel_hi:[1,1]
  v_pk_mul_f32 v[166:167], v[166:167], v[22:23] op_sel:[0,1] op_sel_hi:[1,1]
  v_pk_mul_f32 v[168:169], v[168:169], v[22:23] op_sel:[0,1] op_sel_hi:[1,1]
  v_pk_mul_f32 v[170:171], v[170:171], v[22:23] op_sel:[0,1] op_sel_hi:[1,1]
  v_pk_mul_f32 v[172:173], v[172:173], v[22:23] op_sel:[0,1] op_sel_hi:[1,1]
  v_pk_mul_f32 v[174:175], v[174:175], v[22:23] op_sel:[0,1] op_sel_hi:[1,1]
  s_nop 1
  v_mfma_f32_32x32x16_bf16 v[160:175], v[48:51], a[184:187], v[160:175]
  v_perm_b32 v52, v69, v65, s42
  v_perm_b32 v53, v77, v73, s42
  v_perm_b32 v54, v85, v81, s42
  v_perm_b32 v55, v93, v89, s42
  v_pk_mul_f32 v[176:177], v[176:177], v[22:23] op_sel:[0,1] op_sel_hi:[1,1]
  v_pk_mul_f32 v[178:179], v[178:179], v[22:23] op_sel:[0,1] op_sel_hi:[1,1]
  v_pk_mul_f32 v[180:181], v[180:181], v[22:23] op_sel:[0,1] op_sel_hi:[1,1]
  v_pk_mul_f32 v[182:183], v[182:183], v[22:23] op_sel:[0,1] op_sel_hi:[1,1]
  v_pk_mul_f32 v[184:185], v[184:185], v[22:23] op_sel:[0,1] op_sel_hi:[1,1]
  v_pk_mul_f32 v[186:187], v[186:187], v[22:23] op_sel:[0,1] op_sel_hi:[1,1]
  v_pk_mul_f32 v[188:189], v[188:189], v[22:23] op_sel:[0,1] op_sel_hi:[1,1]
  v_pk_mul_f32 v[190:191], v[190:191], v[22:23] op_sel:[0,1] op_sel_hi:[1,1]
  s_nop 1
  v_mfma_f32_32x32x16_bf16 v[176:191], v[52:55], a[184:187], v[176:191]
  s_waitcnt vmcnt(4)
  buffer_load_dwordx4 v[120:123], v2, s[12:15], s47 offen offset:2048 nt
  v_perm_b32 v40, v70, v66, s41
  v_perm_b32 v41, v78, v74, s41
  v_perm_b32 v42, v86, v82, s41
  v_perm_b32 v43, v94, v90, s41
  v_pk_mul_f32 v[192:193], v[192:193], v[22:23] op_sel:[0,1] op_sel_hi:[1,1]
  v_pk_mul_f32 v[194:195], v[194:195], v[22:23] op_sel:[0,1] op_sel_hi:[1,1]
  v_pk_mul_f32 v[196:197], v[196:197], v[22:23] op_sel:[0,1] op_sel_hi:[1,1]
  v_pk_mul_f32 v[198:199], v[198:199], v[22:23] op_sel:[0,1] op_sel_hi:[1,1]
  v_pk_mul_f32 v[200:201], v[200:201], v[22:23] op_sel:[0,1] op_sel_hi:[1,1]
  v_pk_mul_f32 v[202:203], v[202:203], v[22:23] op_sel:[0,1] op_sel_hi:[1,1]
  v_pk_mul_f32 v[204:205], v[204:205], v[22:23] op_sel:[0,1] op_sel_hi:[1,1]
  v_pk_mul_f32 v[206:207], v[206:207], v[22:23] op_sel:[0,1] op_sel_hi:[1,1]
  s_nop 1
  v_mfma_f32_32x32x16_bf16 v[192:207], v[40:43], a[184:187], v[192:207]
  v_perm_b32 v44, v70, v66, s42
  v_perm_b32 v45, v78, v74, s42
  v_perm_b32 v46, v86, v82, s42
  v_perm_b32 v47, v94, v90, s42
  v_pk_mul_f32 v[208:209], v[208:209], v[22:23] op_sel:[0,1] op_sel_hi:[1,1]
  v_pk_mul_f32 v[210:211], v[210:211], v[22:23] op_sel:[0,1] op_sel_hi:[1,1]
  v_pk_mul_f32 v[212:213], v[212:213], v[22:23] op_sel:[0,1] op_sel_hi:[1,1]
  v_pk_mul_f32 v[214:215], v[214:215], v[22:23] op_sel:[0,1] op_sel_hi:[1,1]
  v_pk_mul_f32 v[216:217], v[216:217], v[22:23] op_sel:[0,1] op_sel_hi:[1,1]
  v_pk_mul_f32 v[218:219], v[218:219], v[22:23] op_sel:[0,1] op_sel_hi:[1,1]
  v_pk_mul_f32 v[220:221], v[220:221], v[22:23] op_sel:[0,1] op_sel_hi:[1,1]
  v_pk_mul_f32 v[222:223], v[222:223], v[22:23] op_sel:[0,1] op_sel_hi:[1,1]
  s_nop 1
  v_mfma_f32_32x32x16_bf16 v[208:223], v[44:47], a[184:187], v[208:223]
  s_waitcnt vmcnt(4)
  buffer_load_dwordx4 v[124:127], v2, s[12:15], s47 offen offset:3072 nt
  v_perm_b32 v48, v71, v67, s41
  v_perm_b32 v49, v79, v75, s41
  v_perm_b32 v50, v87, v83, s41
  v_perm_b32 v51, v95, v91, s41
  v_pk_mul_f32 v[224:225], v[224:225], v[22:23] op_sel:[0,1] op_sel_hi:[1,1]
  v_pk_mul_f32 v[226:227], v[226:227], v[22:23] op_sel:[0,1] op_sel_hi:[1,1]
  v_pk_mul_f32 v[228:229], v[228:229], v[22:23] op_sel:[0,1] op_sel_hi:[1,1]
  v_pk_mul_f32 v[230:231], v[230:231], v[22:23] op_sel:[0,1] op_sel_hi:[1,1]
  v_pk_mul_f32 v[232:233], v[232:233], v[22:23] op_sel:[0,1] op_sel_hi:[1,1]
  v_pk_mul_f32 v[234:235], v[234:235], v[22:23] op_sel:[0,1] op_sel_hi:[1,1]
  v_pk_mul_f32 v[236:237], v[236:237], v[22:23] op_sel:[0,1] op_sel_hi:[1,1]
  v_pk_mul_f32 v[238:239], v[238:239], v[22:23] op_sel:[0,1] op_sel_hi:[1,1]
  s_nop 1
  v_mfma_f32_32x32x16_bf16 v[224:239], v[48:51], a[184:187], v[224:239]
  v_perm_b32 v52, v71, v67, s42
  v_perm_b32 v53, v79, v75, s42
  v_perm_b32 v54, v87, v83, s42
  v_perm_b32 v55, v95, v91, s42
  v_pk_mul_f32 v[240:241], v[240:241], v[22:23] op_sel:[0,1] op_sel_hi:[1,1]
  v_pk_mul_f32 v[242:243], v[242:243], v[22:23] op_sel:[0,1] op_sel_hi:[1,1]
  v_pk_mul_f32 v[244:245], v[244:245], v[22:23] op_sel:[0,1] op_sel_hi:[1,1]
  v_pk_mul_f32 v[246:247], v[246:247], v[22:23] op_sel:[0,1] op_sel_hi:[1,1]
  v_pk_mul_f32 v[248:249], v[248:249], v[22:23] op_sel:[0,1] op_sel_hi:[1,1]
  v_pk_mul_f32 v[250:251], v[250:251], v[22:23] op_sel:[0,1] op_sel_hi:[1,1]
  v_pk_mul_f32 v[252:253], v[252:253], v[22:23] op_sel:[0,1] op_sel_hi:[1,1]
  v_pk_mul_f32 v[254:255], v[254:255], v[22:23] op_sel:[0,1] op_sel_hi:[1,1]
  s_nop 1
  v_mfma_f32_32x32x16_bf16 v[240:255], v[52:55], a[184:187], v[240:255]
  s_add_u32 s44, s55, 524288
  s_add_u32 s45, s55, 540672
  s_add_u32 s46, s55, 557056
  s_add_u32 s47, s55, 573440
  s_waitcnt vmcnt(4)
  buffer_load_dwordx4 v[64:67], v2, s[12:15], s44 offen offset:0 nt
  s_waitcnt vmcnt(4)
  buffer_load_dwordx4 v[68:71], v2, s[12:15], s44 offen offset:1024 nt
  s_waitcnt vmcnt(5)
  s_cbranch_vccnz L_w47
  s_waitcnt vmcnt(4)
L_w47:
  buffer_load_dwordx4 v[72:75], v2, s[12:15], s44 offen offset:2048 nt
  s_waitcnt vmcnt(4)
  buffer_load_dwordx4 v[76:79], v2, s[12:15], s44 offen offset:3072 nt
  s_waitcnt vmcnt(4)
  buffer_load_dwordx4 v[80:83], v2, s[12:15], s45 offen offset:0 nt
  v_perm_b32 v40, v100, v96, s41
  v_perm_b32 v41, v108, v104, s41
  v_perm_b32 v42, v116, v112, s41
  v_perm_b32 v43, v124, v120, s41
  s_nop 1
  v_mfma_f32_32x32x16_bf16 v[128:143], v[40:43], a[188:191], v[128:143]
  v_perm_b32 v44, v100, v96, s42
  v_perm_b32 v45, v108, v104, s42
  v_perm_b32 v46, v116, v112, s42
  v_perm_b32 v47, v124, v120, s42
  s_nop 1
  v_mfma_f32_32x32x16_bf16 v[144:159], v[44:47], a[188:191], v[144:159]
  s_waitcnt vmcnt(4)
  buffer_load_dwordx4 v[84:87], v2, s[12:15], s45 offen offset:1024 nt
  v_perm_b32 v48, v101, v97, s41
  v_perm_b32 v49, v109, v105, s41
  v_perm_b32 v50, v117, v113, s41
  v_perm_b32 v51, v125, v121, s41
  s_nop 1
  v_mfma_f32_32x32x16_bf16 v[160:175], v[48:51], a[188:191], v[160:175]
  v_perm_b32 v52, v101, v97, s42
  v_perm_b32 v53, v109, v105, s42
  v_perm_b32 v54, v117, v113, s42
  v_perm_b32 v55, v125, v121, s42
  s_nop 1
  v_mfma_f32_32x32x16_bf16 v[176:191], v[52:55], a[188:191], v[176:191]
  s_waitcnt vmcnt(4)
  buffer_load_dwordx4 v[88:91], v2, s[12:15], s45 offen offset:2048 nt
  v_perm_b32 v40, v102, v98, s41
  v_perm_b32 v41, v110, v106, s41
  v_perm_b32 v42, v118, v114, s41
  v_perm_b32 v43, v126, v122, s41
  s_nop 1
  v_mfma_f32_32x32x16_bf16 v[192:207], v[40:43], a[188:191], v[192:207]
  v_perm_b32 v44, v102, v98, s42
  v_perm_b32 v45, v110, v106, s42
  v_perm_b32 v46, v118, v114, s42
  v_perm_b32 v47, v126, v122, s42
  s_nop 1
  v_mfma_f32_32x32x16_bf16 v[208:223], v[44:47], a[188:191], v[208:223]
  s_waitcnt vmcnt(4)
  buffer_load_dwordx4 v[92:95], v2, s[12:15], s45 offen offset:3072 nt
  v_perm_b32 v48, v103, v99, s41
  v_perm_b32 v49, v111, v107, s41
  v_perm_b32 v50, v119, v115, s41
  v_perm_b32 v51, v127, v123, s41
  s_nop 1
  v_mfma_f32_32x32x16_bf16 v[224:239], v[48:51], a[188:191], v[224:239]
  v_perm_b32 v52, v103, v99, s42
  v_perm_b32 v53, v111, v107, s42
  v_perm_b32 v54, v119, v115, s42
  v_perm_b32 v55, v127, v123, s42
  s_nop 1
  v_mfma_f32_32x32x16_bf16 v[240:255], v[52:55], a[188:191], v[240:255]
  s_waitcnt vmcnt(4)
  buffer_load_dwordx4 v[96:99], v2, s[12:15], s46 offen offset:0 nt
  s_waitcnt vmcnt(4)
  buffer_load_dwordx4 v[100:103], v2, s[12:15], s46 offen offset:1024 nt
  s_waitcnt vmcnt(5)
  s_cbranch_vccnz L_w48
  s_waitcnt vmcnt(4)
L_w48:
  buffer_load_dwordx4 v[104:107], v2, s[12:15], s46 offen offset:2048 nt
  s_waitcnt vmcnt(4)
  buffer_load_dwordx4 v[108:111], v2, s[12:15], s46 offen offset:3072 nt
  s_waitcnt vmcnt(4)
  buffer_load_dwordx4 v[112:115], v2, s[12:15], s47 offen offset:0 nt
  v_perm_b32 v40, v68, v64, s41
  v_perm_b32 v41, v76, v72, s41
  v_perm_b32 v42, v84, v80, s41
  v_perm_b32 v43, v92, v88, s41
  v_pk_mul_f32 v[128:129], v[128:129], v[24:25] op_sel_hi:[1,0]
  v_pk_mul_f32 v[130:131], v[130:131], v[24:25] op_sel_hi:[1,0]
  v_pk_mul_f32 v[132:133], v[132:133], v[24:25] op_sel_hi:[1,0]
  v_pk_mul_f32 v[134:135], v[134:135], v[24:25] op_sel_hi:[1,0]
  v_pk_mul_f32 v[136:137], v[136:137], v[24:25] op_sel_hi:[1,0]
  v_pk_mul_f32 v[138:139], v[138:139], v[24:25] op_sel_hi:[1,0]
  v_pk_mul_f32 v[140:141], v[140:141], v[24:25] op_sel_hi:[1,0]
  v_pk_mul_f32 v[142:143], v[142:143], v[24:25] op_sel_hi:[1,0]
  s_nop 1
  v_mfma_f32_32x32x16_bf16 v[128:143], v[40:43], a[192:195], v[128:143]
  v_perm_b32 v44, v68, v64, s42
  v_perm_b32 v45, v76, v72, s42
  v_perm_b32 v46, v84, v80, s42
  v_perm_b32 v47, v92, v88, s42
  v_pk_mul_f32 v[144:145], v[144:145], v[24:25] op_sel_hi:[1,0]
  v_pk_mul_f32 v[146:147], v[146:147], v[24:25] op_sel_hi:[1,0]
  v_pk_mul_f32 v[148:149], v[148:149], v[24:25] op_sel_hi:[1,0]
  v_pk_mul_f32 v[150:151], v[150:151], v[24:25] op_sel_hi:[1,0]
  v_pk_mul_f32 v[152:153], v[152:153], v[24:25] op_sel_hi:[1,0]
  v_pk_mul_f32 v[154:155], v[154:155], v[24:25] op_sel_hi:[1,0]
  v_pk_mul_f32 v[156:157], v[156:157], v[24:25] op_sel_hi:[1,0]
  v_pk_mul_f32 v[158:159], v[158:159], v[24:25] op_sel_hi:[1,0]
  s_nop 1
  v_mfma_f32_32x32x16_bf16 v[144:159], v[44:47], a[192:195], v[144:159]
  s_waitcnt vmcnt(4)
  buffer_load_dwordx4 v[116:119], v2, s[12:15], s47 offen offset:1024 nt
  v_perm_b32 v48, v69, v65, s41
  v_perm_b32 v49, v77, v73, s41
  v_perm_b32 v50, v85, v81, s41
  v_perm_b32 v51, v93, v89, s41
  v_pk_mul_f32 v[160:161], v[160:161], v[24:25] op_sel_hi:[1,0]
  v_pk_mul_f32 v[162:163], v[162:163], v[24:25] op_sel_hi:[1,0]
  v_pk_mul_f32 v[164:165], v[164:165], v[24:25] op_sel_hi:[1,0]
  v_pk_mul_f32 v[166:167], v[166:167], v[24:25] op_sel_hi:[1,0]
  v_pk_mul_f32 v[168:169], v[168:169], v[24:25] op_sel_hi:[1,0]
  v_pk_mul_f32 v[170:171], v[170:171], v[24:25] op_sel_hi:[1,0]
  v_pk_mul_f32 v[172:173], v[172:173], v[24:25] op_sel_hi:[1,0]
  v_pk_mul_f32 v[174:175], v[174:175], v[24:25] op_sel_hi:[1,0]
  s_nop 1
  v_mfma_f32_32x32x16_bf16 v[160:175], v[48:51], a[192:195], v[160:175]
  v_perm_b32 v52, v69, v65, s42
  v_perm_b32 v53, v77, v73, s42
  v_perm_b32 v54, v85, v81, s42
  v_perm_b32 v55, v93, v89, s42
  v_pk_mul_f32 v[176:177], v[176:177], v[24:25] op_sel_hi:[1,0]
  v_pk_mul_f32 v[178:179], v[178:179], v[24:25] op_sel_hi:[1,0]
  v_pk_mul_f32 v[180:181], v[180:181], v[24:25] op_sel_hi:[1,0]
  v_pk_mul_f32 v[182:183], v[182:183], v[24:25] op_sel_hi:[1,0]
  v_pk_mul_f32 v[184:185], v[184:185], v[24:25] op_sel_hi:[1,0]
  v_pk_mul_f32 v[186:187], v[186:187], v[24:25] op_sel_hi:[1,0]
  v_pk_mul_f32 v[188:189], v[188:189], v[24:25] op_sel_hi:[1,0]
  v_pk_mul_f32 v[190:191], v[190:191], v[24:25] op_sel_hi:[1,0]
  s_nop 1
  v_mfma_f32_32x32x16_bf16 v[176:191], v[52:55], a[192:195], v[176:191]
  s_waitcnt vmcnt(4)
  buffer_load_dwordx4 v[120:123], v2, s[12:15], s47 offen offset:2048 nt
  v_perm_b32 v40, v70, v66, s41
  v_perm_b32 v41, v78, v74, s41
  v_perm_b32 v42, v86, v82, s41
  v_perm_b32 v43, v94, v90, s41
  v_pk_mul_f32 v[192:193], v[192:193], v[24:25] op_sel_hi:[1,0]
  v_pk_mul_f32 v[194:195], v[194:195], v[24:25] op_sel_hi:[1,0]
  v_pk_mul_f32 v[196:197], v[196:197], v[24:25] op_sel_hi:[1,0]
  v_pk_mul_f32 v[198:199], v[198:199], v[24:25] op_sel_hi:[1,0]
  v_pk_mul_f32 v[200:201], v[200:201], v[24:25] op_sel_hi:[1,0]
  v_pk_mul_f32 v[202:203], v[202:203], v[24:25] op_sel_hi:[1,0]
  v_pk_mul_f32 v[204:205], v[204:205], v[24:25] op_sel_hi:[1,0]
  v_pk_mul_f32 v[206:207], v[206:207], v[24:25] op_sel_hi:[1,0]
  s_nop 1
  v_mfma_f32_32x32x16_bf16 v[192:207], v[40:43], a[192:195], v[192:207]
  v_perm_b32 v44, v70, v66, s42
  v_perm_b32 v45, v78, v74, s42
  v_perm_b32 v46, v86, v82, s42
  v_perm_b32 v47, v94, v90, s42
  v_pk_mul_f32 v[208:209], v[208:209], v[24:25] op_sel_hi:[1,0]
  v_pk_mul_f32 v[210:211], v[210:211], v[24:25] op_sel_hi:[1,0]
  v_pk_mul_f32 v[212:213], v[212:213], v[24:25] op_sel_hi:[1,0]
  v_pk_mul_f32 v[214:215], v[214:215], v[24:25] op_sel_hi:[1,0]
  v_pk_mul_f32 v[216:217], v[216:217], v[24:25] op_sel_hi:[1,0]
  v_pk_mul_f32 v[218:219], v[218:219], v[24:25] op_sel_hi:[1,0]
  v_pk_mul_f32 v[220:221], v[220:221], v[24:25] op_sel_hi:[1,0]
  v_pk_mul_f32 v[222:223], v[222:223], v[24:25] op_sel_hi:[1,0]
  s_nop 1
  v_mfma_f32_32x32x16_bf16 v[208:223], v[44:47], a[192:195], v[208:223]
  s_waitcnt vmcnt(4)
  buffer_load_dwordx4 v[124:127], v2, s[12:15], s47 offen offset:3072 nt
  v_perm_b32 v48, v71, v67, s41
  v_perm_b32 v49, v79, v75, s41
  v_perm_b32 v50, v87, v83, s41
  v_perm_b32 v51, v95, v91, s41
  v_pk_mul_f32 v[224:225], v[224:225], v[24:25] op_sel_hi:[1,0]
  v_pk_mul_f32 v[226:227], v[226:227], v[24:25] op_sel_hi:[1,0]
  v_pk_mul_f32 v[228:229], v[228:229], v[24:25] op_sel_hi:[1,0]
  v_pk_mul_f32 v[230:231], v[230:231], v[24:25] op_sel_hi:[1,0]
  v_pk_mul_f32 v[232:233], v[232:233], v[24:25] op_sel_hi:[1,0]
  v_pk_mul_f32 v[234:235], v[234:235], v[24:25] op_sel_hi:[1,0]
  v_pk_mul_f32 v[236:237], v[236:237], v[24:25] op_sel_hi:[1,0]
  v_pk_mul_f32 v[238:239], v[238:239], v[24:25] op_sel_hi:[1,0]
  s_nop 1
  v_mfma_f32_32x32x16_bf16 v[224:239], v[48:51], a[192:195], v[224:239]
  v_perm_b32 v52, v71, v67, s42
  v_perm_b32 v53, v79, v75, s42
  v_perm_b32 v54, v87, v83, s42
  v_perm_b32 v55, v95, v91, s42
  v_pk_mul_f32 v[240:241], v[240:241], v[24:25] op_sel_hi:[1,0]
  v_pk_mul_f32 v[242:243], v[242:243], v[24:25] op_sel_hi:[1,0]
  v_pk_mul_f32 v[244:245], v[244:245], v[24:25] op_sel_hi:[1,0]
  v_pk_mul_f32 v[246:247], v[246:247], v[24:25] op_sel_hi:[1,0]
  v_pk_mul_f32 v[248:249], v[248:249], v[24:25] op_sel_hi:[1,0]
  v_pk_mul_f32 v[250:251], v[250:251], v[24:25] op_sel_hi:[1,0]
  v_pk_mul_f32 v[252:253], v[252:253], v[24:25] op_sel_hi:[1,0]
  v_pk_mul_f32 v[254:255], v[254:255], v[24:25] op_sel_hi:[1,0]
  s_nop 1
  v_mfma_f32_32x32x16_bf16 v[240:255], v[52:55], a[192:195], v[240:255]
  s_add_u32 s44, s55, 589824
  s_add_u32 s45, s55, 606208
  s_add_u32 s46, s55, 622592
  s_add_u32 s47, s55, 638976
  s_waitcnt vmcnt(4)
  buffer_load_dwordx4 v[64:67], v2, s[12:15], s44 offen offset:0 nt
  s_waitcnt vmcnt(4)
  buffer_load_dwordx4 v[68:71], v2, s[12:15], s44 offen offset:1024 nt
  s_waitcnt vmcnt(5)
  s_cbranch_vccnz L_w49
  s_waitcnt vmcnt(4)
L_w49:
  buffer_load_dwordx4 v[72:75], v2, s[12:15], s44 offen offset:2048 nt
  s_waitcnt vmcnt(4)
  buffer_load_dwordx4 v[76:79], v2, s[12:15], s44 offen offset:3072 nt
  s_waitcnt vmcnt(4)
  buffer_load_dwordx4 v[80:83], v2, s[12:15], s45 offen offset:0 nt
  v_perm_b32 v40, v100, v96, s41
  v_perm_b32 v41, v108, v104, s41
  v_perm_b32 v42, v116, v112, s41
  v_perm_b32 v43, v124, v120, s41
  s_nop 1
  v_mfma_f32_32x32x16_bf16 v[128:143], v[40:43], a[196:199], v[128:143]
  v_perm_b32 v44, v100, v96, s42
  v_perm_b32 v45, v108, v104, s42
  v_perm_b32 v46, v116, v112, s42
  v_perm_b32 v47, v124, v120, s42
  s_nop 1
  v_mfma_f32_32x32x16_bf16 v[144:159], v[44:47], a[196:199], v[144:159]
  s_waitcnt vmcnt(4)
  buffer_load_dwordx4 v[84:87], v2, s[12:15], s45 offen offset:1024 nt
  v_perm_b32 v48, v101, v97, s41
  v_perm_b32 v49, v109, v105, s41
  v_perm_b32 v50, v117, v113, s41
  v_perm_b32 v51, v125, v121, s41
  s_nop 1
  v_mfma_f32_32x32x16_bf16 v[160:175], v[48:51], a[196:199], v[160:175]
  v_perm_b32 v52, v101, v97, s42
  v_perm_b32 v53, v109, v105, s42
  v_perm_b32 v54, v117, v113, s42
  v_perm_b32 v55, v125, v121, s42
  s_nop 1
  v_mfma_f32_32x32x16_bf16 v[176:191], v[52:55], a[196:199], v[176:191]
  s_waitcnt vmcnt(4)
  buffer_load_dwordx4 v[88:91], v2, s[12:15], s45 offen offset:2048 nt
  v_perm_b32 v40, v102, v98, s41
  v_perm_b32 v41, v110, v106, s41
  v_perm_b32 v42, v118, v114, s41
  v_perm_b32 v43, v126, v122, s41
  s_nop 1
  v_mfma_f32_32x32x16_bf16 v[192:207], v[40:43], a[196:199], v[192:207]
  v_perm_b32 v44, v102, v98, s42
  v_perm_b32 v45, v110, v106, s42
  v_perm_b32 v46, v118, v114, s42
  v_perm_b32 v47, v126, v122, s42
  s_nop 1
  v_mfma_f32_32x32x16_bf16 v[208:223], v[44:47], a[196:199], v[208:223]
  s_waitcnt vmcnt(4)
  buffer_load_dwordx4 v[92:95], v2, s[12:15], s45 offen offset:3072 nt
  v_perm_b32 v48, v103, v99, s41
  v_perm_b32 v49, v111, v107, s41
  v_perm_b32 v50, v119, v115, s41
  v_perm_b32 v51, v127, v123, s41
  s_nop 1
  v_mfma_f32_32x32x16_bf16 v[224:239], v[48:51], a[196:199], v[224:239]
  v_perm_b32 v52, v103, v99, s42
  v_perm_b32 v53, v111, v107, s42
  v_perm_b32 v54, v119, v115, s42
  v_perm_b32 v55, v127, v123, s42
  s_nop 1
  v_mfma_f32_32x32x16_bf16 v[240:255], v[52:55], a[196:199], v[240:255]
  s_waitcnt vmcnt(4)
  buffer_load_dwordx4 v[96:99], v2, s[12:15], s46 offen offset:0 nt
  s_waitcnt vmcnt(4)
  buffer_load_dwordx4 v[100:103], v2, s[12:15], s46 offen offset:1024 nt
  s_waitcnt vmcnt(5)
  s_cbranch_vccnz L_w50
  s_waitcnt vmcnt(4)
L_w50:
  buffer_load_dwordx4 v[104:107], v2, s[12:15], s46 offen offset:2048 nt
  s_waitcnt vmcnt(4)
  buffer_load_dwordx4 v[108:111], v2, s[12:15], s46 offen offset:3072 nt
  s_waitcnt vmcnt(4)
  buffer_load_dwordx4 v[112:115], v2, s[12:15], s47 offen offset:0 nt
  v_perm_b32 v40, v68, v64, s41
  v_perm_b32 v41, v76, v72, s41
  v_perm_b32 v42, v84, v80, s41
  v_perm_b32 v43, v92, v88, s41
  v_pk_mul_f32 v[128:129], v[128:129], v[24:25] op_sel:[0,1] op_sel_hi:[1,1]
  v_pk_mul_f32 v[130:131], v[130:131], v[24:25] op_sel:[0,1] op_sel_hi:[1,1]
  v_pk_mul_f32 v[132:133], v[132:133], v[24:25] op_sel:[0,1] op_sel_hi:[1,1]
  v_pk_mul_f32 v[134:135], v[134:135], v[24:25] op_sel:[0,1] op_sel_hi:[1,1]
  v_pk_mul_f32 v[136:137], v[136:137], v[24:25] op_sel:[0,1] op_sel_hi:[1,1]
  v_pk_mul_f32 v[138:139], v[138:139], v[24:25] op_sel:[0,1] op_sel_hi:[1,1]
  v_pk_mul_f32 v[140:141], v[140:141], v[24:25] op_sel:[0,1] op_sel_hi:[1,1]
  v_pk_mul_f32 v[142:143], v[142:143], v[24:25] op_sel:[0,1] op_sel_hi:[1,1]
  s_nop 1
  v_mfma_f32_32x32x16_bf16 v[128:143], v[40:43], a[200:203], v[128:143]
  v_perm_b32 v44, v68, v64, s42
  v_perm_b32 v45, v76, v72, s42
  v_perm_b32 v46, v84, v80, s42
  v_perm_b32 v47, v92, v88, s42
  v_pk_mul_f32 v[144:145], v[144:145], v[24:25] op_sel:[0,1] op_sel_hi:[1,1]
  v_pk_mul_f32 v[146:147], v[146:147], v[24:25] op_sel:[0,1] op_sel_hi:[1,1]
  v_pk_mul_f32 v[148:149], v[148:149], v[24:25] op_sel:[0,1] op_sel_hi:[1,1]
  v_pk_mul_f32 v[150:151], v[150:151], v[24:25] op_sel:[0,1] op_sel_hi:[1,1]
  v_pk_mul_f32 v[152:153], v[152:153], v[24:25] op_sel:[0,1] op_sel_hi:[1,1]
  v_pk_mul_f32 v[154:155], v[154:155], v[24:25] op_sel:[0,1] op_sel_hi:[1,1]
  v_pk_mul_f32 v[156:157], v[156:157], v[24:25] op_sel:[0,1] op_sel_hi:[1,1]
  v_pk_mul_f32 v[158:159], v[158:159], v[24:25] op_sel:[0,1] op_sel_hi:[1,1]
  s_nop 1
  v_mfma_f32_32x32x16_bf16 v[144:159], v[44:47], a[200:203], v[144:159]
  s_waitcnt vmcnt(4)
  buffer_load_dwordx4 v[116:119], v2, s[12:15], s47 offen offset:1024 nt
  v_perm_b32 v48, v69, v65, s41
  v_perm_b32 v49, v77, v73, s41
  v_perm_b32 v50, v85, v81, s41
  v_perm_b32 v51, v93, v89, s41
  v_pk_mul_f32 v[160:161], v[160:161], v[24:25] op_sel:[0,1] op_sel_hi:[1,1]
  v_pk_mul_f32 v[162:163], v[162:163], v[24:25] op_sel:[0,1] op_sel_hi:[1,1]
  v_pk_mul_f32 v[164:165], v[164:165], v[24:25] op_sel:[0,1] op_sel_hi:[1,1]
  v_pk_mul_f32 v[166:167], v[166:167], v[24:25] op_sel:[0,1] op_sel_hi:[1,1]
  v_pk_mul_f32 v[168:169], v[168:169], v[24:25] op_sel:[0,1] op_sel_hi:[1,1]
  v_pk_mul_f32 v[170:171], v[170:171], v[24:25] op_sel:[0,1] op_sel_hi:[1,1]
  v_pk_mul_f32 v[172:173], v[172:173], v[24:25] op_sel:[0,1] op_sel_hi:[1,1]
  v_pk_mul_f32 v[174:175], v[174:175], v[24:25] op_sel:[0,1] op_sel_hi:[1,1]
  s_nop 1
  v_mfma_f32_32x32x16_bf16 v[160:175], v[48:51], a[200:203], v[160:175]
  v_perm_b32 v52, v69, v65, s42
  v_perm_b32 v53, v77, v73, s42
  v_perm_b32 v54, v85, v81, s42
  v_perm_b32 v55, v93, v89, s42
  v_pk_mul_f32 v[176:177], v[176:177], v[24:25] op_sel:[0,1] op_sel_hi:[1,1]
  v_pk_mul_f32 v[178:179], v[178:179], v[24:25] op_sel:[0,1] op_sel_hi:[1,1]
  v_pk_mul_f32 v[180:181], v[180:181], v[24:25] op_sel:[0,1] op_sel_hi:[1,1]
  v_pk_mul_f32 v[182:183], v[182:183], v[24:25] op_sel:[0,1] op_sel_hi:[1,1]
  v_pk_mul_f32 v[184:185], v[184:185], v[24:25] op_sel:[0,1] op_sel_hi:[1,1]
  v_pk_mul_f32 v[186:187], v[186:187], v[24:25] op_sel:[0,1] op_sel_hi:[1,1]
  v_pk_mul_f32 v[188:189], v[188:189], v[24:25] op_sel:[0,1] op_sel_hi:[1,1]
  v_pk_mul_f32 v[190:191], v[190:191], v[24:25] op_sel:[0,1] op_sel_hi:[1,1]
  s_nop 1
  v_mfma_f32_32x32x16_bf16 v[176:191], v[52:55], a[200:203], v[176:191]
  s_waitcnt vmcnt(4)
  buffer_load_dwordx4 v[120:123], v2, s[12:15], s47 offen offset:2048 nt
  v_perm_b32 v40, v70, v66, s41
  v_perm_b32 v41, v78, v74, s41
  v_perm_b32 v42, v86, v82, s41
  v_perm_b32 v43, v94, v90, s41
  v_pk_mul_f32 v[192:193], v[192:193], v[24:25] op_sel:[0,1] op_sel_hi:[1,1]
  v_pk_mul_f32 v[194:195], v[194:195], v[24:25] op_sel:[0,1] op_sel_hi:[1,1]
  v_pk_mul_f32 v[196:197], v[196:197], v[24:25] op_sel:[0,1] op_sel_hi:[1,1]
  v_pk_mul_f32 v[198:199], v[198:199], v[24:25] op_sel:[0,1] op_sel_hi:[1,1]
  v_pk_mul_f32 v[200:201], v[200:201], v[24:25] op_sel:[0,1] op_sel_hi:[1,1]
  v_pk_mul_f32 v[202:203], v[202:203], v[24:25] op_sel:[0,1] op_sel_hi:[1,1]
  v_pk_mul_f32 v[204:205], v[204:205], v[24:25] op_sel:[0,1] op_sel_hi:[1,1]
  v_pk_mul_f32 v[206:207], v[206:207], v[24:25] op_sel:[0,1] op_sel_hi:[1,1]
  s_nop 1
  v_mfma_f32_32x32x16_bf16 v[192:207], v[40:43], a[200:203], v[192:207]
  v_perm_b32 v44, v70, v66, s42
  v_perm_b32 v45, v78, v74, s42
  v_perm_b32 v46, v86, v82, s42
  v_perm_b32 v47, v94, v90, s42
  v_pk_mul_f32 v[208:209], v[208:209], v[24:25] op_sel:[0,1] op_sel_hi:[1,1]
  v_pk_mul_f32 v[210:211], v[210:211], v[24:25] op_sel:[0,1] op_sel_hi:[1,1]
  v_pk_mul_f32 v[212:213], v[212:213], v[24:25] op_sel:[0,1] op_sel_hi:[1,1]
  v_pk_mul_f32 v[214:215], v[214:215], v[24:25] op_sel:[0,1] op_sel_hi:[1,1]
  v_pk_mul_f32 v[216:217], v[216:217], v[24:25] op_sel:[0,1] op_sel_hi:[1,1]
  v_pk_mul_f32 v[218:219], v[218:219], v[24:25] op_sel:[0,1] op_sel_hi:[1,1]
  v_pk_mul_f32 v[220:221], v[220:221], v[24:25] op_sel:[0,1] op_sel_hi:[1,1]
  v_pk_mul_f32 v[222:223], v[222:223], v[24:25] op_sel:[0,1] op_sel_hi:[1,1]
  s_nop 1
  v_mfma_f32_32x32x16_bf16 v[208:223], v[44:47], a[200:203], v[208:223]
  s_waitcnt vmcnt(4)
  buffer_load_dwordx4 v[124:127], v2, s[12:15], s47 offen offset:3072 nt
  v_perm_b32 v48, v71, v67, s41
  v_perm_b32 v49, v79, v75, s41
  v_perm_b32 v50, v87, v83, s41
  v_perm_b32 v51, v95, v91, s41
  v_pk_mul_f32 v[224:225], v[224:225], v[24:25] op_sel:[0,1] op_sel_hi:[1,1]
  v_pk_mul_f32 v[226:227], v[226:227], v[24:25] op_sel:[0,1] op_sel_hi:[1,1]
  v_pk_mul_f32 v[228:229], v[228:229], v[24:25] op_sel:[0,1] op_sel_hi:[1,1]
  v_pk_mul_f32 v[230:231], v[230:231], v[24:25] op_sel:[0,1] op_sel_hi:[1,1]
  v_pk_mul_f32 v[232:233], v[232:233], v[24:25] op_sel:[0,1] op_sel_hi:[1,1]
  v_pk_mul_f32 v[234:235], v[234:235], v[24:25] op_sel:[0,1] op_sel_hi:[1,1]
  v_pk_mul_f32 v[236:237], v[236:237], v[24:25] op_sel:[0,1] op_sel_hi:[1,1]
  v_pk_mul_f32 v[238:239], v[238:239], v[24:25] op_sel:[0,1] op_sel_hi:[1,1]
  s_nop 1
  v_mfma_f32_32x32x16_bf16 v[224:239], v[48:51], a[200:203], v[224:239]
  v_perm_b32 v52, v71, v67, s42
  v_perm_b32 v53, v79, v75, s42
  v_perm_b32 v54, v87, v83, s42
  v_perm_b32 v55, v95, v91, s42
  v_pk_mul_f32 v[240:241], v[240:241], v[24:25] op_sel:[0,1] op_sel_hi:[1,1]
  v_pk_mul_f32 v[242:243], v[242:243], v[24:25] op_sel:[0,1] op_sel_hi:[1,1]
  v_pk_mul_f32 v[244:245], v[244:245], v[24:25] op_sel:[0,1] op_sel_hi:[1,1]
  v_pk_mul_f32 v[246:247], v[246:247], v[24:25] op_sel:[0,1] op_sel_hi:[1,1]
  v_pk_mul_f32 v[248:249], v[248:249], v[24:25] op_sel:[0,1] op_sel_hi:[1,1]
  v_pk_mul_f32 v[250:251], v[250:251], v[24:25] op_sel:[0,1] op_sel_hi:[1,1]
  v_pk_mul_f32 v[252:253], v[252:253], v[24:25] op_sel:[0,1] op_sel_hi:[1,1]
  v_pk_mul_f32 v[254:255], v[254:255], v[24:25] op_sel:[0,1] op_sel_hi:[1,1]
  s_nop 1
  v_mfma_f32_32x32x16_bf16 v[240:255], v[52:55], a[200:203], v[240:255]
  s_add_u32 s44, s55, 655360
  s_add_u32 s45, s55, 671744
  s_add_u32 s46, s55, 688128
  s_add_u32 s47, s55, 704512
  s_waitcnt vmcnt(4)
  buffer_load_dwordx4 v[64:67], v2, s[12:15], s44 offen offset:0 nt
  s_waitcnt vmcnt(4)
  buffer_load_dwordx4 v[68:71], v2, s[12:15], s44 offen offset:1024 nt
  s_waitcnt vmcnt(5)
  s_cbranch_vccnz L_w51
  s_waitcnt vmcnt(4)
L_w51:
  buffer_load_dwordx4 v[72:75], v2, s[12:15], s44 offen offset:2048 nt
  s_waitcnt vmcnt(4)
  buffer_load_dwordx4 v[76:79], v2, s[12:15], s44 offen offset:3072 nt
  s_waitcnt vmcnt(4)
  buffer_load_dwordx4 v[80:83], v2, s[12:15], s45 offen offset:0 nt
  v_perm_b32 v40, v100, v96, s41
  v_perm_b32 v41, v108, v104, s41
  v_perm_b32 v42, v116, v112, s41
  v_perm_b32 v43, v124, v120, s41
  s_nop 1
  v_mfma_f32_32x32x16_bf16 v[128:143], v[40:43], a[204:207], v[128:143]
  v_perm_b32 v44, v100, v96, s42
  v_perm_b32 v45, v108, v104, s42
  v_perm_b32 v46, v116, v112, s42
  v_perm_b32 v47, v124, v120, s42
  s_nop 1
  v_mfma_f32_32x32x16_bf16 v[144:159], v[44:47], a[204:207], v[144:159]
  s_waitcnt vmcnt(4)
  buffer_load_dwordx4 v[84:87], v2, s[12:15], s45 offen offset:1024 nt
  v_perm_b32 v48, v101, v97, s41
  v_perm_b32 v49, v109, v105, s41
  v_perm_b32 v50, v117, v113, s41
  v_perm_b32 v51, v125, v121, s41
  s_nop 1
  v_mfma_f32_32x32x16_bf16 v[160:175], v[48:51], a[204:207], v[160:175]
  v_perm_b32 v52, v101, v97, s42
  v_perm_b32 v53, v109, v105, s42
  v_perm_b32 v54, v117, v113, s42
  v_perm_b32 v55, v125, v121, s42
  s_nop 1
  v_mfma_f32_32x32x16_bf16 v[176:191], v[52:55], a[204:207], v[176:191]
  s_waitcnt vmcnt(4)
  buffer_load_dwordx4 v[88:91], v2, s[12:15], s45 offen offset:2048 nt
  v_perm_b32 v40, v102, v98, s41
  v_perm_b32 v41, v110, v106, s41
  v_perm_b32 v42, v118, v114, s41
  v_perm_b32 v43, v126, v122, s41
  s_nop 1
  v_mfma_f32_32x32x16_bf16 v[192:207], v[40:43], a[204:207], v[192:207]
  v_perm_b32 v44, v102, v98, s42
  v_perm_b32 v45, v110, v106, s42
  v_perm_b32 v46, v118, v114, s42
  v_perm_b32 v47, v126, v122, s42
  s_nop 1
  v_mfma_f32_32x32x16_bf16 v[208:223], v[44:47], a[204:207], v[208:223]
  s_waitcnt vmcnt(4)
  buffer_load_dwordx4 v[92:95], v2, s[12:15], s45 offen offset:3072 nt
  v_perm_b32 v48, v103, v99, s41
  v_perm_b32 v49, v111, v107, s41
  v_perm_b32 v50, v119, v115, s41
  v_perm_b32 v51, v127, v123, s41
  s_nop 1
  v_mfma_f32_32x32x16_bf16 v[224:239], v[48:51], a[204:207], v[224:239]
  v_perm_b32 v52, v103, v99, s42
  v_perm_b32 v53, v111, v107, s42
  v_perm_b32 v54, v119, v115, s42
  v_perm_b32 v55, v127, v123, s42
  s_nop 1
  v_mfma_f32_32x32x16_bf16 v[240:255], v[52:55], a[204:207], v[240:255]
  s_waitcnt vmcnt(4)
  buffer_load_dwordx4 v[96:99], v2, s[12:15], s46 offen offset:0 nt
  s_waitcnt vmcnt(4)
  buffer_load_dwordx4 v[100:103], v2, s[12:15], s46 offen offset:1024 nt
  s_waitcnt vmcnt(5)
  s_cbranch_vccnz L_w52
  s_waitcnt vmcnt(4)
L_w52:
  buffer_load_dwordx4 v[104:107], v2, s[12:15], s46 offen offset:2048 nt
  s_waitcnt vmcnt(4)
  buffer_load_dwordx4 v[108:111], v2, s[12:15], s46 offen offset:3072 nt
  s_waitcnt vmcnt(4)
  buffer_load_dwordx4 v[112:115], v2, s[12:15], s47 offen offset:0 nt
  v_perm_b32 v40, v68, v64, s41
  v_perm_b32 v41, v76, v72, s41
  v_perm_b32 v42, v84, v80, s41
  v_perm_b32 v43, v92, v88, s41
  v_pk_mul_f32 v[128:129], v[128:129], v[26:27] op_sel_hi:[1,0]
  v_pk_mul_f32 v[130:131], v[130:131], v[26:27] op_sel_hi:[1,0]
  v_pk_mul_f32 v[132:133], v[132:133], v[26:27] op_sel_hi:[1,0]
  v_pk_mul_f32 v[134:135], v[134:135], v[26:27] op_sel_hi:[1,0]
  v_pk_mul_f32 v[136:137], v[136:137], v[26:27] op_sel_hi:[1,0]
  v_pk_mul_f32 v[138:139], v[138:139], v[26:27] op_sel_hi:[1,0]
  v_pk_mul_f32 v[140:141], v[140:141], v[26:27] op_sel_hi:[1,0]
  v_pk_mul_f32 v[142:143], v[142:143], v[26:27] op_sel_hi:[1,0]
  s_nop 1
  v_mfma_f32_32x32x16_bf16 v[128:143], v[40:43], a[208:211], v[128:143]
  v_perm_b32 v44, v68, v64, s42
  v_perm_b32 v45, v76, v72, s42
  v_perm_b32 v46, v84, v80, s42
  v_perm_b32 v47, v92, v88, s42
  v_pk_mul_f32 v[144:145], v[144:145], v[26:27] op_sel_hi:[1,0]
  v_pk_mul_f32 v[146:147], v[146:147], v[26:27] op_sel_hi:[1,0]
  v_pk_mul_f32 v[148:149], v[148:149], v[26:27] op_sel_hi:[1,0]
  v_pk_mul_f32 v[150:151], v[150:151], v[26:27] op_sel_hi:[1,0]
  v_pk_mul_f32 v[152:153], v[152:153], v[26:27] op_sel_hi:[1,0]
  v_pk_mul_f32 v[154:155], v[154:155], v[26:27] op_sel_hi:[1,0]
  v_pk_mul_f32 v[156:157], v[156:157], v[26:27] op_sel_hi:[1,0]
  v_pk_mul_f32 v[158:159], v[158:159], v[26:27] op_sel_hi:[1,0]
  s_nop 1
  v_mfma_f32_32x32x16_bf16 v[144:159], v[44:47], a[208:211], v[144:159]
  s_waitcnt vmcnt(4)
  buffer_load_dwordx4 v[116:119], v2, s[12:15], s47 offen offset:1024 nt
  v_perm_b32 v48, v69, v65, s41
  v_perm_b32 v49, v77, v73, s41
  v_perm_b32 v50, v85, v81, s41
  v_perm_b32 v51, v93, v89, s41
  v_pk_mul_f32 v[160:161], v[160:161], v[26:27] op_sel_hi:[1,0]
  v_pk_mul_f32 v[162:163], v[162:163], v[26:27] op_sel_hi:[1,0]
  v_pk_mul_f32 v[164:165], v[164:165], v[26:27] op_sel_hi:[1,0]
  v_pk_mul_f32 v[166:167], v[166:167], v[26:27] op_sel_hi:[1,0]
  v_pk_mul_f32 v[168:169], v[168:169], v[26:27] op_sel_hi:[1,0]
  v_pk_mul_f32 v[170:171], v[170:171], v[26:27] op_sel_hi:[1,0]
  v_pk_mul_f32 v[172:173], v[172:173], v[26:27] op_sel_hi:[1,0]
  v_pk_mul_f32 v[174:175], v[174:175], v[26:27] op_sel_hi:[1,0]
  s_nop 1
  v_mfma_f32_32x32x16_bf16 v[160:175], v[48:51], a[208:211], v[160:175]
  v_perm_b32 v52, v69, v65, s42
  v_perm_b32 v53, v77, v73, s42
  v_perm_b32 v54, v85, v81, s42
  v_perm_b32 v55, v93, v89, s42
  v_pk_mul_f32 v[176:177], v[176:177], v[26:27] op_sel_hi:[1,0]
  v_pk_mul_f32 v[178:179], v[178:179], v[26:27] op_sel_hi:[1,0]
  v_pk_mul_f32 v[180:181], v[180:181], v[26:27] op_sel_hi:[1,0]
  v_pk_mul_f32 v[182:183], v[182:183], v[26:27] op_sel_hi:[1,0]
  v_pk_mul_f32 v[184:185], v[184:185], v[26:27] op_sel_hi:[1,0]
  v_pk_mul_f32 v[186:187], v[186:187], v[26:27] op_sel_hi:[1,0]
  v_pk_mul_f32 v[188:189], v[188:189], v[26:27] op_sel_hi:[1,0]
  v_pk_mul_f32 v[190:191], v[190:191], v[26:27] op_sel_hi:[1,0]
  s_nop 1
  v_mfma_f32_32x32x16_bf16 v[176:191], v[52:55], a[208:211], v[176:191]
  s_waitcnt vmcnt(4)
  buffer_load_dwordx4 v[120:123], v2, s[12:15], s47 offen offset:2048 nt
  v_perm_b32 v40, v70, v66, s41
  v_perm_b32 v41, v78, v74, s41
  v_perm_b32 v42, v86, v82, s41
  v_perm_b32 v43, v94, v90, s41
  v_pk_mul_f32 v[192:193], v[192:193], v[26:27] op_sel_hi:[1,0]
  v_pk_mul_f32 v[194:195], v[194:195], v[26:27] op_sel_hi:[1,0]
  v_pk_mul_f32 v[196:197], v[196:197], v[26:27] op_sel_hi:[1,0]
  v_pk_mul_f32 v[198:199], v[198:199], v[26:27] op_sel_hi:[1,0]
  v_pk_mul_f32 v[200:201], v[200:201], v[26:27] op_sel_hi:[1,0]
  v_pk_mul_f32 v[202:203], v[202:203], v[26:27] op_sel_hi:[1,0]
  v_pk_mul_f32 v[204:205], v[204:205], v[26:27] op_sel_hi:[1,0]
  v_pk_mul_f32 v[206:207], v[206:207], v[26:27] op_sel_hi:[1,0]
  s_nop 1
  v_mfma_f32_32x32x16_bf16 v[192:207], v[40:43], a[208:211], v[192:207]
  v_perm_b32 v44, v70, v66, s42
  v_perm_b32 v45, v78, v74, s42
  v_perm_b32 v46, v86, v82, s42
  v_perm_b32 v47, v94, v90, s42
  v_pk_mul_f32 v[208:209], v[208:209], v[26:27] op_sel_hi:[1,0]
  v_pk_mul_f32 v[210:211], v[210:211], v[26:27] op_sel_hi:[1,0]
  v_pk_mul_f32 v[212:213], v[212:213], v[26:27] op_sel_hi:[1,0]
  v_pk_mul_f32 v[214:215], v[214:215], v[26:27] op_sel_hi:[1,0]
  v_pk_mul_f32 v[216:217], v[216:217], v[26:27] op_sel_hi:[1,0]
  v_pk_mul_f32 v[218:219], v[218:219], v[26:27] op_sel_hi:[1,0]
  v_pk_mul_f32 v[220:221], v[220:221], v[26:27] op_sel_hi:[1,0]
  v_pk_mul_f32 v[222:223], v[222:223], v[26:27] op_sel_hi:[1,0]
  s_nop 1
  v_mfma_f32_32x32x16_bf16 v[208:223], v[44:47], a[208:211], v[208:223]
  s_waitcnt vmcnt(4)
  buffer_load_dwordx4 v[124:127], v2, s[12:15], s47 offen offset:3072 nt
  v_perm_b32 v48, v71, v67, s41
  v_perm_b32 v49, v79, v75, s41
  v_perm_b32 v50, v87, v83, s41
  v_perm_b32 v51, v95, v91, s41
  v_pk_mul_f32 v[224:225], v[224:225], v[26:27] op_sel_hi:[1,0]
  v_pk_mul_f32 v[226:227], v[226:227], v[26:27] op_sel_hi:[1,0]
  v_pk_mul_f32 v[228:229], v[228:229], v[26:27] op_sel_hi:[1,0]
  v_pk_mul_f32 v[230:231], v[230:231], v[26:27] op_sel_hi:[1,0]
  v_pk_mul_f32 v[232:233], v[232:233], v[26:27] op_sel_hi:[1,0]
  v_pk_mul_f32 v[234:235], v[234:235], v[26:27] op_sel_hi:[1,0]
  v_pk_mul_f32 v[236:237], v[236:237], v[26:27] op_sel_hi:[1,0]
  v_pk_mul_f32 v[238:239], v[238:239], v[26:27] op_sel_hi:[1,0]
  s_nop 1
  v_mfma_f32_32x32x16_bf16 v[224:239], v[48:51], a[208:211], v[224:239]
  v_perm_b32 v52, v71, v67, s42
  v_perm_b32 v53, v79, v75, s42
  v_perm_b32 v54, v87, v83, s42
  v_perm_b32 v55, v95, v91, s42
  v_pk_mul_f32 v[240:241], v[240:241], v[26:27] op_sel_hi:[1,0]
  v_pk_mul_f32 v[242:243], v[242:243], v[26:27] op_sel_hi:[1,0]
  v_pk_mul_f32 v[244:245], v[244:245], v[26:27] op_sel_hi:[1,0]
  v_pk_mul_f32 v[246:247], v[246:247], v[26:27] op_sel_hi:[1,0]
  v_pk_mul_f32 v[248:249], v[248:249], v[26:27] op_sel_hi:[1,0]
  v_pk_mul_f32 v[250:251], v[250:251], v[26:27] op_sel_hi:[1,0]
  v_pk_mul_f32 v[252:253], v[252:253], v[26:27] op_sel_hi:[1,0]
  v_pk_mul_f32 v[254:255], v[254:255], v[26:27] op_sel_hi:[1,0]
  s_nop 1
  v_mfma_f32_32x32x16_bf16 v[240:255], v[52:55], a[208:211], v[240:255]
  s_add_u32 s44, s55, 720896
  s_add_u32 s45, s55, 737280
  s_add_u32 s46, s55, 753664
  s_add_u32 s47, s55, 770048
  s_waitcnt vmcnt(4)
  buffer_load_dwordx4 v[64:67], v2, s[12:15], s44 offen offset:0 nt
  s_waitcnt vmcnt(4)
  buffer_load_dwordx4 v[68:71], v2, s[12:15], s44 offen offset:1024 nt
  s_waitcnt vmcnt(5)
  s_cbranch_vccnz L_w53
  s_waitcnt vmcnt(4)
L_w53:
  buffer_load_dwordx4 v[72:75], v2, s[12:15], s44 offen offset:2048 nt
  s_waitcnt vmcnt(4)
  buffer_load_dwordx4 v[76:79], v2, s[12:15], s44 offen offset:3072 nt
  s_waitcnt vmcnt(4)
  buffer_load_dwordx4 v[80:83], v2, s[12:15], s45 offen offset:0 nt
  v_perm_b32 v40, v100, v96, s41
  v_perm_b32 v41, v108, v104, s41
  v_perm_b32 v42, v116, v112, s41
  v_perm_b32 v43, v124, v120, s41
  s_nop 1
  v_mfma_f32_32x32x16_bf16 v[128:143], v[40:43], a[212:215], v[128:143]
  v_perm_b32 v44, v100, v96, s42
  v_perm_b32 v45, v108, v104, s42
  v_perm_b32 v46, v116, v112, s42
  v_perm_b32 v47, v124, v120, s42
  s_nop 1
  v_mfma_f32_32x32x16_bf16 v[144:159], v[44:47], a[212:215], v[144:159]
  s_waitcnt vmcnt(4)
  buffer_load_dwordx4 v[84:87], v2, s[12:15], s45 offen offset:1024 nt
  v_perm_b32 v48, v101, v97, s41
  v_perm_b32 v49, v109, v105, s41
  v_perm_b32 v50, v117, v113, s41
  v_perm_b32 v51, v125, v121, s41
  s_nop 1
  v_mfma_f32_32x32x16_bf16 v[160:175], v[48:51], a[212:215], v[160:175]
  v_perm_b32 v52, v101, v97, s42
  v_perm_b32 v53, v109, v105, s42
  v_perm_b32 v54, v117, v113, s42
  v_perm_b32 v55, v125, v121, s42
  s_nop 1
  v_mfma_f32_32x32x16_bf16 v[176:191], v[52:55], a[212:215], v[176:191]
  s_waitcnt vmcnt(4)
  buffer_load_dwordx4 v[88:91], v2, s[12:15], s45 offen offset:2048 nt
  v_perm_b32 v40, v102, v98, s41
  v_perm_b32 v41, v110, v106, s41
  v_perm_b32 v42, v118, v114, s41
  v_perm_b32 v43, v126, v122, s41
  s_nop 1
  v_mfma_f32_32x32x16_bf16 v[192:207], v[40:43], a[212:215], v[192:207]
  v_perm_b32 v44, v102, v98, s42
  v_perm_b32 v45, v110, v106, s42
  v_perm_b32 v46, v118, v114, s42
  v_perm_b32 v47, v126, v122, s42
  s_nop 1
  v_mfma_f32_32x32x16_bf16 v[208:223], v[44:47], a[212:215], v[208:223]
  s_waitcnt vmcnt(4)
  buffer_load_dwordx4 v[92:95], v2, s[12:15], s45 offen offset:3072 nt
  v_perm_b32 v48, v103, v99, s41
  v_perm_b32 v49, v111, v107, s41
  v_perm_b32 v50, v119, v115, s41
  v_perm_b32 v51, v127, v123, s41
  s_nop 1
  v_mfma_f32_32x32x16_bf16 v[224:239], v[48:51], a[212:215], v[224:239]
  v_perm_b32 v52, v103, v99, s42
  v_perm_b32 v53, v111, v107, s42
  v_perm_b32 v54, v119, v115, s42
  v_perm_b32 v55, v127, v123, s42
  s_nop 1
  v_mfma_f32_32x32x16_bf16 v[240:255], v[52:55], a[212:215], v[240:255]
  s_waitcnt vmcnt(4)
  buffer_load_dwordx4 v[96:99], v2, s[12:15], s46 offen offset:0 nt
  s_waitcnt vmcnt(4)
  buffer_load_dwordx4 v[100:103], v2, s[12:15], s46 offen offset:1024 nt
  s_waitcnt vmcnt(5)
  s_cbranch_vccnz L_w54
  s_waitcnt vmcnt(4)
L_w54:
  buffer_load_dwordx4 v[104:107], v2, s[12:15], s46 offen offset:2048 nt
  s_waitcnt vmcnt(4)
  buffer_load_dwordx4 v[108:111], v2, s[12:15], s46 offen offset:3072 nt
  s_waitcnt vmcnt(4)
  buffer_load_dwordx4 v[112:115], v2, s[12:15], s47 offen offset:0 nt
  v_perm_b32 v40, v68, v64, s41
  v_perm_b32 v41, v76, v72, s41
  v_perm_b32 v42, v84, v80, s41
  v_perm_b32 v43, v92, v88, s41
  v_pk_mul_f32 v[128:129], v[128:129], v[26:27] op_sel:[0,1] op_sel_hi:[1,1]
  v_pk_mul_f32 v[130:131], v[130:131], v[26:27] op_sel:[0,1] op_sel_hi:[1,1]
  v_pk_mul_f32 v[132:133], v[132:133], v[26:27] op_sel:[0,1] op_sel_hi:[1,1]
  v_pk_mul_f32 v[134:135], v[134:135], v[26:27] op_sel:[0,1] op_sel_hi:[1,1]
  v_pk_mul_f32 v[136:137], v[136:137], v[26:27] op_sel:[0,1] op_sel_hi:[1,1]
  v_pk_mul_f32 v[138:139], v[138:139], v[26:27] op_sel:[0,1] op_sel_hi:[1,1]
  v_pk_mul_f32 v[140:141], v[140:141], v[26:27] op_sel:[0,1] op_sel_hi:[1,1]
  v_pk_mul_f32 v[142:143], v[142:143], v[26:27] op_sel:[0,1] op_sel_hi:[1,1]
  s_nop 1
  v_mfma_f32_32x32x16_bf16 v[128:143], v[40:43], a[216:219], v[128:143]
  v_perm_b32 v44, v68, v64, s42
  v_perm_b32 v45, v76, v72, s42
  v_perm_b32 v46, v84, v80, s42
  v_perm_b32 v47, v92, v88, s42
  v_pk_mul_f32 v[144:145], v[144:145], v[26:27] op_sel:[0,1] op_sel_hi:[1,1]
  v_pk_mul_f32 v[146:147], v[146:147], v[26:27] op_sel:[0,1] op_sel_hi:[1,1]
  v_pk_mul_f32 v[148:149], v[148:149], v[26:27] op_sel:[0,1] op_sel_hi:[1,1]
  v_pk_mul_f32 v[150:151], v[150:151], v[26:27] op_sel:[0,1] op_sel_hi:[1,1]
  v_pk_mul_f32 v[152:153], v[152:153], v[26:27] op_sel:[0,1] op_sel_hi:[1,1]
  v_pk_mul_f32 v[154:155], v[154:155], v[26:27] op_sel:[0,1] op_sel_hi:[1,1]
  v_pk_mul_f32 v[156:157], v[156:157], v[26:27] op_sel:[0,1] op_sel_hi:[1,1]
  v_pk_mul_f32 v[158:159], v[158:159], v[26:27] op_sel:[0,1] op_sel_hi:[1,1]
  s_nop 1
  v_mfma_f32_32x32x16_bf16 v[144:159], v[44:47], a[216:219], v[144:159]
  s_waitcnt vmcnt(4)
  buffer_load_dwordx4 v[116:119], v2, s[12:15], s47 offen offset:1024 nt
  v_perm_b32 v48, v69, v65, s41
  v_perm_b32 v49, v77, v73, s41
  v_perm_b32 v50, v85, v81, s41
  v_perm_b32 v51, v93, v89, s41
  v_pk_mul_f32 v[160:161], v[160:161], v[26:27] op_sel:[0,1] op_sel_hi:[1,1]
  v_pk_mul_f32 v[162:163], v[162:163], v[26:27] op_sel:[0,1] op_sel_hi:[1,1]
  v_pk_mul_f32 v[164:165], v[164:165], v[26:27] op_sel:[0,1] op_sel_hi:[1,1]
  v_pk_mul_f32 v[166:167], v[166:167], v[26:27] op_sel:[0,1] op_sel_hi:[1,1]
  v_pk_mul_f32 v[168:169], v[168:169], v[26:27] op_sel:[0,1] op_sel_hi:[1,1]
  v_pk_mul_f32 v[170:171], v[170:171], v[26:27] op_sel:[0,1] op_sel_hi:[1,1]
  v_pk_mul_f32 v[172:173], v[172:173], v[26:27] op_sel:[0,1] op_sel_hi:[1,1]
  v_pk_mul_f32 v[174:175], v[174:175], v[26:27] op_sel:[0,1] op_sel_hi:[1,1]
  s_nop 1
  v_mfma_f32_32x32x16_bf16 v[160:175], v[48:51], a[216:219], v[160:175]
  v_perm_b32 v52, v69, v65, s42
  v_perm_b32 v53, v77, v73, s42
  v_perm_b32 v54, v85, v81, s42
  v_perm_b32 v55, v93, v89, s42
  v_pk_mul_f32 v[176:177], v[176:177], v[26:27] op_sel:[0,1] op_sel_hi:[1,1]
  v_pk_mul_f32 v[178:179], v[178:179], v[26:27] op_sel:[0,1] op_sel_hi:[1,1]
  v_pk_mul_f32 v[180:181], v[180:181], v[26:27] op_sel:[0,1] op_sel_hi:[1,1]
  v_pk_mul_f32 v[182:183], v[182:183], v[26:27] op_sel:[0,1] op_sel_hi:[1,1]
  v_pk_mul_f32 v[184:185], v[184:185], v[26:27] op_sel:[0,1] op_sel_hi:[1,1]
  v_pk_mul_f32 v[186:187], v[186:187], v[26:27] op_sel:[0,1] op_sel_hi:[1,1]
  v_pk_mul_f32 v[188:189], v[188:189], v[26:27] op_sel:[0,1] op_sel_hi:[1,1]
  v_pk_mul_f32 v[190:191], v[190:191], v[26:27] op_sel:[0,1] op_sel_hi:[1,1]
  s_nop 1
  v_mfma_f32_32x32x16_bf16 v[176:191], v[52:55], a[216:219], v[176:191]
  s_waitcnt vmcnt(4)
  buffer_load_dwordx4 v[120:123], v2, s[12:15], s47 offen offset:2048 nt
  v_perm_b32 v40, v70, v66, s41
  v_perm_b32 v41, v78, v74, s41
  v_perm_b32 v42, v86, v82, s41
  v_perm_b32 v43, v94, v90, s41
  v_pk_mul_f32 v[192:193], v[192:193], v[26:27] op_sel:[0,1] op_sel_hi:[1,1]
  v_pk_mul_f32 v[194:195], v[194:195], v[26:27] op_sel:[0,1] op_sel_hi:[1,1]
  v_pk_mul_f32 v[196:197], v[196:197], v[26:27] op_sel:[0,1] op_sel_hi:[1,1]
  v_pk_mul_f32 v[198:199], v[198:199], v[26:27] op_sel:[0,1] op_sel_hi:[1,1]
  v_pk_mul_f32 v[200:201], v[200:201], v[26:27] op_sel:[0,1] op_sel_hi:[1,1]
  v_pk_mul_f32 v[202:203], v[202:203], v[26:27] op_sel:[0,1] op_sel_hi:[1,1]
  v_pk_mul_f32 v[204:205], v[204:205], v[26:27] op_sel:[0,1] op_sel_hi:[1,1]
  v_pk_mul_f32 v[206:207], v[206:207], v[26:27] op_sel:[0,1] op_sel_hi:[1,1]
  s_nop 1
  v_mfma_f32_32x32x16_bf16 v[192:207], v[40:43], a[216:219], v[192:207]
  v_perm_b32 v44, v70, v66, s42
  v_perm_b32 v45, v78, v74, s42
  v_perm_b32 v46, v86, v82, s42
  v_perm_b32 v47, v94, v90, s42
  v_pk_mul_f32 v[208:209], v[208:209], v[26:27] op_sel:[0,1] op_sel_hi:[1,1]
  v_pk_mul_f32 v[210:211], v[210:211], v[26:27] op_sel:[0,1] op_sel_hi:[1,1]
  v_pk_mul_f32 v[212:213], v[212:213], v[26:27] op_sel:[0,1] op_sel_hi:[1,1]
  v_pk_mul_f32 v[214:215], v[214:215], v[26:27] op_sel:[0,1] op_sel_hi:[1,1]
  v_pk_mul_f32 v[216:217], v[216:217], v[26:27] op_sel:[0,1] op_sel_hi:[1,1]
  v_pk_mul_f32 v[218:219], v[218:219], v[26:27] op_sel:[0,1] op_sel_hi:[1,1]
  v_pk_mul_f32 v[220:221], v[220:221], v[26:27] op_sel:[0,1] op_sel_hi:[1,1]
  v_pk_mul_f32 v[222:223], v[222:223], v[26:27] op_sel:[0,1] op_sel_hi:[1,1]
  s_nop 1
  v_mfma_f32_32x32x16_bf16 v[208:223], v[44:47], a[216:219], v[208:223]
  s_waitcnt vmcnt(4)
  buffer_load_dwordx4 v[124:127], v2, s[12:15], s47 offen offset:3072 nt
  v_perm_b32 v48, v71, v67, s41
  v_perm_b32 v49, v79, v75, s41
  v_perm_b32 v50, v87, v83, s41
  v_perm_b32 v51, v95, v91, s41
  v_pk_mul_f32 v[224:225], v[224:225], v[26:27] op_sel:[0,1] op_sel_hi:[1,1]
  v_pk_mul_f32 v[226:227], v[226:227], v[26:27] op_sel:[0,1] op_sel_hi:[1,1]
  v_pk_mul_f32 v[228:229], v[228:229], v[26:27] op_sel:[0,1] op_sel_hi:[1,1]
  v_pk_mul_f32 v[230:231], v[230:231], v[26:27] op_sel:[0,1] op_sel_hi:[1,1]
  v_pk_mul_f32 v[232:233], v[232:233], v[26:27] op_sel:[0,1] op_sel_hi:[1,1]
  v_pk_mul_f32 v[234:235], v[234:235], v[26:27] op_sel:[0,1] op_sel_hi:[1,1]
  v_pk_mul_f32 v[236:237], v[236:237], v[26:27] op_sel:[0,1] op_sel_hi:[1,1]
  v_pk_mul_f32 v[238:239], v[238:239], v[26:27] op_sel:[0,1] op_sel_hi:[1,1]
  s_nop 1
  v_mfma_f32_32x32x16_bf16 v[224:239], v[48:51], a[216:219], v[224:239]
  v_perm_b32 v52, v71, v67, s42
  v_perm_b32 v53, v79, v75, s42
  v_perm_b32 v54, v87, v83, s42
  v_perm_b32 v55, v95, v91, s42
  v_pk_mul_f32 v[240:241], v[240:241], v[26:27] op_sel:[0,1] op_sel_hi:[1,1]
  v_pk_mul_f32 v[242:243], v[242:243], v[26:27] op_sel:[0,1] op_sel_hi:[1,1]
  v_pk_mul_f32 v[244:245], v[244:245], v[26:27] op_sel:[0,1] op_sel_hi:[1,1]
  v_pk_mul_f32 v[246:247], v[246:247], v[26:27] op_sel:[0,1] op_sel_hi:[1,1]
  v_pk_mul_f32 v[248:249], v[248:249], v[26:27] op_sel:[0,1] op_sel_hi:[1,1]
  v_pk_mul_f32 v[250:251], v[250:251], v[26:27] op_sel:[0,1] op_sel_hi:[1,1]
  v_pk_mul_f32 v[252:253], v[252:253], v[26:27] op_sel:[0,1] op_sel_hi:[1,1]
  v_pk_mul_f32 v[254:255], v[254:255], v[26:27] op_sel:[0,1] op_sel_hi:[1,1]
  s_nop 1
  v_mfma_f32_32x32x16_bf16 v[240:255], v[52:55], a[216:219], v[240:255]
  s_add_u32 s44, s55, 786432
  s_add_u32 s45, s55, 802816
  s_add_u32 s46, s55, 819200
  s_add_u32 s47, s55, 835584
  s_waitcnt vmcnt(4)
  buffer_load_dwordx4 v[64:67], v2, s[12:15], s44 offen offset:0 nt
  s_waitcnt vmcnt(4)
  buffer_load_dwordx4 v[68:71], v2, s[12:15], s44 offen offset:1024 nt
  s_waitcnt vmcnt(5)
  s_cbranch_vccnz L_w55
  s_waitcnt vmcnt(4)
L_w55:
  buffer_load_dwordx4 v[72:75], v2, s[12:15], s44 offen offset:2048 nt
  s_waitcnt vmcnt(4)
  buffer_load_dwordx4 v[76:79], v2, s[12:15], s44 offen offset:3072 nt
  s_waitcnt vmcnt(4)
  buffer_load_dwordx4 v[80:83], v2, s[12:15], s45 offen offset:0 nt
  v_perm_b32 v40, v100, v96, s41
  v_perm_b32 v41, v108, v104, s41
  v_perm_b32 v42, v116, v112, s41
  v_perm_b32 v43, v124, v120, s41
  s_nop 1
  v_mfma_f32_32x32x16_bf16 v[128:143], v[40:43], a[220:223], v[128:143]
  v_perm_b32 v44, v100, v96, s42
  v_perm_b32 v45, v108, v104, s42
  v_perm_b32 v46, v116, v112, s42
  v_perm_b32 v47, v124, v120, s42
  s_nop 1
  v_mfma_f32_32x32x16_bf16 v[144:159], v[44:47], a[220:223], v[144:159]
  s_waitcnt vmcnt(4)
  buffer_load_dwordx4 v[84:87], v2, s[12:15], s45 offen offset:1024 nt
  v_perm_b32 v48, v101, v97, s41
  v_perm_b32 v49, v109, v105, s41
  v_perm_b32 v50, v117, v113, s41
  v_perm_b32 v51, v125, v121, s41
  s_nop 1
  v_mfma_f32_32x32x16_bf16 v[160:175], v[48:51], a[220:223], v[160:175]
  v_perm_b32 v52, v101, v97, s42
  v_perm_b32 v53, v109, v105, s42
  v_perm_b32 v54, v117, v113, s42
  v_perm_b32 v55, v125, v121, s42
  s_nop 1
  v_mfma_f32_32x32x16_bf16 v[176:191], v[52:55], a[220:223], v[176:191]
  s_waitcnt vmcnt(4)
  buffer_load_dwordx4 v[88:91], v2, s[12:15], s45 offen offset:2048 nt
  v_perm_b32 v40, v102, v98, s41
  v_perm_b32 v41, v110, v106, s41
  v_perm_b32 v42, v118, v114, s41
  v_perm_b32 v43, v126, v122, s41
  s_nop 1
  v_mfma_f32_32x32x16_bf16 v[192:207], v[40:43], a[220:223], v[192:207]
  v_perm_b32 v44, v102, v98, s42
  v_perm_b32 v45, v110, v106, s42
  v_perm_b32 v46, v118, v114, s42
  v_perm_b32 v47, v126, v122, s42
  s_nop 1
  v_mfma_f32_32x32x16_bf16 v[208:223], v[44:47], a[220:223], v[208:223]
  s_waitcnt vmcnt(4)
  buffer_load_dwordx4 v[92:95], v2, s[12:15], s45 offen offset:3072 nt
  v_perm_b32 v48, v103, v99, s41
  v_perm_b32 v49, v111, v107, s41
  v_perm_b32 v50, v119, v115, s41
  v_perm_b32 v51, v127, v123, s41
  s_nop 1
  v_mfma_f32_32x32x16_bf16 v[224:239], v[48:51], a[220:223], v[224:239]
  v_perm_b32 v52, v103, v99, s42
  v_perm_b32 v53, v111, v107, s42
  v_perm_b32 v54, v119, v115, s42
  v_perm_b32 v55, v127, v123, s42
  s_nop 1
  v_mfma_f32_32x32x16_bf16 v[240:255], v[52:55], a[220:223], v[240:255]
  s_waitcnt vmcnt(4)
  buffer_load_dwordx4 v[96:99], v2, s[12:15], s46 offen offset:0 nt
  s_waitcnt vmcnt(4)
  buffer_load_dwordx4 v[100:103], v2, s[12:15], s46 offen offset:1024 nt
  s_waitcnt vmcnt(5)
  s_cbranch_vccnz L_w56
  s_waitcnt vmcnt(4)
L_w56:
  buffer_load_dwordx4 v[104:107], v2, s[12:15], s46 offen offset:2048 nt
  s_waitcnt vmcnt(4)
  buffer_load_dwordx4 v[108:111], v2, s[12:15], s46 offen offset:3072 nt
  s_waitcnt vmcnt(4)
  buffer_load_dwordx4 v[112:115], v2, s[12:15], s47 offen offset:0 nt
  v_perm_b32 v40, v68, v64, s41
  v_perm_b32 v41, v76, v72, s41
  v_perm_b32 v42, v84, v80, s41
  v_perm_b32 v43, v92, v88, s41
  v_pk_mul_f32 v[128:129], v[128:129], v[28:29] op_sel_hi:[1,0]
  v_pk_mul_f32 v[130:131], v[130:131], v[28:29] op_sel_hi:[1,0]
  v_pk_mul_f32 v[132:133], v[132:133], v[28:29] op_sel_hi:[1,0]
  v_pk_mul_f32 v[134:135], v[134:135], v[28:29] op_sel_hi:[1,0]
  v_pk_mul_f32 v[136:137], v[136:137], v[28:29] op_sel_hi:[1,0]
  v_pk_mul_f32 v[138:139], v[138:139], v[28:29] op_sel_hi:[1,0]
  v_pk_mul_f32 v[140:141], v[140:141], v[28:29] op_sel_hi:[1,0]
  v_pk_mul_f32 v[142:143], v[142:143], v[28:29] op_sel_hi:[1,0]
  s_nop 1
  v_mfma_f32_32x32x16_bf16 v[128:143], v[40:43], a[224:227], v[128:143]
  v_perm_b32 v44, v68, v64, s42
  v_perm_b32 v45, v76, v72, s42
  v_perm_b32 v46, v84, v80, s42
  v_perm_b32 v47, v92, v88, s42
  v_pk_mul_f32 v[144:145], v[144:145], v[28:29] op_sel_hi:[1,0]
  v_pk_mul_f32 v[146:147], v[146:147], v[28:29] op_sel_hi:[1,0]
  v_pk_mul_f32 v[148:149], v[148:149], v[28:29] op_sel_hi:[1,0]
  v_pk_mul_f32 v[150:151], v[150:151], v[28:29] op_sel_hi:[1,0]
  v_pk_mul_f32 v[152:153], v[152:153], v[28:29] op_sel_hi:[1,0]
  v_pk_mul_f32 v[154:155], v[154:155], v[28:29] op_sel_hi:[1,0]
  v_pk_mul_f32 v[156:157], v[156:157], v[28:29] op_sel_hi:[1,0]
  v_pk_mul_f32 v[158:159], v[158:159], v[28:29] op_sel_hi:[1,0]
  s_nop 1
  v_mfma_f32_32x32x16_bf16 v[144:159], v[44:47], a[224:227], v[144:159]
  s_waitcnt vmcnt(4)
  buffer_load_dwordx4 v[116:119], v2, s[12:15], s47 offen offset:1024 nt
  v_perm_b32 v48, v69, v65, s41
  v_perm_b32 v49, v77, v73, s41
  v_perm_b32 v50, v85, v81, s41
  v_perm_b32 v51, v93, v89, s41
  v_pk_mul_f32 v[160:161], v[160:161], v[28:29] op_sel_hi:[1,0]
  v_pk_mul_f32 v[162:163], v[162:163], v[28:29] op_sel_hi:[1,0]
  v_pk_mul_f32 v[164:165], v[164:165], v[28:29] op_sel_hi:[1,0]
  v_pk_mul_f32 v[166:167], v[166:167], v[28:29] op_sel_hi:[1,0]
  v_pk_mul_f32 v[168:169], v[168:169], v[28:29] op_sel_hi:[1,0]
  v_pk_mul_f32 v[170:171], v[170:171], v[28:29] op_sel_hi:[1,0]
  v_pk_mul_f32 v[172:173], v[172:173], v[28:29] op_sel_hi:[1,0]
  v_pk_mul_f32 v[174:175], v[174:175], v[28:29] op_sel_hi:[1,0]
  s_nop 1
  v_mfma_f32_32x32x16_bf16 v[160:175], v[48:51], a[224:227], v[160:175]
  v_perm_b32 v52, v69, v65, s42
  v_perm_b32 v53, v77, v73, s42
  v_perm_b32 v54, v85, v81, s42
  v_perm_b32 v55, v93, v89, s42
  v_pk_mul_f32 v[176:177], v[176:177], v[28:29] op_sel_hi:[1,0]
  v_pk_mul_f32 v[178:179], v[178:179], v[28:29] op_sel_hi:[1,0]
  v_pk_mul_f32 v[180:181], v[180:181], v[28:29] op_sel_hi:[1,0]
  v_pk_mul_f32 v[182:183], v[182:183], v[28:29] op_sel_hi:[1,0]
  v_pk_mul_f32 v[184:185], v[184:185], v[28:29] op_sel_hi:[1,0]
  v_pk_mul_f32 v[186:187], v[186:187], v[28:29] op_sel_hi:[1,0]
  v_pk_mul_f32 v[188:189], v[188:189], v[28:29] op_sel_hi:[1,0]
  v_pk_mul_f32 v[190:191], v[190:191], v[28:29] op_sel_hi:[1,0]
  s_nop 1
  v_mfma_f32_32x32x16_bf16 v[176:191], v[52:55], a[224:227], v[176:191]
  s_waitcnt vmcnt(4)
  buffer_load_dwordx4 v[120:123], v2, s[12:15], s47 offen offset:2048 nt
  v_perm_b32 v40, v70, v66, s41
  v_perm_b32 v41, v78, v74, s41
  v_perm_b32 v42, v86, v82, s41
  v_perm_b32 v43, v94, v90, s41
  v_pk_mul_f32 v[192:193], v[192:193], v[28:29] op_sel_hi:[1,0]
  v_pk_mul_f32 v[194:195], v[194:195], v[28:29] op_sel_hi:[1,0]
  v_pk_mul_f32 v[196:197], v[196:197], v[28:29] op_sel_hi:[1,0]
  v_pk_mul_f32 v[198:199], v[198:199], v[28:29] op_sel_hi:[1,0]
  v_pk_mul_f32 v[200:201], v[200:201], v[28:29] op_sel_hi:[1,0]
  v_pk_mul_f32 v[202:203], v[202:203], v[28:29] op_sel_hi:[1,0]
  v_pk_mul_f32 v[204:205], v[204:205], v[28:29] op_sel_hi:[1,0]
  v_pk_mul_f32 v[206:207], v[206:207], v[28:29] op_sel_hi:[1,0]
  s_nop 1
  v_mfma_f32_32x32x16_bf16 v[192:207], v[40:43], a[224:227], v[192:207]
  v_perm_b32 v44, v70, v66, s42
  v_perm_b32 v45, v78, v74, s42
  v_perm_b32 v46, v86, v82, s42
  v_perm_b32 v47, v94, v90, s42
  v_pk_mul_f32 v[208:209], v[208:209], v[28:29] op_sel_hi:[1,0]
  v_pk_mul_f32 v[210:211], v[210:211], v[28:29] op_sel_hi:[1,0]
  v_pk_mul_f32 v[212:213], v[212:213], v[28:29] op_sel_hi:[1,0]
  v_pk_mul_f32 v[214:215], v[214:215], v[28:29] op_sel_hi:[1,0]
  v_pk_mul_f32 v[216:217], v[216:217], v[28:29] op_sel_hi:[1,0]
  v_pk_mul_f32 v[218:219], v[218:219], v[28:29] op_sel_hi:[1,0]
  v_pk_mul_f32 v[220:221], v[220:221], v[28:29] op_sel_hi:[1,0]
  v_pk_mul_f32 v[222:223], v[222:223], v[28:29] op_sel_hi:[1,0]
  s_nop 1
  v_mfma_f32_32x32x16_bf16 v[208:223], v[44:47], a[224:227], v[208:223]
  s_waitcnt vmcnt(4)
  buffer_load_dwordx4 v[124:127], v2, s[12:15], s47 offen offset:3072 nt
  v_perm_b32 v48, v71, v67, s41
  v_perm_b32 v49, v79, v75, s41
  v_perm_b32 v50, v87, v83, s41
  v_perm_b32 v51, v95, v91, s41
  v_pk_mul_f32 v[224:225], v[224:225], v[28:29] op_sel_hi:[1,0]
  v_pk_mul_f32 v[226:227], v[226:227], v[28:29] op_sel_hi:[1,0]
  v_pk_mul_f32 v[228:229], v[228:229], v[28:29] op_sel_hi:[1,0]
  v_pk_mul_f32 v[230:231], v[230:231], v[28:29] op_sel_hi:[1,0]
  v_pk_mul_f32 v[232:233], v[232:233], v[28:29] op_sel_hi:[1,0]
  v_pk_mul_f32 v[234:235], v[234:235], v[28:29] op_sel_hi:[1,0]
  v_pk_mul_f32 v[236:237], v[236:237], v[28:29] op_sel_hi:[1,0]
  v_pk_mul_f32 v[238:239], v[238:239], v[28:29] op_sel_hi:[1,0]
  s_nop 1
  v_mfma_f32_32x32x16_bf16 v[224:239], v[48:51], a[224:227], v[224:239]
  v_perm_b32 v52, v71, v67, s42
  v_perm_b32 v53, v79, v75, s42
  v_perm_b32 v54, v87, v83, s42
  v_perm_b32 v55, v95, v91, s42
  v_pk_mul_f32 v[240:241], v[240:241], v[28:29] op_sel_hi:[1,0]
  v_pk_mul_f32 v[242:243], v[242:243], v[28:29] op_sel_hi:[1,0]
  v_pk_mul_f32 v[244:245], v[244:245], v[28:29] op_sel_hi:[1,0]
  v_pk_mul_f32 v[246:247], v[246:247], v[28:29] op_sel_hi:[1,0]
  v_pk_mul_f32 v[248:249], v[248:249], v[28:29] op_sel_hi:[1,0]
  v_pk_mul_f32 v[250:251], v[250:251], v[28:29] op_sel_hi:[1,0]
  v_pk_mul_f32 v[252:253], v[252:253], v[28:29] op_sel_hi:[1,0]
  v_pk_mul_f32 v[254:255], v[254:255], v[28:29] op_sel_hi:[1,0]
  s_nop 1
  v_mfma_f32_32x32x16_bf16 v[240:255], v[52:55], a[224:227], v[240:255]
  s_add_u32 s44, s55, 851968
  s_add_u32 s45, s55, 868352
  s_add_u32 s46, s55, 884736
  s_add_u32 s47, s55, 901120
  s_waitcnt vmcnt(4)
  buffer_load_dwordx4 v[64:67], v2, s[12:15], s44 offen offset:0 nt
  s_waitcnt vmcnt(4)
  buffer_load_dwordx4 v[68:71], v2, s[12:15], s44 offen offset:1024 nt
  s_waitcnt vmcnt(5)
  s_cbranch_vccnz L_w57
  s_waitcnt vmcnt(4)
L_w57:
  buffer_load_dwordx4 v[72:75], v2, s[12:15], s44 offen offset:2048 nt
  s_waitcnt vmcnt(4)
  buffer_load_dwordx4 v[76:79], v2, s[12:15], s44 offen offset:3072 nt
  s_waitcnt vmcnt(4)
  buffer_load_dwordx4 v[80:83], v2, s[12:15], s45 offen offset:0 nt
  v_perm_b32 v40, v100, v96, s41
  v_perm_b32 v41, v108, v104, s41
  v_perm_b32 v42, v116, v112, s41
  v_perm_b32 v43, v124, v120, s41
  s_nop 1
  v_mfma_f32_32x32x16_bf16 v[128:143], v[40:43], a[228:231], v[128:143]
  v_perm_b32 v44, v100, v96, s42
  v_perm_b32 v45, v108, v104, s42
  v_perm_b32 v46, v116, v112, s42
  v_perm_b32 v47, v124, v120, s42
  s_nop 1
  v_mfma_f32_32x32x16_bf16 v[144:159], v[44:47], a[228:231], v[144:159]
  s_waitcnt vmcnt(4)
  buffer_load_dwordx4 v[84:87], v2, s[12:15], s45 offen offset:1024 nt
  v_perm_b32 v48, v101, v97, s41
  v_perm_b32 v49, v109, v105, s41
  v_perm_b32 v50, v117, v113, s41
  v_perm_b32 v51, v125, v121, s41
  s_nop 1
  v_mfma_f32_32x32x16_bf16 v[160:175], v[48:51], a[228:231], v[160:175]
  v_perm_b32 v52, v101, v97, s42
  v_perm_b32 v53, v109, v105, s42
  v_perm_b32 v54, v117, v113, s42
  v_perm_b32 v55, v125, v121, s42
  s_nop 1
  v_mfma_f32_32x32x16_bf16 v[176:191], v[52:55], a[228:231], v[176:191]
  s_waitcnt vmcnt(4)
  buffer_load_dwordx4 v[88:91], v2, s[12:15], s45 offen offset:2048 nt
  v_perm_b32 v40, v102, v98, s41
  v_perm_b32 v41, v110, v106, s41
  v_perm_b32 v42, v118, v114, s41
  v_perm_b32 v43, v126, v122, s41
  s_nop 1
  v_mfma_f32_32x32x16_bf16 v[192:207], v[40:43], a[228:231], v[192:207]
  v_perm_b32 v44, v102, v98, s42
  v_perm_b32 v45, v110, v106, s42
  v_perm_b32 v46, v118, v114, s42
  v_perm_b32 v47, v126, v122, s42
  s_nop 1
  v_mfma_f32_32x32x16_bf16 v[208:223], v[44:47], a[228:231], v[208:223]
  s_waitcnt vmcnt(4)
  buffer_load_dwordx4 v[92:95], v2, s[12:15], s45 offen offset:3072 nt
  v_perm_b32 v48, v103, v99, s41
  v_perm_b32 v49, v111, v107, s41
  v_perm_b32 v50, v119, v115, s41
  v_perm_b32 v51, v127, v123, s41
  s_nop 1
  v_mfma_f32_32x32x16_bf16 v[224:239], v[48:51], a[228:231], v[224:239]
  v_perm_b32 v52, v103, v99, s42
  v_perm_b32 v53, v111, v107, s42
  v_perm_b32 v54, v119, v115, s42
  v_perm_b32 v55, v127, v123, s42
  s_nop 1
  v_mfma_f32_32x32x16_bf16 v[240:255], v[52:55], a[228:231], v[240:255]
  s_waitcnt vmcnt(4)
  buffer_load_dwordx4 v[96:99], v2, s[12:15], s46 offen offset:0 nt
  s_waitcnt vmcnt(4)
  buffer_load_dwordx4 v[100:103], v2, s[12:15], s46 offen offset:1024 nt
  s_waitcnt vmcnt(5)
  s_cbranch_vccnz L_w58
  s_waitcnt vmcnt(4)
L_w58:
  buffer_load_dwordx4 v[104:107], v2, s[12:15], s46 offen offset:2048 nt
  s_waitcnt vmcnt(4)
  buffer_load_dwordx4 v[108:111], v2, s[12:15], s46 offen offset:3072 nt
  s_waitcnt vmcnt(4)
  buffer_load_dwordx4 v[112:115], v2, s[12:15], s47 offen offset:0 nt
  v_perm_b32 v40, v68, v64, s41
  v_perm_b32 v41, v76, v72, s41
  v_perm_b32 v42, v84, v80, s41
  v_perm_b32 v43, v92, v88, s41
  v_pk_mul_f32 v[128:129], v[128:129], v[28:29] op_sel:[0,1] op_sel_hi:[1,1]
  v_pk_mul_f32 v[130:131], v[130:131], v[28:29] op_sel:[0,1] op_sel_hi:[1,1]
  v_pk_mul_f32 v[132:133], v[132:133], v[28:29] op_sel:[0,1] op_sel_hi:[1,1]
  v_pk_mul_f32 v[134:135], v[134:135], v[28:29] op_sel:[0,1] op_sel_hi:[1,1]
  v_pk_mul_f32 v[136:137], v[136:137], v[28:29] op_sel:[0,1] op_sel_hi:[1,1]
  v_pk_mul_f32 v[138:139], v[138:139], v[28:29] op_sel:[0,1] op_sel_hi:[1,1]
  v_pk_mul_f32 v[140:141], v[140:141], v[28:29] op_sel:[0,1] op_sel_hi:[1,1]
  v_pk_mul_f32 v[142:143], v[142:143], v[28:29] op_sel:[0,1] op_sel_hi:[1,1]
  s_nop 1
  v_mfma_f32_32x32x16_bf16 v[128:143], v[40:43], a[232:235], v[128:143]
  v_perm_b32 v44, v68, v64, s42
  v_perm_b32 v45, v76, v72, s42
  v_perm_b32 v46, v84, v80, s42
  v_perm_b32 v47, v92, v88, s42
  v_pk_mul_f32 v[144:145], v[144:145], v[28:29] op_sel:[0,1] op_sel_hi:[1,1]
  v_pk_mul_f32 v[146:147], v[146:147], v[28:29] op_sel:[0,1] op_sel_hi:[1,1]
  v_pk_mul_f32 v[148:149], v[148:149], v[28:29] op_sel:[0,1] op_sel_hi:[1,1]
  v_pk_mul_f32 v[150:151], v[150:151], v[28:29] op_sel:[0,1] op_sel_hi:[1,1]
  v_pk_mul_f32 v[152:153], v[152:153], v[28:29] op_sel:[0,1] op_sel_hi:[1,1]
  v_pk_mul_f32 v[154:155], v[154:155], v[28:29] op_sel:[0,1] op_sel_hi:[1,1]
  v_pk_mul_f32 v[156:157], v[156:157], v[28:29] op_sel:[0,1] op_sel_hi:[1,1]
  v_pk_mul_f32 v[158:159], v[158:159], v[28:29] op_sel:[0,1] op_sel_hi:[1,1]
  s_nop 1
  v_mfma_f32_32x32x16_bf16 v[144:159], v[44:47], a[232:235], v[144:159]
  s_waitcnt vmcnt(4)
  buffer_load_dwordx4 v[116:119], v2, s[12:15], s47 offen offset:1024 nt
  v_perm_b32 v48, v69, v65, s41
  v_perm_b32 v49, v77, v73, s41
  v_perm_b32 v50, v85, v81, s41
  v_perm_b32 v51, v93, v89, s41
  v_pk_mul_f32 v[160:161], v[160:161], v[28:29] op_sel:[0,1] op_sel_hi:[1,1]
  v_pk_mul_f32 v[162:163], v[162:163], v[28:29] op_sel:[0,1] op_sel_hi:[1,1]
  v_pk_mul_f32 v[164:165], v[164:165], v[28:29] op_sel:[0,1] op_sel_hi:[1,1]
  v_pk_mul_f32 v[166:167], v[166:167], v[28:29] op_sel:[0,1] op_sel_hi:[1,1]
  v_pk_mul_f32 v[168:169], v[168:169], v[28:29] op_sel:[0,1] op_sel_hi:[1,1]
  v_pk_mul_f32 v[170:171], v[170:171], v[28:29] op_sel:[0,1] op_sel_hi:[1,1]
  v_pk_mul_f32 v[172:173], v[172:173], v[28:29] op_sel:[0,1] op_sel_hi:[1,1]
  v_pk_mul_f32 v[174:175], v[174:175], v[28:29] op_sel:[0,1] op_sel_hi:[1,1]
  s_nop 1
  v_mfma_f32_32x32x16_bf16 v[160:175], v[48:51], a[232:235], v[160:175]
  v_perm_b32 v52, v69, v65, s42
  v_perm_b32 v53, v77, v73, s42
  v_perm_b32 v54, v85, v81, s42
  v_perm_b32 v55, v93, v89, s42
  v_pk_mul_f32 v[176:177], v[176:177], v[28:29] op_sel:[0,1] op_sel_hi:[1,1]
  v_pk_mul_f32 v[178:179], v[178:179], v[28:29] op_sel:[0,1] op_sel_hi:[1,1]
  v_pk_mul_f32 v[180:181], v[180:181], v[28:29] op_sel:[0,1] op_sel_hi:[1,1]
  v_pk_mul_f32 v[182:183], v[182:183], v[28:29] op_sel:[0,1] op_sel_hi:[1,1]
  v_pk_mul_f32 v[184:185], v[184:185], v[28:29] op_sel:[0,1] op_sel_hi:[1,1]
  v_pk_mul_f32 v[186:187], v[186:187], v[28:29] op_sel:[0,1] op_sel_hi:[1,1]
  v_pk_mul_f32 v[188:189], v[188:189], v[28:29] op_sel:[0,1] op_sel_hi:[1,1]
  v_pk_mul_f32 v[190:191], v[190:191], v[28:29] op_sel:[0,1] op_sel_hi:[1,1]
  s_nop 1
  v_mfma_f32_32x32x16_bf16 v[176:191], v[52:55], a[232:235], v[176:191]
  s_waitcnt vmcnt(4)
  buffer_load_dwordx4 v[120:123], v2, s[12:15], s47 offen offset:2048 nt
  v_perm_b32 v40, v70, v66, s41
  v_perm_b32 v41, v78, v74, s41
  v_perm_b32 v42, v86, v82, s41
  v_perm_b32 v43, v94, v90, s41
  v_pk_mul_f32 v[192:193], v[192:193], v[28:29] op_sel:[0,1] op_sel_hi:[1,1]
  v_pk_mul_f32 v[194:195], v[194:195], v[28:29] op_sel:[0,1] op_sel_hi:[1,1]
  v_pk_mul_f32 v[196:197], v[196:197], v[28:29] op_sel:[0,1] op_sel_hi:[1,1]
  v_pk_mul_f32 v[198:199], v[198:199], v[28:29] op_sel:[0,1] op_sel_hi:[1,1]
  v_pk_mul_f32 v[200:201], v[200:201], v[28:29] op_sel:[0,1] op_sel_hi:[1,1]
  v_pk_mul_f32 v[202:203], v[202:203], v[28:29] op_sel:[0,1] op_sel_hi:[1,1]
  v_pk_mul_f32 v[204:205], v[204:205], v[28:29] op_sel:[0,1] op_sel_hi:[1,1]
  v_pk_mul_f32 v[206:207], v[206:207], v[28:29] op_sel:[0,1] op_sel_hi:[1,1]
  s_nop 1
  v_mfma_f32_32x32x16_bf16 v[192:207], v[40:43], a[232:235], v[192:207]
  v_perm_b32 v44, v70, v66, s42
  v_perm_b32 v45, v78, v74, s42
  v_perm_b32 v46, v86, v82, s42
  v_perm_b32 v47, v94, v90, s42
  v_pk_mul_f32 v[208:209], v[208:209], v[28:29] op_sel:[0,1] op_sel_hi:[1,1]
  v_pk_mul_f32 v[210:211], v[210:211], v[28:29] op_sel:[0,1] op_sel_hi:[1,1]
  v_pk_mul_f32 v[212:213], v[212:213], v[28:29] op_sel:[0,1] op_sel_hi:[1,1]
  v_pk_mul_f32 v[214:215], v[214:215], v[28:29] op_sel:[0,1] op_sel_hi:[1,1]
  v_pk_mul_f32 v[216:217], v[216:217], v[28:29] op_sel:[0,1] op_sel_hi:[1,1]
  v_pk_mul_f32 v[218:219], v[218:219], v[28:29] op_sel:[0,1] op_sel_hi:[1,1]
  v_pk_mul_f32 v[220:221], v[220:221], v[28:29] op_sel:[0,1] op_sel_hi:[1,1]
  v_pk_mul_f32 v[222:223], v[222:223], v[28:29] op_sel:[0,1] op_sel_hi:[1,1]
  s_nop 1
  v_mfma_f32_32x32x16_bf16 v[208:223], v[44:47], a[232:235], v[208:223]
  s_waitcnt vmcnt(4)
  buffer_load_dwordx4 v[124:127], v2, s[12:15], s47 offen offset:3072 nt
  v_perm_b32 v48, v71, v67, s41
  v_perm_b32 v49, v79, v75, s41
  v_perm_b32 v50, v87, v83, s41
  v_perm_b32 v51, v95, v91, s41
  v_pk_mul_f32 v[224:225], v[224:225], v[28:29] op_sel:[0,1] op_sel_hi:[1,1]
  v_pk_mul_f32 v[226:227], v[226:227], v[28:29] op_sel:[0,1] op_sel_hi:[1,1]
  v_pk_mul_f32 v[228:229], v[228:229], v[28:29] op_sel:[0,1] op_sel_hi:[1,1]
  v_pk_mul_f32 v[230:231], v[230:231], v[28:29] op_sel:[0,1] op_sel_hi:[1,1]
  v_pk_mul_f32 v[232:233], v[232:233], v[28:29] op_sel:[0,1] op_sel_hi:[1,1]
  v_pk_mul_f32 v[234:235], v[234:235], v[28:29] op_sel:[0,1] op_sel_hi:[1,1]
  v_pk_mul_f32 v[236:237], v[236:237], v[28:29] op_sel:[0,1] op_sel_hi:[1,1]
  v_pk_mul_f32 v[238:239], v[238:239], v[28:29] op_sel:[0,1] op_sel_hi:[1,1]
  s_nop 1
  v_mfma_f32_32x32x16_bf16 v[224:239], v[48:51], a[232:235], v[224:239]
  v_perm_b32 v52, v71, v67, s42
  v_perm_b32 v53, v79, v75, s42
  v_perm_b32 v54, v87, v83, s42
  v_perm_b32 v55, v95, v91, s42
  v_pk_mul_f32 v[240:241], v[240:241], v[28:29] op_sel:[0,1] op_sel_hi:[1,1]
  v_pk_mul_f32 v[242:243], v[242:243], v[28:29] op_sel:[0,1] op_sel_hi:[1,1]
  v_pk_mul_f32 v[244:245], v[244:245], v[28:29] op_sel:[0,1] op_sel_hi:[1,1]
  v_pk_mul_f32 v[246:247], v[246:247], v[28:29] op_sel:[0,1] op_sel_hi:[1,1]
  v_pk_mul_f32 v[248:249], v[248:249], v[28:29] op_sel:[0,1] op_sel_hi:[1,1]
  v_pk_mul_f32 v[250:251], v[250:251], v[28:29] op_sel:[0,1] op_sel_hi:[1,1]
  v_pk_mul_f32 v[252:253], v[252:253], v[28:29] op_sel:[0,1] op_sel_hi:[1,1]
  v_pk_mul_f32 v[254:255], v[254:255], v[28:29] op_sel:[0,1] op_sel_hi:[1,1]
  s_nop 1
  v_mfma_f32_32x32x16_bf16 v[240:255], v[52:55], a[232:235], v[240:255]
  s_add_u32 s44, s55, 917504
  s_add_u32 s45, s55, 933888
  s_add_u32 s46, s55, 950272
  s_add_u32 s47, s55, 966656
  s_waitcnt vmcnt(4)
  buffer_load_dwordx4 v[64:67], v2, s[12:15], s44 offen offset:0 nt
  s_waitcnt vmcnt(4)
  buffer_load_dwordx4 v[68:71], v2, s[12:15], s44 offen offset:1024 nt
  s_waitcnt vmcnt(5)
  s_cbranch_vccnz L_w59
  s_waitcnt vmcnt(4)
L_w59:
  buffer_load_dwordx4 v[72:75], v2, s[12:15], s44 offen offset:2048 nt
  s_waitcnt vmcnt(4)
  buffer_load_dwordx4 v[76:79], v2, s[12:15], s44 offen offset:3072 nt
  s_waitcnt vmcnt(4)
  buffer_load_dwordx4 v[80:83], v2, s[12:15], s45 offen offset:0 nt
  v_perm_b32 v40, v100, v96, s41
  v_perm_b32 v41, v108, v104, s41
  v_perm_b32 v42, v116, v112, s41
  v_perm_b32 v43, v124, v120, s41
  s_nop 1
  v_mfma_f32_32x32x16_bf16 v[128:143], v[40:43], a[236:239], v[128:143]
  v_perm_b32 v44, v100, v96, s42
  v_perm_b32 v45, v108, v104, s42
  v_perm_b32 v46, v116, v112, s42
  v_perm_b32 v47, v124, v120, s42
  s_nop 1
  v_mfma_f32_32x32x16_bf16 v[144:159], v[44:47], a[236:239], v[144:159]
  s_waitcnt vmcnt(4)
  buffer_load_dwordx4 v[84:87], v2, s[12:15], s45 offen offset:1024 nt
  v_perm_b32 v48, v101, v97, s41
  v_perm_b32 v49, v109, v105, s41
  v_perm_b32 v50, v117, v113, s41
  v_perm_b32 v51, v125, v121, s41
  s_nop 1
  v_mfma_f32_32x32x16_bf16 v[160:175], v[48:51], a[236:239], v[160:175]
  v_perm_b32 v52, v101, v97, s42
  v_perm_b32 v53, v109, v105, s42
  v_perm_b32 v54, v117, v113, s42
  v_perm_b32 v55, v125, v121, s42
  s_nop 1
  v_mfma_f32_32x32x16_bf16 v[176:191], v[52:55], a[236:239], v[176:191]
  buffer_load_dword v61, v60, s[72:75], 0 offen sc1
  s_waitcnt vmcnt(4)
  buffer_load_dwordx4 v[88:91], v2, s[12:15], s45 offen offset:2048 nt
  v_perm_b32 v40, v102, v98, s41
  v_perm_b32 v41, v110, v106, s41
  v_perm_b32 v42, v118, v114, s41
  v_perm_b32 v43, v126, v122, s41
  s_nop 1
  v_mfma_f32_32x32x16_bf16 v[192:207], v[40:43], a[236:239], v[192:207]
  v_perm_b32 v44, v102, v98, s42
  v_perm_b32 v45, v110, v106, s42
  v_perm_b32 v46, v118, v114, s42
  v_perm_b32 v47, v126, v122, s42
  s_nop 1
  v_mfma_f32_32x32x16_bf16 v[208:223], v[44:47], a[236:239], v[208:223]
  s_waitcnt vmcnt(4)
  buffer_load_dwordx4 v[92:95], v2, s[12:15], s45 offen offset:3072 nt
  v_perm_b32 v48, v103, v99, s41
  v_perm_b32 v49, v111, v107, s41
  v_perm_b32 v50, v119, v115, s41
  v_perm_b32 v51, v127, v123, s41
  s_nop 1
  v_mfma_f32_32x32x16_bf16 v[224:239], v[48:51], a[236:239], v[224:239]
  v_perm_b32 v52, v103, v99, s42
  v_perm_b32 v53, v111, v107, s42
  v_perm_b32 v54, v119, v115, s42
  v_perm_b32 v55, v127, v123, s42
  s_nop 1
  v_mfma_f32_32x32x16_bf16 v[240:255], v[52:55], a[236:239], v[240:255]
  s_waitcnt vmcnt(4)
  buffer_load_dwordx4 v[96:99], v2, s[12:15], s46 offen offset:0 nt
  s_waitcnt vmcnt(4)
  buffer_load_dwordx4 v[100:103], v2, s[12:15], s46 offen offset:1024 nt
  s_waitcnt vmcnt(5)
  s_cbranch_vccnz L_w60
  s_waitcnt vmcnt(4)
L_w60:
  buffer_load_dwordx4 v[104:107], v2, s[12:15], s46 offen offset:2048 nt
  s_waitcnt vmcnt(4)
  buffer_load_dwordx4 v[108:111], v2, s[12:15], s46 offen offset:3072 nt
  s_waitcnt vmcnt(4)
  buffer_load_dwordx4 v[112:115], v2, s[12:15], s47 offen offset:0 nt
  v_perm_b32 v40, v68, v64, s41
  v_perm_b32 v41, v76, v72, s41
  v_perm_b32 v42, v84, v80, s41
  v_perm_b32 v43, v92, v88, s41
  v_pk_mul_f32 v[128:129], v[128:129], v[30:31] op_sel_hi:[1,0]
  v_pk_mul_f32 v[130:131], v[130:131], v[30:31] op_sel_hi:[1,0]
  v_pk_mul_f32 v[132:133], v[132:133], v[30:31] op_sel_hi:[1,0]
  v_pk_mul_f32 v[134:135], v[134:135], v[30:31] op_sel_hi:[1,0]
  v_pk_mul_f32 v[136:137], v[136:137], v[30:31] op_sel_hi:[1,0]
  v_pk_mul_f32 v[138:139], v[138:139], v[30:31] op_sel_hi:[1,0]
  v_pk_mul_f32 v[140:141], v[140:141], v[30:31] op_sel_hi:[1,0]
  v_pk_mul_f32 v[142:143], v[142:143], v[30:31] op_sel_hi:[1,0]
  s_nop 1
  v_mfma_f32_32x32x16_bf16 v[128:143], v[40:43], a[240:243], v[128:143]
  v_perm_b32 v44, v68, v64, s42
  v_perm_b32 v45, v76, v72, s42
  v_perm_b32 v46, v84, v80, s42
  v_perm_b32 v47, v92, v88, s42
  v_pk_mul_f32 v[144:145], v[144:145], v[30:31] op_sel_hi:[1,0]
  v_pk_mul_f32 v[146:147], v[146:147], v[30:31] op_sel_hi:[1,0]
  v_pk_mul_f32 v[148:149], v[148:149], v[30:31] op_sel_hi:[1,0]
  v_pk_mul_f32 v[150:151], v[150:151], v[30:31] op_sel_hi:[1,0]
  v_pk_mul_f32 v[152:153], v[152:153], v[30:31] op_sel_hi:[1,0]
  v_pk_mul_f32 v[154:155], v[154:155], v[30:31] op_sel_hi:[1,0]
  v_pk_mul_f32 v[156:157], v[156:157], v[30:31] op_sel_hi:[1,0]
  v_pk_mul_f32 v[158:159], v[158:159], v[30:31] op_sel_hi:[1,0]
  s_nop 1
  v_mfma_f32_32x32x16_bf16 v[144:159], v[44:47], a[240:243], v[144:159]
  s_waitcnt vmcnt(4)
  buffer_load_dwordx4 v[116:119], v2, s[12:15], s47 offen offset:1024 nt
  v_perm_b32 v48, v69, v65, s41
  v_perm_b32 v49, v77, v73, s41
  v_perm_b32 v50, v85, v81, s41
  v_perm_b32 v51, v93, v89, s41
  v_pk_mul_f32 v[160:161], v[160:161], v[30:31] op_sel_hi:[1,0]
  v_pk_mul_f32 v[162:163], v[162:163], v[30:31] op_sel_hi:[1,0]
  v_pk_mul_f32 v[164:165], v[164:165], v[30:31] op_sel_hi:[1,0]
  v_pk_mul_f32 v[166:167], v[166:167], v[30:31] op_sel_hi:[1,0]
  v_pk_mul_f32 v[168:169], v[168:169], v[30:31] op_sel_hi:[1,0]
  v_pk_mul_f32 v[170:171], v[170:171], v[30:31] op_sel_hi:[1,0]
  v_pk_mul_f32 v[172:173], v[172:173], v[30:31] op_sel_hi:[1,0]
  v_pk_mul_f32 v[174:175], v[174:175], v[30:31] op_sel_hi:[1,0]
  s_nop 1
  v_mfma_f32_32x32x16_bf16 v[160:175], v[48:51], a[240:243], v[160:175]
  v_perm_b32 v52, v69, v65, s42
  v_perm_b32 v53, v77, v73, s42
  v_perm_b32 v54, v85, v81, s42
  v_perm_b32 v55, v93, v89, s42
  v_pk_mul_f32 v[176:177], v[176:177], v[30:31] op_sel_hi:[1,0]
  v_pk_mul_f32 v[178:179], v[178:179], v[30:31] op_sel_hi:[1,0]
  v_pk_mul_f32 v[180:181], v[180:181], v[30:31] op_sel_hi:[1,0]
  v_pk_mul_f32 v[182:183], v[182:183], v[30:31] op_sel_hi:[1,0]
  v_pk_mul_f32 v[184:185], v[184:185], v[30:31] op_sel_hi:[1,0]
  v_pk_mul_f32 v[186:187], v[186:187], v[30:31] op_sel_hi:[1,0]
  v_pk_mul_f32 v[188:189], v[188:189], v[30:31] op_sel_hi:[1,0]
  v_pk_mul_f32 v[190:191], v[190:191], v[30:31] op_sel_hi:[1,0]
  s_nop 1
  v_mfma_f32_32x32x16_bf16 v[176:191], v[52:55], a[240:243], v[176:191]
  s_waitcnt vmcnt(4)
  buffer_load_dwordx4 v[120:123], v2, s[12:15], s47 offen offset:2048 nt
  v_perm_b32 v40, v70, v66, s41
  v_perm_b32 v41, v78, v74, s41
  v_perm_b32 v42, v86, v82, s41
  v_perm_b32 v43, v94, v90, s41
  v_pk_mul_f32 v[192:193], v[192:193], v[30:31] op_sel_hi:[1,0]
  v_pk_mul_f32 v[194:195], v[194:195], v[30:31] op_sel_hi:[1,0]
  v_pk_mul_f32 v[196:197], v[196:197], v[30:31] op_sel_hi:[1,0]
  v_pk_mul_f32 v[198:199], v[198:199], v[30:31] op_sel_hi:[1,0]
  v_pk_mul_f32 v[200:201], v[200:201], v[30:31] op_sel_hi:[1,0]
  v_pk_mul_f32 v[202:203], v[202:203], v[30:31] op_sel_hi:[1,0]
  v_pk_mul_f32 v[204:205], v[204:205], v[30:31] op_sel_hi:[1,0]
  v_pk_mul_f32 v[206:207], v[206:207], v[30:31] op_sel_hi:[1,0]
  s_nop 1
  v_mfma_f32_32x32x16_bf16 v[192:207], v[40:43], a[240:243], v[192:207]
  v_perm_b32 v44, v70, v66, s42
  v_perm_b32 v45, v78, v74, s42
  v_perm_b32 v46, v86, v82, s42
  v_perm_b32 v47, v94, v90, s42
  v_pk_mul_f32 v[208:209], v[208:209], v[30:31] op_sel_hi:[1,0]
  v_pk_mul_f32 v[210:211], v[210:211], v[30:31] op_sel_hi:[1,0]
  v_pk_mul_f32 v[212:213], v[212:213], v[30:31] op_sel_hi:[1,0]
  v_pk_mul_f32 v[214:215], v[214:215], v[30:31] op_sel_hi:[1,0]
  v_pk_mul_f32 v[216:217], v[216:217], v[30:31] op_sel_hi:[1,0]
  v_pk_mul_f32 v[218:219], v[218:219], v[30:31] op_sel_hi:[1,0]
  v_pk_mul_f32 v[220:221], v[220:221], v[30:31] op_sel_hi:[1,0]
  v_pk_mul_f32 v[222:223], v[222:223], v[30:31] op_sel_hi:[1,0]
  s_nop 1
  v_mfma_f32_32x32x16_bf16 v[208:223], v[44:47], a[240:243], v[208:223]
  s_waitcnt vmcnt(4)
  buffer_load_dwordx4 v[124:127], v2, s[12:15], s47 offen offset:3072 nt
  v_perm_b32 v48, v71, v67, s41
  v_perm_b32 v49, v79, v75, s41
  v_perm_b32 v50, v87, v83, s41
  v_perm_b32 v51, v95, v91, s41
  v_pk_mul_f32 v[224:225], v[224:225], v[30:31] op_sel_hi:[1,0]
  v_pk_mul_f32 v[226:227], v[226:227], v[30:31] op_sel_hi:[1,0]
  v_pk_mul_f32 v[228:229], v[228:229], v[30:31] op_sel_hi:[1,0]
  v_pk_mul_f32 v[230:231], v[230:231], v[30:31] op_sel_hi:[1,0]
  v_pk_mul_f32 v[232:233], v[232:233], v[30:31] op_sel_hi:[1,0]
  v_pk_mul_f32 v[234:235], v[234:235], v[30:31] op_sel_hi:[1,0]
  v_pk_mul_f32 v[236:237], v[236:237], v[30:31] op_sel_hi:[1,0]
  v_pk_mul_f32 v[238:239], v[238:239], v[30:31] op_sel_hi:[1,0]
  s_nop 1
  v_mfma_f32_32x32x16_bf16 v[224:239], v[48:51], a[240:243], v[224:239]
  v_perm_b32 v52, v71, v67, s42
  v_perm_b32 v53, v79, v75, s42
  v_perm_b32 v54, v87, v83, s42
  v_perm_b32 v55, v95, v91, s42
  v_pk_mul_f32 v[240:241], v[240:241], v[30:31] op_sel_hi:[1,0]
  v_pk_mul_f32 v[242:243], v[242:243], v[30:31] op_sel_hi:[1,0]
  v_pk_mul_f32 v[244:245], v[244:245], v[30:31] op_sel_hi:[1,0]
  v_pk_mul_f32 v[246:247], v[246:247], v[30:31] op_sel_hi:[1,0]
  v_pk_mul_f32 v[248:249], v[248:249], v[30:31] op_sel_hi:[1,0]
  v_pk_mul_f32 v[250:251], v[250:251], v[30:31] op_sel_hi:[1,0]
  v_pk_mul_f32 v[252:253], v[252:253], v[30:31] op_sel_hi:[1,0]
  v_pk_mul_f32 v[254:255], v[254:255], v[30:31] op_sel_hi:[1,0]
  s_nop 1
  v_mfma_f32_32x32x16_bf16 v[240:255], v[52:55], a[240:243], v[240:255]
  s_add_u32 s44, s55, 983040
  s_add_u32 s45, s55, 999424
  s_add_u32 s46, s55, 1015808
  s_add_u32 s47, s55, 1032192
  s_waitcnt vmcnt(7)
  buffer_load_dwordx4 v[64:67], v2, s[12:15], s44 offen offset:0 nt
  s_waitcnt vmcnt(7)
  buffer_load_dwordx4 v[68:71], v2, s[12:15], s44 offen offset:1024 nt
  s_waitcnt vmcnt(7)
  buffer_load_dwordx4 v[72:75], v2, s[12:15], s44 offen offset:2048 nt
  s_waitcnt vmcnt(7)
  buffer_load_dwordx4 v[76:79], v2, s[12:15], s44 offen offset:3072 nt
  s_waitcnt vmcnt(7)
  buffer_load_dwordx4 v[80:83], v2, s[12:15], s45 offen offset:0 nt
  s_waitcnt vmcnt(7)
  buffer_load_dwordx4 v[84:87], v2, s[12:15], s45 offen offset:1024 nt
L_claim_s:
  s_mov_b32 s57, 0x400000
L_claimw_s:
  v_readfirstlane_b32 s56, v61
  s_nop 3
  s_bitcmp1_b32 s56, 16
  s_cbranch_scc1 L_flag_ok_s
  s_sub_u32 s57, s57, 1
  s_cmp_eq_u32 s57, 0
  s_cbranch_scc1 L_flag_ok_s
  s_sleep 8
  buffer_load_dword v61, v60, s[72:75], 0 offen sc1
  s_waitcnt vmcnt(0)
  s_branch L_claimw_s
L_flag_ok_s:
  s_waitcnt vmcnt(7)
  buffer_load_dwordx4 v[88:91], v2, s[12:15], s45 offen offset:2048 nt
  s_waitcnt vmcnt(7)
  buffer_load_dwordx4 v[92:95], v2, s[12:15], s45 offen offset:3072 nt
  v_perm_b32 v40, v100, v96, s41
  v_perm_b32 v41, v108, v104, s41
  v_perm_b32 v42, v116, v112, s41
  v_perm_b32 v43, v124, v120, s41
  s_nop 1
  v_mfma_f32_32x32x16_bf16 v[128:143], v[40:43], a[244:247], v[128:143]
  v_perm_b32 v44, v100, v96, s42
  v_perm_b32 v45, v108, v104, s42
  v_perm_b32 v46, v116, v112, s42
  v_perm_b32 v47, v124, v120, s42
  s_nop 1
  v_mfma_f32_32x32x16_bf16 v[144:159], v[44:47], a[244:247], v[144:159]
  v_perm_b32 v48, v101, v97, s41
  v_perm_b32 v49, v109, v105, s41
  v_perm_b32 v50, v117, v113, s41
  v_perm_b32 v51, v125, v121, s41
  s_nop 1
  v_mfma_f32_32x32x16_bf16 v[160:175], v[48:51], a[244:247], v[160:175]
  v_perm_b32 v52, v101, v97, s42
  v_perm_b32 v53, v109, v105, s42
  v_perm_b32 v54, v117, v113, s42
  v_perm_b32 v55, v125, v121, s42
  s_nop 1
  v_mfma_f32_32x32x16_bf16 v[176:191], v[52:55], a[244:247], v[176:191]
  v_perm_b32 v40, v102, v98, s41
  v_perm_b32 v41, v110, v106, s41
  v_perm_b32 v42, v118, v114, s41
  v_perm_b32 v43, v126, v122, s41
  s_nop 1
  v_mfma_f32_32x32x16_bf16 v[192:207], v[40:43], a[244:247], v[192:207]
  v_perm_b32 v44, v102, v98, s42
  v_perm_b32 v45, v110, v106, s42
  v_perm_b32 v46, v118, v114, s42
  v_perm_b32 v47, v126, v122, s42
  s_nop 1
  v_mfma_f32_32x32x16_bf16 v[208:223], v[44:47], a[244:247], v[208:223]
  v_perm_b32 v48, v103, v99, s41
  v_perm_b32 v49, v111, v107, s41
  v_perm_b32 v50, v119, v115, s41
  v_perm_b32 v51, v127, v123, s41
  s_nop 1
  v_mfma_f32_32x32x16_bf16 v[224:239], v[48:51], a[244:247], v[224:239]
  v_perm_b32 v52, v103, v99, s42
  v_perm_b32 v53, v111, v107, s42
  v_perm_b32 v54, v119, v115, s42
  v_perm_b32 v55, v127, v123, s42
  s_nop 1
  v_mfma_f32_32x32x16_bf16 v[240:255], v[52:55], a[244:247], v[240:255]
  s_waitcnt vmcnt(15)
  buffer_load_dwordx4 v[96:99], v2, s[12:15], s46 offen offset:0 nt
  s_waitcnt vmcnt(15)
  buffer_load_dwordx4 v[100:103], v2, s[12:15], s46 offen offset:1024 nt
  s_waitcnt vmcnt(15)
  buffer_load_dwordx4 v[104:107], v2, s[12:15], s46 offen offset:2048 nt
  s_waitcnt vmcnt(15)
  buffer_load_dwordx4 v[108:111], v2, s[12:15], s46 offen offset:3072 nt
  s_waitcnt vmcnt(15)
  buffer_load_dwordx4 v[112:115], v2, s[12:15], s47 offen offset:0 nt
  v_accvgpr_read_b32 v32, a248
  v_accvgpr_read_b32 v33, a249
  v_accvgpr_read_b32 v34, a250
  v_accvgpr_read_b32 v35, a251
  v_accvgpr_read_b32 v36, a252
  v_accvgpr_read_b32 v37, a253
  v_accvgpr_read_b32 v38, a254
  v_accvgpr_read_b32 v39, a255
  v_mov_b32 v10, v31
  v_mov_b32 v11, v31
  s_waitcnt vmcnt(15)
  buffer_load_dwordx4 v[116:119], v2, s[12:15], s47 offen offset:1024 nt
  s_waitcnt vmcnt(15)
  buffer_load_dwordx4 v[120:123], v2, s[12:15], s47 offen offset:2048 nt
  s_waitcnt vmcnt(15)
  buffer_load_dwordx4 v[124:127], v2, s[12:15], s47 offen offset:3072 nt
L_loop_end:
  v_mov_b32 v8, v7
  v_mov_b32 v9, v7
  s_nop 1
  v_permlane32_swap_b32 v8, v9
  s_nop 1
  v_add_f32 v7, v8, v9
  v_and_b32 v12, 31, v0
  v_lshlrev_b32 v12, 3, v12
  s_lshl_b32 s56, s3, 8
  s_add_u32 s56, s56, 131072
  v_add_u32 v13, s56, v12
  ds_write_b64 v13, v[6:7]
  v_add_u32 v4, s43, v2
  s_mov_b32 s36, s32
  s_and_b32 s37, s33, 0xffff
  s_mov_b32 s38, 0x1000000
  s_mov_b32 s87, 0
  s_lshl_b32 s44, s52, 17
  s_lshl_b32 s58, s3, 13
  s_add_u32 s44, s44, s58
  s_add_u32 s45, s44, 4096
  s_waitcnt vmcnt(8)
  v_perm_b32 v40, v68, v64, s41
  v_perm_b32 v41, v76, v72, s41
  v_perm_b32 v42, v84, v80, s41
  v_perm_b32 v43, v92, v88, s41
  v_pk_mul_f32 v[128:129], v[128:129], v[10:11]
  v_pk_mul_f32 v[130:131], v[130:131], v[10:11]
  v_pk_mul_f32 v[132:133], v[132:133], v[10:11]
  v_pk_mul_f32 v[134:135], v[134:135], v[10:11]
  v_pk_mul_f32 v[136:137], v[136:137], v[10:11]
  v_pk_mul_f32 v[138:139], v[138:139], v[10:11]
  v_pk_mul_f32 v[140:141], v[140:141], v[10:11]
  v_pk_mul_f32 v[142:143], v[142:143], v[10:11]
  s_nop 1
  v_mfma_f32_32x32x16_bf16 v[128:143], v[40:43], v[32:35], v[128:143]
  v_perm_b32 v44, v68, v64, s42
  v_perm_b32 v45, v76, v72, s42
  v_perm_b32 v46, v84, v80, s42
  v_perm_b32 v47, v92, v88, s42
  v_pk_mul_f32 v[144:145], v[144:145], v[10:11]
  v_pk_mul_f32 v[146:147], v[146:147], v[10:11]
  v_pk_mul_f32 v[148:149], v[148:149], v[10:11]
  v_pk_mul_f32 v[150:151], v[150:151], v[10:11]
  v_pk_mul_f32 v[152:153], v[152:153], v[10:11]
  v_pk_mul_f32 v[154:155], v[154:155], v[10:11]
  v_pk_mul_f32 v[156:157], v[156:157], v[10:11]
  v_pk_mul_f32 v[158:159], v[158:159], v[10:11]
  s_nop 1
  v_mfma_f32_32x32x16_bf16 v[144:159], v[44:47], v[32:35], v[144:159]
  v_perm_b32 v48, v69, v65, s41
  v_perm_b32 v49, v77, v73, s41
  v_perm_b32 v50, v85, v81, s41
  v_perm_b32 v51, v93, v89, s41
  v_pk_mul_f32 v[160:161], v[160:161], v[10:11]
  v_pk_mul_f32 v[162:163], v[162:163], v[10:11]
  v_pk_mul_f32 v[164:165], v[164:165], v[10:11]
  v_pk_mul_f32 v[166:167], v[166:167], v[10:11]
  v_pk_mul_f32 v[168:169], v[168:169], v[10:11]
  v_pk_mul_f32 v[170:171], v[170:171], v[10:11]
  v_pk_mul_f32 v[172:173], v[172:173], v[10:11]
  v_pk_mul_f32 v[174:175], v[174:175], v[10:11]
  s_nop 1
  v_mfma_f32_32x32x16_bf16 v[160:175], v[48:51], v[32:35], v[160:175]
  v_perm_b32 v52, v69, v65, s42
  v_perm_b32 v53, v77, v73, s42
  v_perm_b32 v54, v85, v81, s42
  v_perm_b32 v55, v93, v89, s42
  v_pk_mul_f32 v[176:177], v[176:177], v[10:11]
  v_pk_mul_f32 v[178:179], v[178:179], v[10:11]
  v_pk_mul_f32 v[180:181], v[180:181], v[10:11]
  v_pk_mul_f32 v[182:183], v[182:183], v[10:11]
  v_pk_mul_f32 v[184:185], v[184:185], v[10:11]
  v_pk_mul_f32 v[186:187], v[186:187], v[10:11]
  v_pk_mul_f32 v[188:189], v[188:189], v[10:11]
  v_pk_mul_f32 v[190:191], v[190:191], v[10:11]
  s_nop 1
  v_mfma_f32_32x32x16_bf16 v[176:191], v[52:55], v[32:35], v[176:191]
  v_perm_b32 v40, v70, v66, s41
  v_perm_b32 v41, v78, v74, s41
  v_perm_b32 v42, v86, v82, s41
  v_perm_b32 v43, v94, v90, s41
  v_pk_mul_f32 v[192:193], v[192:193], v[10:11]
  v_pk_mul_f32 v[194:195], v[194:195], v[10:11]
  v_pk_mul_f32 v[196:197], v[196:197], v[10:11]
  v_pk_mul_f32 v[198:199], v[198:199], v[10:11]
  v_pk_mul_f32 v[200:201], v[200:201], v[10:11]
  v_pk_mul_f32 v[202:203], v[202:203], v[10:11]
  v_pk_mul_f32 v[204:205], v[204:205], v[10:11]
  v_pk_mul_f32 v[206:207], v[206:207], v[10:11]
  s_nop 1
  v_mfma_f32_32x32x16_bf16 v[192:207], v[40:43], v[32:35], v[192:207]
  v_perm_b32 v44, v70, v66, s42
  v_perm_b32 v45, v78, v74, s42
  v_perm_b32 v46, v86, v82, s42
  v_perm_b32 v47, v94, v90, s42
  v_pk_mul_f32 v[208:209], v[208:209], v[10:11]
  v_pk_mul_f32 v[210:211], v[210:211], v[10:11]
  v_pk_mul_f32 v[212:213], v[212:213], v[10:11]
  v_pk_mul_f32 v[214:215], v[214:215], v[10:11]
  v_pk_mul_f32 v[216:217], v[216:217], v[10:11]
  v_pk_mul_f32 v[218:219], v[218:219], v[10:11]
  v_pk_mul_f32 v[220:221], v[220:221], v[10:11]
  v_pk_mul_f32 v[222:223], v[222:223], v[10:11]
  s_nop 1
  v_mfma_f32_32x32x16_bf16 v[208:223], v[44:47], v[32:35], v[208:223]
  v_perm_b32 v48, v71, v67, s41
  v_perm_b32 v49, v79, v75, s41
  v_perm_b32 v50, v87, v83, s41
  v_perm_b32 v51, v95, v91, s41
  v_pk_mul_f32 v[224:225], v[224:225], v[10:11]
  v_pk_mul_f32 v[226:227], v[226:227], v[10:11]
  v_pk_mul_f32 v[228:229], v[228:229], v[10:11]
  v_pk_mul_f32 v[230:231], v[230:231], v[10:11]
  v_pk_mul_f32 v[232:233], v[232:233], v[10:11]
  v_pk_mul_f32 v[234:235], v[234:235], v[10:11]
  v_pk_mul_f32 v[236:237], v[236:237], v[10:11]
  v_pk_mul_f32 v[238:239], v[238:239], v[10:11]
  s_nop 1
  v_mfma_f32_32x32x16_bf16 v[224:239], v[48:51], v[32:35], v[224:239]
  v_perm_b32 v52, v71, v67, s42
  v_perm_b32 v53, v79, v75, s42
  v_perm_b32 v54, v87, v83, s42
  v_perm_b32 v55, v95, v91, s42
  v_pk_mul_f32 v[240:241], v[240:241], v[10:11]
  v_pk_mul_f32 v[242:243], v[242:243], v[10:11]
  v_pk_mul_f32 v[244:245], v[244:245], v[10:11]
  v_pk_mul_f32 v[246:247], v[246:247], v[10:11]
  v_pk_mul_f32 v[248:249], v[248:249], v[10:11]
  v_pk_mul_f32 v[250:251], v[250:251], v[10:11]
  v_pk_mul_f32 v[252:253], v[252:253], v[10:11]
  v_pk_mul_f32 v[254:255], v[254:255], v[10:11]
  s_nop 1
  v_mfma_f32_32x32x16_bf16 v[240:255], v[52:55], v[32:35], v[240:255]
  s_cmp_eq_u32 s53, 0
  s_cbranch_scc0 L_nopoll0
  buffer_load_dword v61, v62, s[76:79], 0 offen sc1
  s_waitcnt vmcnt(1)
  s_branch L_lastpv
L_nopoll0:
  s_waitcnt vmcnt(0)
L_lastpv:
  s_cmp_eq_u32 s3, 1
  s_cbranch_scc1 L_wr1
  s_cmp_eq_u32 s3, 2
  s_cbranch_scc1 L_wr2
  s_cmp_eq_u32 s3, 3
  s_cbranch_scc1 L_wr3
  v_perm_b32 v40, v100, v96, s41
  v_perm_b32 v41, v108, v104, s41
  v_perm_b32 v42, v116, v112, s41
  v_perm_b32 v43, v124, v120, s41
  s_nop 1
  v_mfma_f32_32x32x16_bf16 v[128:143], v[40:43], v[36:39], v[128:143]
  v_perm_b32 v44, v100, v96, s42
  v_perm_b32 v45, v108, v104, s42
  v_perm_b32 v46, v116, v112, s42
  v_perm_b32 v47, v124, v120, s42
  s_nop 1
  v_mfma_f32_32x32x16_bf16 v[144:159], v[44:47], v[36:39], v[144:159]
  v_perm_b32 v48, v101, v97, s41
  v_perm_b32 v49, v109, v105, s41
  v_perm_b32 v50, v117, v113, s41
  v_perm_b32 v51, v125, v121, s41
  s_nop 1
  v_mfma_f32_32x32x16_bf16 v[160:175], v[48:51], v[36:39], v[160:175]
  ds_write_b128 v4, v[132:135] offset:8192
  ds_write_b128 v4, v[136:139] offset:16384
  ds_write_b128 v4, v[140:143] offset:24576
  v_perm_b32 v52, v101, v97, s42
  v_perm_b32 v53, v109, v105, s42
  v_perm_b32 v54, v117, v113, s42
  v_perm_b32 v55, v125, v121, s42
  s_nop 1
  v_mfma_f32_32x32x16_bf16 v[176:191], v[52:55], v[36:39], v[176:191]
  ds_write_b128 v4, v[148:151] offset:9216
  ds_write_b128 v4, v[152:155] offset:17408
  ds_write_b128 v4, v[156:159] offset:25600
  v_perm_b32 v40, v102, v98, s41
  v_perm_b32 v41, v110, v106, s41
  v_perm_b32 v42, v118, v114, s41
  v_perm_b32 v43, v126, v122, s41
  s_nop 1
  v_mfma_f32_32x32x16_bf16 v[192:207], v[40:43], v[36:39], v[192:207]
  ds_write_b128 v4, v[164:167] offset:10240
  ds_write_b128 v4, v[168:171] offset:18432
  ds_write_b128 v4, v[172:175] offset:26624
  v_perm_b32 v44, v102, v98, s42
  v_perm_b32 v45, v110, v106, s42
  v_perm_b32 v46, v118, v114, s42
  v_perm_b32 v47, v126, v122, s42
  s_nop 1
  v_mfma_f32_32x32x16_bf16 v[208:223], v[44:47], v[36:39], v[208:223]
  ds_write_b128 v4, v[180:183] offset:11264
  ds_write_b128 v4, v[184:187] offset:19456
  ds_write_b128 v4, v[188:191] offset:27648
  v_perm_b32 v48, v103, v99, s41
  v_perm_b32 v49, v111, v107, s41
  v_perm_b32 v50, v119, v115, s41
  v_perm_b32 v51, v127, v123, s41
  s_nop 1
  v_mfma_f32_32x32x16_bf16 v[224:239], v[48:51], v[36:39], v[224:239]
  ds_write_b128 v4, v[196:199] offset:12288
  ds_write_b128 v4, v[200:203] offset:20480
  ds_write_b128 v4, v[204:207] offset:28672
  v_perm_b32 v52, v103, v99, s42
  v_perm_b32 v53, v111, v107, s42
  v_perm_b32 v54, v119, v115, s42
  v_perm_b32 v55, v127, v123, s42
  s_nop 1
  v_mfma_f32_32x32x16_bf16 v[240:255], v[52:55], v[36:39], v[240:255]
  ds_write_b128 v4, v[212:215] offset:13312
  ds_write_b128 v4, v[216:219] offset:21504
  ds_write_b128 v4, v[220:223] offset:29696
  s_nop 7
  ds_write_b128 v4, v[228:231] offset:14336
  ds_write_b128 v4, v[232:235] offset:22528
  ds_write_b128 v4, v[236:239] offset:30720
  s_nop 3
  ds_write_b128 v4, v[244:247] offset:15360
  ds_write_b128 v4, v[248:251] offset:23552
  ds_write_b128 v4, v[252:255] offset:31744
  s_branch L_wr_done
L_wr1:
  v_perm_b32 v40, v100, v96, s41
  v_perm_b32 v41, v108, v104, s41
  v_perm_b32 v42, v116, v112, s41
  v_perm_b32 v43, v124, v120, s41
  s_nop 1
  v_mfma_f32_32x32x16_bf16 v[128:143], v[40:43], v[36:39], v[128:143]
  v_perm_b32 v44, v100, v96, s42
  v_perm_b32 v45, v108, v104, s42
  v_perm_b32 v46, v116, v112, s42
  v_perm_b32 v47, v124, v120, s42
  s_nop 1
  v_mfma_f32_32x32x16_bf16 v[144:159], v[44:47], v[36:39], v[144:159]
  v_perm_b32 v48, v101, v97, s41
  v_perm_b32 v49, v109, v105, s41
  v_perm_b32 v50, v117, v113, s41
  v_perm_b32 v51, v125, v121, s41
  s_nop 1
  v_mfma_f32_32x32x16_bf16 v[160:175], v[48:51], v[36:39], v[160:175]
  ds_write_b128 v4, v[128:131] offset:0
  ds_write_b128 v4, v[136:139] offset:16384
  ds_write_b128 v4, v[140:143] offset:24576
  v_perm_b32 v52, v101, v97, s42
  v_perm_b32 v53, v109, v105, s42
  v_perm_b32 v54, v117, v113, s42
  v_perm_b32 v55, v125, v121, s42
  s_nop 1
  v_mfma_f32_32x32x16_bf16 v[176:191], v[52:55], v[36:39], v[176:191]
  ds_write_b128 v4, v[144:147] offset:1024
  ds_write_b128 v4, v[152:155] offset:17408
  ds_write_b128 v4, v[156:159] offset:25600
  v_perm_b32 v40, v102, v98, s41
  v_perm_b32 v41, v110, v106, s41
  v_perm_b32 v42, v118, v114, s41
  v_perm_b32 v43, v126, v122, s41
  s_nop 1
  v_mfma_f32_32x32x16_bf16 v[192:207], v[40:43], v[36:39], v[192:207]
  ds_write_b128 v4, v[160:163] offset:2048
  ds_write_b128 v4, v[168:171] offset:18432
  ds_write_b128 v4, v[172:175] offset:26624
  v_perm_b32 v44, v102, v98, s42
  v_perm_b32 v45, v110, v106, s42
  v_perm_b32 v46, v118, v114, s42
  v_perm_b32 v47, v126, v122, s42
  s_nop 1
  v_mfma_f32_32x32x16_bf16 v[208:223], v[44:47], v[36:39], v[208:223]
  ds_write_b128 v4, v[176:179] offset:3072
  ds_write_b128 v4, v[184:187] offset:19456
  ds_write_b128 v4, v[188:191] offset:27648
  v_perm_b32 v48, v103, v99, s41
  v_perm_b32 v49, v111, v107, s41
  v_perm_b32 v50, v119, v115, s41
  v_perm_b32 v51, v127, v123, s41
  s_nop 1
  v_mfma_f32_32x32x16_bf16 v[224:239], v[48:51], v[36:39], v[224:239]
  ds_write_b128 v4, v[192:195] offset:4096
  ds_write_b128 v4, v[200:203] offset:20480
  ds_write_b128 v4, v[204:207] offset:28672
  v_perm_b32 v52, v103, v99, s42
  v_perm_b32 v53, v111, v107, s42
  v_perm_b32 v54, v119, v115, s42
  v_perm_b32 v55, v127, v123, s42
  s_nop 1
  v_mfma_f32_32x32x16_bf16 v[240:255], v[52:55], v[36:39], v[240:255]
  ds_write_b128 v4, v[208:211] offset:5120
  ds_write_b128 v4, v[216:219] offset:21504
  ds_write_b128 v4, v[220:223] offset:29696
  s_nop 7
  ds_write_b128 v4, v[224:227] offset:6144
  ds_write_b128 v4, v[232:235] offset:22528
  ds_write_b128 v4, v[236:239] offset:30720
  s_nop 3
  ds_write_b128 v4, v[240:243] offset:7168
  ds_write_b128 v4, v[248:251] offset:23552
  ds_write_b128 v4, v[252:255] offset:31744
  s_branch L_wr_done
L_wr2:
  v_perm_b32 v40, v100, v96, s41
  v_perm_b32 v41, v108, v104, s41
  v_perm_b32 v42, v116, v112, s41
  v_perm_b32 v43, v124, v120, s41
  s_nop 1
  v_mfma_f32_32x32x16_bf16 v[128:143], v[40:43], v[36:39], v[128:143]
  v_perm_b32 v44, v100, v96, s42
  v_perm_b32 v45, v108, v104, s42
  v_perm_b32 v46, v116, v112, s42
  v_perm_b32 v47, v124, v120, s42
  s_nop 1
  v_mfma_f32_32x32x16_bf16 v[144:159], v[44:47], v[36:39], v[144:159]
  v_perm_b32 v48, v101, v97, s41
  v_perm_b32 v49, v109, v105, s41
  v_perm_b32 v50, v117, v113, s41
  v_perm_b32 v51, v125, v121, s41
  s_nop 1
  v_mfma_f32_32x32x16_bf16 v[160:175], v[48:51], v[36:39], v[160:175]
  ds_write_b128 v4, v[128:131] offset:0
  ds_write_b128 v4, v[132:135] offset:8192
  ds_write_b128 v4, v[140:143] offset:24576
  v_perm_b32 v52, v101, v97, s42
  v_perm_b32 v53, v109, v105, s42
  v_perm_b32 v54, v117, v113, s42
  v_perm_b32 v55, v125, v121, s42
  s_nop 1
  v_mfma_f32_32x32x16_bf16 v[176:191], v[52:55], v[36:39], v[176:191]
  ds_write_b128 v4, v[144:147] offset:1024
  ds_write_b128 v4, v[148:151] offset:9216
  ds_write_b128 v4, v[156:159] offset:25600
  v_perm_b32 v40, v102, v98, s41
  v_perm_b32 v41, v110, v106, s41
  v_perm_b32 v42, v118, v114, s41
  v_perm_b32 v43, v126, v122, s41
  s_nop 1
  v_mfma_f32_32x32x16_bf16 v[192:207], v[40:43], v[36:39], v[192:207]
  ds_write_b128 v4, v[160:163] offset:2048
  ds_write_b128 v4, v[164:167] offset:10240
  ds_write_b128 v4, v[172:175] offset:26624
  v_perm_b32 v44, v102, v98, s42
  v_perm_b32 v45, v110, v106, s42
  v_perm_b32 v46, v118, v114, s42
  v_perm_b32 v47, v126, v122, s42
  s_nop 1
  v_mfma_f32_32x32x16_bf16 v[208:223], v[44:47], v[36:39], v[208:223]
  ds_write_b128 v4, v[176:179] offset:3072
  ds_write_b128 v4, v[180:183] offset:11264
  ds_write_b128 v4, v[188:191] offset:27648
  v_perm_b32 v48, v103, v99, s41
  v_perm_b32 v49, v111, v107, s41
  v_perm_b32 v50, v119, v115, s41
  v_perm_b32 v51, v127, v123, s41
  s_nop 1
  v_mfma_f32_32x32x16_bf16 v[224:239], v[48:51], v[36:39], v[224:239]
  ds_write_b128 v4, v[192:195] offset:4096
  ds_write_b128 v4, v[196:199] offset:12288
  ds_write_b128 v4, v[204:207] offset:28672
  v_perm_b32 v52, v103, v99, s42
  v_perm_b32 v53, v111, v107, s42
  v_perm_b32 v54, v119, v115, s42
  v_perm_b32 v55, v127, v123, s42
  s_nop 1
  v_mfma_f32_32x32x16_bf16 v[240:255], v[52:55], v[36:39], v[240:255]
  ds_write_b128 v4, v[208:211] offset:5120
  ds_write_b128 v4, v[212:215] offset:13312
  ds_write_b128 v4, v[220:223] offset:29696
  s_nop 7
  ds_write_b128 v4, v[224:227] offset:6144
  ds_write_b128 v4, v[228:231] offset:14336
  ds_write_b128 v4, v[236:239] offset:30720
  s_nop 3
  ds_write_b128 v4, v[240:243] offset:7168
  ds_write_b128 v4, v[244:247] offset:15360
  ds_write_b128 v4, v[252:255] offset:31744
  s_branch L_wr_done
L_wr3:
  v_perm_b32 v40, v100, v96, s41
  v_perm_b32 v41, v108, v104, s41
  v_perm_b32 v42, v116, v112, s41
  v_perm_b32 v43, v124, v120, s41
  s_nop 1
  v_mfma_f32_32x32x16_bf16 v[128:143], v[40:43], v[36:39], v[128:143]
  v_perm_b32 v44, v100, v96, s42
  v_perm_b32 v45, v108, v104, s42
  v_perm_b32 v46, v116, v112, s42
  v_perm_b32 v47, v124, v120, s42
  s_nop 1
  v_mfma_f32_32x32x16_bf16 v[144:159], v[44:47], v[36:39], v[144:159]
  v_perm_b32 v48, v101, v97, s41
  v_perm_b32 v49, v109, v105, s41
  v_perm_b32 v50, v117, v113, s41
  v_perm_b32 v51, v125, v121, s41
  s_nop 1
  v_mfma_f32_32x32x16_bf16 v[160:175], v[48:51], v[36:39], v[160:175]
  ds_write_b128 v4, v[128:131] offset:0
  ds_write_b128 v4, v[132:135] offset:8192
  ds_write_b128 v4, v[136:139] offset:16384
  v_perm_b32 v52, v101, v97, s42
  v_perm_b32 v53, v109, v105, s42
  v_perm_b32 v54, v117, v113, s42
  v_perm_b32 v55, v125, v121, s42
  s_nop 1
  v_mfma_f32_32x32x16_bf16 v[176:191], v[52:55], v[36:39], v[176:191]
  ds_write_b128 v4, v[144:147] offset:1024
  ds_write_b128 v4, v[148:151] offset:9216
  ds_write_b128 v4, v[152:155] offset:17408
  v_perm_b32 v40, v102, v98, s41
  v_perm_b32 v41, v110, v106, s41
  v_perm_b32 v42, v118, v114, s41
  v_perm_b32 v43, v126, v122, s41
  s_nop 1
  v_mfma_f32_32x32x16_bf16 v[192:207], v[40:43], v[36:39], v[192:207]
  ds_write_b128 v4, v[160:163] offset:2048
  ds_write_b128 v4, v[164:167] offset:10240
  ds_write_b128 v4, v[168:171] offset:18432
  v_perm_b32 v44, v102, v98, s42
  v_perm_b32 v45, v110, v106, s42
  v_perm_b32 v46, v118, v114, s42
  v_perm_b32 v47, v126, v122, s42
  s_nop 1
  v_mfma_f32_32x32x16_bf16 v[208:223], v[44:47], v[36:39], v[208:223]
  ds_write_b128 v4, v[176:179] offset:3072
  ds_write_b128 v4, v[180:183] offset:11264
  ds_write_b128 v4, v[184:187] offset:19456
  v_perm_b32 v48, v103, v99, s41
  v_perm_b32 v49, v111, v107, s41
  v_perm_b32 v50, v119, v115, s41
  v_perm_b32 v51, v127, v123, s41
  s_nop 1
  v_mfma_f32_32x32x16_bf16 v[224:239], v[48:51], v[36:39], v[224:239]
  ds_write_b128 v4, v[192:195] offset:4096
  ds_write_b128 v4, v[196:199] offset:12288
  ds_write_b128 v4, v[200:203] offset:20480
  v_perm_b32 v52, v103, v99, s42
  v_perm_b32 v53, v111, v107, s42
  v_perm_b32 v54, v119, v115, s42
  v_perm_b32 v55, v127, v123, s42
  s_nop 1
  v_mfma_f32_32x32x16_bf16 v[240:255], v[52:55], v[36:39], v[240:255]
  ds_write_b128 v4, v[208:211] offset:5120
  ds_write_b128 v4, v[212:215] offset:13312
  ds_write_b128 v4, v[216:219] offset:21504
  s_nop 7
  ds_write_b128 v4, v[224:227] offset:6144
  ds_write_b128 v4, v[228:231] offset:14336
  ds_write_b128 v4, v[232:235] offset:22528
  s_nop 3
  ds_write_b128 v4, v[240:243] offset:7168
  ds_write_b128 v4, v[244:247] offset:15360
  ds_write_b128 v4, v[248:251] offset:23552
L_wr_done:
  s_cmp_eq_u32 s53, 0
  s_cbranch_scc0 L_nopre
  s_waitcnt vmcnt(0)
  v_readfirstlane_b32 s56, v61
  s_nop 3
  s_andn2_b32 s56, s56, s87
  s_or_b32 s87, s87, s56
  s_bitcmp1_b32 s56, 1
  s_cbranch_scc0 L_cl0_1
  s_add_u32 s57, s44, 32768
  s_add_u32 s58, s45, 32768
  buffer_load_dwordx4 v[112:115], v2, s[36:39], s58 offen sc1
  buffer_load_dwordx4 v[64:67], v2, s[36:39], s57 offen offset:0 sc1
  buffer_load_dwordx4 v[68:71], v2, s[36:39], s57 offen offset:1024 sc1
  buffer_load_dwordx4 v[72:75], v2, s[36:39], s57 offen offset:2048 sc1
  buffer_load_dwordx4 v[76:79], v2, s[36:39], s57 offen offset:3072 sc1
L_cl0_1:
  s_bitcmp1_b32 s56, 2
  s_cbranch_scc0 L_cl0_2
  s_add_u32 s57, s44, 65536
  s_add_u32 s58, s45, 65536
  buffer_load_dwordx4 v[116:119], v2, s[36:39], s58 offen sc1
  buffer_load_dwordx4 v[80:83], v2, s[36:39], s57 offen offset:0 sc1
  buffer_load_dwordx4 v[84:87], v2, s[36:39], s57 offen offset:1024 sc1
  buffer_load_dwordx4 v[88:91], v2, s[36:39], s57 offen offset:2048 sc1
  buffer_load_dwordx4 v[92:95], v2, s[36:39], s57 offen offset:3072 sc1
L_cl0_2:
  s_bitcmp1_b32 s56, 3
  s_cbranch_scc0 L_cl0_3
  s_add_u32 s57, s44, 98304
  s_add_u32 s58, s45, 98304
  buffer_load_dwordx4 v[120:123], v2, s[36:39], s58 offen sc1
  buffer_load_dwordx4 v[96:99], v2, s[36:39], s57 offen offset:0 sc1
  buffer_load_dwordx4 v[100:103], v2, s[36:39], s57 offen offset:1024 sc1
  buffer_load_dwordx4 v[104:107], v2, s[36:39], s57 offen offset:2048 sc1
  buffer_load_dwordx4 v[108:111], v2, s[36:39], s57 offen offset:3072 sc1
L_cl0_3:
  s_and_b32 s56, s87, 14
  s_cmp_eq_u32 s56, 14
  s_cbranch_scc1 L_cl0_all
  buffer_load_dword v61, v62, s[76:79], 0 offen sc1
L_cl0_all:
L_nopre:
  s_waitcnt lgkmcnt(0)
  s_barrier
  v_add_u32 v13, 131072, v12
  ds_read_b64 v[8:9], v13 offset:0
  ds_read_b64 v[10:11], v13 offset:256
  ds_read_b64 v[14:15], v13 offset:512
  ds_read_b64 v[56:57], v13 offset:768
  s_lshl_b32 s56, s3, 13
  v_add_u32 v4, s56, v2
  v_add_u32 v5, 0x10000, v4
  s_cmp_eq_u32 s3, 0
  s_cbranch_scc1 L_rd0
  ds_read_b128 v[128:131], v4 offset:0
  ds_read_b128 v[144:147], v4 offset:1024
  ds_read_b128 v[160:163], v4 offset:2048
  ds_read_b128 v[176:179], v4 offset:3072
  ds_read_b128 v[192:195], v4 offset:4096
  ds_read_b128 v[208:211], v4 offset:5120
  ds_read_b128 v[224:227], v4 offset:6144
  ds_read_b128 v[240:243], v4 offset:7168
L_rd0:
  s_cmp_eq_u32 s3, 1
  s_cbranch_scc1 L_rd1
  ds_read_b128 v[132:135], v4 offset:32768
  ds_read_b128 v[148:151], v4 offset:33792
  ds_read_b128 v[164:167], v4 offset:34816
  ds_read_b128 v[180:183], v4 offset:35840
  ds_read_b128 v[196:199], v4 offset:36864
  ds_read_b128 v[212:215], v4 offset:37888
  ds_read_b128 v[228:231], v4 offset:38912
  ds_read_b128 v[244:247], v4 offset:39936
L_rd1:
  s_cmp_eq_u32 s3, 2
  s_cbranch_scc1 L_rd2
  ds_read_b128 v[136:139], v5 offset:0
  ds_read_b128 v[152:155], v5 offset:1024
  ds_read_b128 v[168:171], v5 offset:2048
  ds_read_b128 v[184:187], v5 offset:3072
  ds_read_b128 v[200:203], v5 offset:4096
  ds_read_b128 v[216:219], v5 offset:5120
  ds_read_b128 v[232:235], v5 offset:6144
  ds_read_b128 v[248:251], v5 offset:7168
L_rd2:
  s_cmp_eq_u32 s3, 3
  s_cbranch_scc1 L_rd3
  ds_read_b128 v[140:143], v5 offset:32768
  ds_read_b128 v[156:159], v5 offset:33792
  ds_read_b128 v[172:175], v5 offset:34816
  ds_read_b128 v[188:191], v5 offset:35840
  ds_read_b128 v[204:207], v5 offset:36864
  ds_read_b128 v[220:223], v5 offset:37888
  ds_read_b128 v[236:239], v5 offset:38912
  ds_read_b128 v[252:255], v5 offset:39936
L_rd3:
  s_waitcnt lgkmcnt(15)
  v_max3_f32 v6, v8, v10, v14
  v_max_f32 v6, v6, v56
  v_sub_f32 v8, v8, v6
  v_sub_f32 v10, v10, v6
  v_sub_f32 v14, v14, v6
  v_sub_f32 v56, v56, v6
  v_exp_f32 v8, v8
  v_exp_f32 v10, v10
  v_exp_f32 v14, v14
  v_exp_f32 v56, v56
  s_nop 0
  v_mul_f32 v7, v8, v9
  v_fma_f32 v7, v10, v11, v7
  v_fma_f32 v7, v14, v15, v7
  v_fma_f32 v7, v56, v57, v7
  s_lshl_b32 s56, s53, 15
  s_add_u32 s57, s44, s56
  s_add_u32 s58, s57, 4096
  s_cmp_eq_u32 s53, 0
  s_cbranch_scc1 L_comb_fma
  s_waitcnt lgkmcnt(7)
  v_pk_mul_f32 v[128:129], v[128:129], v[8:9] op_sel_hi:[1,0]
  v_pk_mul_f32 v[130:131], v[130:131], v[8:9] op_sel_hi:[1,0]
  v_pk_fma_f32 v[128:129], v[132:133], v[10:11], v[128:129] op_sel_hi:[1,0,1]
  v_pk_fma_f32 v[130:131], v[134:135], v[10:11], v[130:131] op_sel_hi:[1,0,1]
  v_pk_fma_f32 v[128:129], v[136:137], v[14:15], v[128:129] op_sel_hi:[1,0,1]
  v_pk_fma_f32 v[130:131], v[138:139], v[14:15], v[130:131] op_sel_hi:[1,0,1]
  v_pk_fma_f32 v[128:129], v[140:141], v[56:57], v[128:129] op_sel_hi:[1,0,1]
  v_pk_fma_f32 v[130:131], v[142:143], v[56:57], v[130:131] op_sel_hi:[1,0,1]
  v_max3_f32 v13, |v128|, |v129|, |v130|
  v_max_f32 v13, v13, |v131|
  s_waitcnt lgkmcnt(6)
  v_pk_mul_f32 v[144:145], v[144:145], v[8:9] op_sel_hi:[1,0]
  v_pk_mul_f32 v[146:147], v[146:147], v[8:9] op_sel_hi:[1,0]
  v_pk_fma_f32 v[144:145], v[148:149], v[10:11], v[144:145] op_sel_hi:[1,0,1]
  v_pk_fma_f32 v[146:147], v[150:151], v[10:11], v[146:147] op_sel_hi:[1,0,1]
  v_pk_fma_f32 v[144:145], v[152:153], v[14:15], v[144:145] op_sel_hi:[1,0,1]
  v_pk_fma_f32 v[146:147], v[154:155], v[14:15], v[146:147] op_sel_hi:[1,0,1]
  v_pk_fma_f32 v[144:145], v[156:157], v[56:57], v[144:145] op_sel_hi:[1,0,1]
  v_pk_fma_f32 v[146:147], v[158:159], v[56:57], v[146:147] op_sel_hi:[1,0,1]
  v_max3_f32 v13, v13, |v144|, |v145|
  v_max3_f32 v13, v13, |v146|, |v147|
  s_waitcnt lgkmcnt(5)
  v_pk_mul_f32 v[160:161], v[160:161], v[8:9] op_sel_hi:[1,0]
  v_pk_mul_f32 v[162:163], v[162:163], v[8:9] op_sel_hi:[1,0]
  v_pk_fma_f32 v[160:161], v[164:165], v[10:11], v[160:161] op_sel_hi:[1,0,1]
  v_pk_fma_f32 v[162:163], v[166:167], v[10:11], v[162:163] op_sel_hi:[1,0,1]
  v_pk_fma_f32 v[160:161], v[168:169], v[14:15], v[160:161] op_sel_hi:[1,0,1]
  v_pk_fma_f32 v[162:163], v[170:171], v[14:15], v[162:163] op_sel_hi:[1,0,1]
  v_pk_fma_f32 v[160:161], v[172:173], v[56:57], v[160:161] op_sel_hi:[1,0,1]
  v_pk_fma_f32 v[162:163], v[174:175], v[56:57], v[162:163] op_sel_hi:[1,0,1]
  v_max3_f32 v13, v13, |v160|, |v161|
  v_max3_f32 v13, v13, |v162|, |v163|
  s_waitcnt lgkmcnt(4)
  v_pk_mul_f32 v[176:177], v[176:177], v[8:9] op_sel_hi:[1,0]
  v_pk_mul_f32 v[178:179], v[178:179], v[8:9] op_sel_hi:[1,0]
  v_pk_fma_f32 v[176:177], v[180:181], v[10:11], v[176:177] op_sel_hi:[1,0,1]
  v_pk_fma_f32 v[178:179], v[182:183], v[10:11], v[178:179] op_sel_hi:[1,0,1]
  v_pk_fma_f32 v[176:177], v[184:185], v[14:15], v[176:177] op_sel_hi:[1,0,1]
  v_pk_fma_f32 v[178:179], v[186:187], v[14:15], v[178:179] op_sel_hi:[1,0,1]
  v_pk_fma_f32 v[176:177], v[188:189], v[56:57], v[176:177] op_sel_hi:[1,0,1]
  v_pk_fma_f32 v[178:179], v[190:191], v[56:57], v[178:179] op_sel_hi:[1,0,1]
  v_max3_f32 v13, v13, |v176|, |v177|
  v_max3_f32 v13, v13, |v178|, |v179|
  s_waitcnt lgkmcnt(3)
  v_pk_mul_f32 v[192:193], v[192:193], v[8:9] op_sel_hi:[1,0]
  v_pk_mul_f32 v[194:195], v[194:195], v[8:9] op_sel_hi:[1,0]
  v_pk_fma_f32 v[192:193], v[196:197], v[10:11], v[192:193] op_sel_hi:[1,0,1]
  v_pk_fma_f32 v[194:195], v[198:199], v[10:11], v[194:195] op_sel_hi:[1,0,1]
  v_pk_fma_f32 v[192:193], v[200:201], v[14:15], v[192:193] op_sel_hi:[1,0,1]
  v_pk_fma_f32 v[194:195], v[202:203], v[14:15], v[194:195] op_sel_hi:[1,0,1]
  v_pk_fma_f32 v[192:193], v[204:205], v[56:57], v[192:193] op_sel_hi:[1,0,1]
  v_pk_fma_f32 v[194:195], v[206:207], v[56:57], v[194:195] op_sel_hi:[1,0,1]
  v_max3_f32 v13, v13, |v192|, |v193|
  v_max3_f32 v13, v13, |v194|, |v195|
  s_waitcnt lgkmcnt(2)
  v_pk_mul_f32 v[208:209], v[208:209], v[8:9] op_sel_hi:[1,0]
  v_pk_mul_f32 v[210:211], v[210:211], v[8:9] op_sel_hi:[1,0]
  v_pk_fma_f32 v[208:209], v[212:213], v[10:11], v[208:209] op_sel_hi:[1,0,1]
  v_pk_fma_f32 v[210:211], v[214:215], v[10:11], v[210:211] op_sel_hi:[1,0,1]
  v_pk_fma_f32 v[208:209], v[216:217], v[14:15], v[208:209] op_sel_hi:[1,0,1]
  v_pk_fma_f32 v[210:211], v[218:219], v[14:15], v[210:211] op_sel_hi:[1,0,1]
  v_pk_fma_f32 v[208:209], v[220:221], v[56:57], v[208:209] op_sel_hi:[1,0,1]
  v_pk_fma_f32 v[210:211], v[222:223], v[56:57], v[210:211] op_sel_hi:[1,0,1]
  v_max3_f32 v13, v13, |v208|, |v209|
  v_max3_f32 v13, v13, |v210|, |v211|
  s_waitcnt lgkmcnt(1)
  v_pk_mul_f32 v[224:225], v[224:225], v[8:9] op_sel_hi:[1,0]
  v_pk_mul_f32 v[226:227], v[226:227], v[8:9] op_sel_hi:[1,0]
  v_pk_fma_f32 v[224:225], v[228:229], v[10:11], v[224:225] op_sel_hi:[1,0,1]
  v_pk_fma_f32 v[226:227], v[230:231], v[10:11], v[226:227] op_sel_hi:[1,0,1]
  v_pk_fma_f32 v[224:225], v[232:233], v[14:15], v[224:225] op_sel_hi:[1,0,1]
  v_pk_fma_f32 v[226:227], v[234:235], v[14:15], v[226:227] op_sel_hi:[1,0,1]
  v_pk_fma_f32 v[224:225], v[236:237], v[56:57], v[224:225] op_sel_hi:[1,0,1]
  v_pk_fma_f32 v[226:227], v[238:239], v[56:57], v[226:227] op_sel_hi:[1,0,1]
  v_max3_f32 v13, v13, |v224|, |v225|
  v_max3_f32 v13, v13, |v226|, |v227|
  s_waitcnt lgkmcnt(0)
  v_pk_mul_f32 v[240:241], v[240:241], v[8:9] op_sel_hi:[1,0]
  v_pk_mul_f32 v[242:243], v[242:243], v[8:9] op_sel_hi:[1,0]
  v_pk_fma_f32 v[240:241], v[244:245], v[10:11], v[240:241] op_sel_hi:[1,0,1]
  v_pk_fma_f32 v[242:243], v[246:247], v[10:11], v[242:243] op_sel_hi:[1,0,1]
  v_pk_fma_f32 v[240:241], v[248:249], v[14:15], v[240:241] op_sel_hi:[1,0,1]
  v_pk_fma_f32 v[242:243], v[250:251], v[14:15], v[242:243] op_sel_hi:[1,0,1]
  v_pk_fma_f32 v[240:241], v[252:253], v[56:57], v[240:241] op_sel_hi:[1,0,1]
  v_pk_fma_f32 v[242:243], v[254:255], v[56:57], v[242:243] op_sel_hi:[1,0,1]
  v_max3_f32 v13, v13, |v240|, |v241|
  v_max3_f32 v13, v13, |v242|, |v243|
  v_frexp_exp_i32_f32 v13, v13
  v_max_i32 v13, -100, v13
  v_sub_u32 v5, 14, v13
  v_ldexp_f32 v10, 1.0, v5
  v_subrev_u32 v5, 14, v13
  v_ldexp_f32 v8, 1.0, v5
  v_pk_mul_f32 v[128:129], v[128:129], v[10:11] op_sel_hi:[1,0]
  v_pk_mul_f32 v[130:131], v[130:131], v[10:11] op_sel_hi:[1,0]
  v_cvt_pk_f16_f32 v64, v128, v129
  v_cvt_pk_f16_f32 v65, v130, v131
  v_pk_mul_f32 v[144:145], v[144:145], v[10:11] op_sel_hi:[1,0]
  v_pk_mul_f32 v[146:147], v[146:147], v[10:11] op_sel_hi:[1,0]
  v_cvt_pk_f16_f32 v66, v144, v145
  v_cvt_pk_f16_f32 v67, v146, v147
  buffer_store_dwordx4 v[64:67], v2, s[36:39], s57 offen offset:0 sc1
  v_pk_mul_f32 v[160:161], v[160:161], v[10:11] op_sel_hi:[1,0]
  v_pk_mul_f32 v[162:163], v[162:163], v[10:11] op_sel_hi:[1,0]
  v_cvt_pk_f16_f32 v68, v160, v161
  v_cvt_pk_f16_f32 v69, v162, v163
  v_pk_mul_f32 v[176:177], v[176:177], v[10:11] op_sel_hi:[1,0]
  v_pk_mul_f32 v[178:179], v[178:179], v[10:11] op_sel_hi:[1,0]
  v_cvt_pk_f16_f32 v70, v176, v177
  v_cvt_pk_f16_f32 v71, v178, v179
  buffer_store_dwordx4 v[68:71], v2, s[36:39], s57 offen offset:1024 sc1
  v_pk_mul_f32 v[192:193], v[192:193], v[10:11] op_sel_hi:[1,0]
  v_pk_mul_f32 v[194:195], v[194:195], v[10:11] op_sel_hi:[1,0]
  v_cvt_pk_f16_f32 v72, v192, v193
  v_cvt_pk_f16_f32 v73, v194, v195
  v_pk_mul_f32 v[208:209], v[208:209], v[10:11] op_sel_hi:[1,0]
  v_pk_mul_f32 v[210:211], v[210:211], v[10:11] op_sel_hi:[1,0]
  v_cvt_pk_f16_f32 v74, v208, v209
  v_cvt_pk_f16_f32 v75, v210, v211
  buffer_store_dwordx4 v[72:75], v2, s[36:39], s57 offen offset:2048 sc1
  v_pk_mul_f32 v[224:225], v[224:225], v[10:11] op_sel_hi:[1,0]
  v_pk_mul_f32 v[226:227], v[226:227], v[10:11] op_sel_hi:[1,0]
  v_cvt_pk_f16_f32 v76, v224, v225
  v_cvt_pk_f16_f32 v77, v226, v227
  v_pk_mul_f32 v[240:241], v[240:241], v[10:11] op_sel_hi:[1,0]
  v_pk_mul_f32 v[242:243], v[242:243], v[10:11] op_sel_hi:[1,0]
  v_cvt_pk_f16_f32 v78, v240, v241
  v_cvt_pk_f16_f32 v79, v242, v243
  buffer_store_dwordx4 v[76:79], v2, s[36:39], s57 offen offset:3072 sc1
  buffer_store_dwordx4 v[6:9], v2, s[36:39], s58 offen sc1
  s_lshl_b32 s56, 1, s53
  v_mov_b32 v56, s56
  s_waitcnt vmcnt(0)
  s_mov_b64 exec, 1
  buffer_atomic_or v56, v62, s[76:79], 0 offen
  s_mov_b64 exec, -1
  s_branch L_fin
L_comb_fma:
  s_waitcnt lgkmcnt(7)
  v_pk_mul_f32 v[128:129], v[128:129], v[8:9] op_sel_hi:[1,0]
  v_pk_mul_f32 v[130:131], v[130:131], v[8:9] op_sel_hi:[1,0]
  v_pk_fma_f32 v[128:129], v[132:133], v[10:11], v[128:129] op_sel_hi:[1,0,1]
  v_pk_fma_f32 v[130:131], v[134:135], v[10:11], v[130:131] op_sel_hi:[1,0,1]
  v_pk_fma_f32 v[128:129], v[136:137], v[14:15], v[128:129] op_sel_hi:[1,0,1]
  v_pk_fma_f32 v[130:131], v[138:139], v[14:15], v[130:131] op_sel_hi:[1,0,1]
  v_pk_fma_f32 v[128:129], v[140:141], v[56:57], v[128:129] op_sel_hi:[1,0,1]
  v_pk_fma_f32 v[130:131], v[142:143], v[56:57], v[130:131] op_sel_hi:[1,0,1]
  s_waitcnt lgkmcnt(6)
  v_pk_mul_f32 v[144:145], v[144:145], v[8:9] op_sel_hi:[1,0]
  v_pk_mul_f32 v[146:147], v[146:147], v[8:9] op_sel_hi:[1,0]
  v_pk_fma_f32 v[144:145], v[148:149], v[10:11], v[144:145] op_sel_hi:[1,0,1]
  v_pk_fma_f32 v[146:147], v[150:151], v[10:11], v[146:147] op_sel_hi:[1,0,1]
  v_pk_fma_f32 v[144:145], v[152:153], v[14:15], v[144:145] op_sel_hi:[1,0,1]
  v_pk_fma_f32 v[146:147], v[154:155], v[14:15], v[146:147] op_sel_hi:[1,0,1]
  v_pk_fma_f32 v[144:145], v[156:157], v[56:57], v[144:145] op_sel_hi:[1,0,1]
  v_pk_fma_f32 v[146:147], v[158:159], v[56:57], v[146:147] op_sel_hi:[1,0,1]
  s_waitcnt lgkmcnt(5)
  v_pk_mul_f32 v[160:161], v[160:161], v[8:9] op_sel_hi:[1,0]
  v_pk_mul_f32 v[162:163], v[162:163], v[8:9] op_sel_hi:[1,0]
  v_pk_fma_f32 v[160:161], v[164:165], v[10:11], v[160:161] op_sel_hi:[1,0,1]
  v_pk_fma_f32 v[162:163], v[166:167], v[10:11], v[162:163] op_sel_hi:[1,0,1]
  v_pk_fma_f32 v[160:161], v[168:169], v[14:15], v[160:161] op_sel_hi:[1,0,1]
  v_pk_fma_f32 v[162:163], v[170:171], v[14:15], v[162:163] op_sel_hi:[1,0,1]
  v_pk_fma_f32 v[160:161], v[172:173], v[56:57], v[160:161] op_sel_hi:[1,0,1]
  v_pk_fma_f32 v[162:163], v[174:175], v[56:57], v[162:163] op_sel_hi:[1,0,1]
  s_waitcnt lgkmcnt(4)
  v_pk_mul_f32 v[176:177], v[176:177], v[8:9] op_sel_hi:[1,0]
  v_pk_mul_f32 v[178:179], v[178:179], v[8:9] op_sel_hi:[1,0]
  v_pk_fma_f32 v[176:177], v[180:181], v[10:11], v[176:177] op_sel_hi:[1,0,1]
  v_pk_fma_f32 v[178:179], v[182:183], v[10:11], v[178:179] op_sel_hi:[1,0,1]
  v_pk_fma_f32 v[176:177], v[184:185], v[14:15], v[176:177] op_sel_hi:[1,0,1]
  v_pk_fma_f32 v[178:179], v[186:187], v[14:15], v[178:179] op_sel_hi:[1,0,1]
  v_pk_fma_f32 v[176:177], v[188:189], v[56:57], v[176:177] op_sel_hi:[1,0,1]
  v_pk_fma_f32 v[178:179], v[190:191], v[56:57], v[178:179] op_sel_hi:[1,0,1]
  s_waitcnt lgkmcnt(3)
  v_pk_mul_f32 v[192:193], v[192:193], v[8:9] op_sel_hi:[1,0]
  v_pk_mul_f32 v[194:195], v[194:195], v[8:9] op_sel_hi:[1,0]
  v_pk_fma_f32 v[192:193], v[196:197], v[10:11], v[192:193] op_sel_hi:[1,0,1]
  v_pk_fma_f32 v[194:195], v[198:199], v[10:11], v[194:195] op_sel_hi:[1,0,1]
  v_pk_fma_f32 v[192:193], v[200:201], v[14:15], v[192:193] op_sel_hi:[1,0,1]
  v_pk_fma_f32 v[194:195], v[202:203], v[14:15], v[194:195] op_sel_hi:[1,0,1]
  v_pk_fma_f32 v[192:193], v[204:205], v[56:57], v[192:193] op_sel_hi:[1,0,1]
  v_pk_fma_f32 v[194:195], v[206:207], v[56:57], v[194:195] op_sel_hi:[1,0,1]
  s_waitcnt lgkmcnt(2)
  v_pk_mul_f32 v[208:209], v[208:209], v[8:9] op_sel_hi:[1,0]
  v_pk_mul_f32 v[210:211], v[210:211], v[8:9] op_sel_hi:[1,0]
  v_pk_fma_f32 v[208:209], v[212:213], v[10:11], v[208:209] op_sel_hi:[1,0,1]
  v_pk_fma_f32 v[210:211], v[214:215], v[10:11], v[210:211] op_sel_hi:[1,0,1]
  v_pk_fma_f32 v[208:209], v[216:217], v[14:15], v[208:209] op_sel_hi:[1,0,1]
  v_pk_fma_f32 v[210:211], v[218:219], v[14:15], v[210:211] op_sel_hi:[1,0,1]
  v_pk_fma_f32 v[208:209], v[220:221], v[56:57], v[208:209] op_sel_hi:[1,0,1]
  v_pk_fma_f32 v[210:211], v[222:223], v[56:57], v[210:211] op_sel_hi:[1,0,1]
  s_waitcnt lgkmcnt(1)
  v_pk_mul_f32 v[224:225], v[224:225], v[8:9] op_sel_hi:[1,0]
  v_pk_mul_f32 v[226:227], v[226:227], v[8:9] op_sel_hi:[1,0]
  v_pk_fma_f32 v[224:225], v[228:229], v[10:11], v[224:225] op_sel_hi:[1,0,1]
  v_pk_fma_f32 v[226:227], v[230:231], v[10:11], v[226:227] op_sel_hi:[1,0,1]
  v_pk_fma_f32 v[224:225], v[232:233], v[14:15], v[224:225] op_sel_hi:[1,0,1]
  v_pk_fma_f32 v[226:227], v[234:235], v[14:15], v[226:227] op_sel_hi:[1,0,1]
  v_pk_fma_f32 v[224:225], v[236:237], v[56:57], v[224:225] op_sel_hi:[1,0,1]
  v_pk_fma_f32 v[226:227], v[238:239], v[56:57], v[226:227] op_sel_hi:[1,0,1]
  s_waitcnt lgkmcnt(0)
  v_pk_mul_f32 v[240:241], v[240:241], v[8:9] op_sel_hi:[1,0]
  v_pk_mul_f32 v[242:243], v[242:243], v[8:9] op_sel_hi:[1,0]
  v_pk_fma_f32 v[240:241], v[244:245], v[10:11], v[240:241] op_sel_hi:[1,0,1]
  v_pk_fma_f32 v[242:243], v[246:247], v[10:11], v[242:243] op_sel_hi:[1,0,1]
  v_pk_fma_f32 v[240:241], v[248:249], v[14:15], v[240:241] op_sel_hi:[1,0,1]
  v_pk_fma_f32 v[242:243], v[250:251], v[14:15], v[242:243] op_sel_hi:[1,0,1]
  v_pk_fma_f32 v[240:241], v[252:253], v[56:57], v[240:241] op_sel_hi:[1,0,1]
  v_pk_fma_f32 v[242:243], v[254:255], v[56:57], v[242:243] op_sel_hi:[1,0,1]
  s_lshl_b32 s56, s52, 14
  s_add_u32 s8, s28, s56
  s_addc_u32 s9, s29, 0
  s_and_b32 s9, s9, 0xffff
  s_mov_b32 s10, 16384
  v_lshrrev_b32 v4, 5, v0
  v_lshlrev_b32 v4, 6, v4
  v_lshl_add_u32 v4, v12, 6, v4
  v_mov_b32 v16, v6
  v_mov_b32 v17, v7
  s_mov_b32 s54, 0x400000
L_poll:
  s_and_b32 s56, s87, 14
  s_cmp_eq_u32 s56, 14
  s_cbranch_scc1 L_loaded
  s_sub_u32 s54, s54, 1
  s_cmp_eq_u32 s54, 0
  s_cbranch_scc1 L_loaded
  s_waitcnt vmcnt(0)
  v_readfirstlane_b32 s56, v61
  s_nop 3
  s_andn2_b32 s56, s56, s87
  s_or_b32 s87, s87, s56
  s_bitcmp1_b32 s56, 1
  s_cbranch_scc0 L_cl1_1
  s_add_u32 s57, s44, 32768
  s_add_u32 s58, s45, 32768
  buffer_load_dwordx4 v[112:115], v2, s[36:39], s58 offen sc1
  buffer_load_dwordx4 v[64:67], v2, s[36:39], s57 offen offset:0 sc1
  buffer_load_dwordx4 v[68:71], v2, s[36:39], s57 offen offset:1024 sc1
  buffer_load_dwordx4 v[72:75], v2, s[36:39], s57 offen offset:2048 sc1
  buffer_load_dwordx4 v[76:79], v2, s[36:39], s57 offen offset:3072 sc1
L_cl1_1:
  s_bitcmp1_b32 s56, 2
  s_cbranch_scc0 L_cl1_2
  s_add_u32 s57, s44, 65536
  s_add_u32 s58, s45, 65536
  buffer_load_dwordx4 v[116:119], v2, s[36:39], s58 offen sc1
  buffer_load_dwordx4 v[80:83], v2, s[36:39], s57 offen offset:0 sc1
  buffer_load_dwordx4 v[84:87], v2, s[36:39], s57 offen offset:1024 sc1
  buffer_load_dwordx4 v[88:91], v2, s[36:39], s57 offen offset:2048 sc1
  buffer_load_dwordx4 v[92:95], v2, s[36:39], s57 offen offset:3072 sc1
L_cl1_2:
  s_bitcmp1_b32 s56, 3
  s_cbranch_scc0 L_cl1_3
  s_add_u32 s57, s44, 98304
  s_add_u32 s58, s45, 98304
  buffer_load_dwordx4 v[120:123], v2, s[36:39], s58 offen sc1
  buffer_load_dwordx4 v[96:99], v2, s[36:39], s57 offen offset:0 sc1
  buffer_load_dwordx4 v[100:103], v2, s[36:39], s57 offen offset:1024 sc1
  buffer_load_dwordx4 v[104:107], v2, s[36:39], s57 offen offset:2048 sc1
  buffer_load_dwordx4 v[108:111], v2, s[36:39], s57 offen offset:3072 sc1
L_cl1_3:
  s_and_b32 s56, s87, 14
  s_cmp_eq_u32 s56, 14
  s_cbranch_scc1 L_cl1_all
  buffer_load_dword v61, v62, s[76:79], 0 offen sc1
L_cl1_all:
  s_branch L_poll
L_loaded:
  s_lshl_b32 s57, s3, 7
  s_waitcnt vmcnt(0)
  v_mov_b32 v18, v112
  v_mov_b32 v19, v113
  v_mov_b32 v20, v116
  v_mov_b32 v21, v117
  v_mov_b32 v22, v120
  v_mov_b32 v23, v121
  v_max3_f32 v6, v16, v18, v20
  v_max_f32 v6, v6, v22
  v_sub_f32 v16, v16, v6
  v_sub_f32 v18, v18, v6
  v_sub_f32 v20, v20, v6
  v_sub_f32 v22, v22, v6
  v_exp_f32 v16, v16
  v_exp_f32 v18, v18
  v_exp_f32 v20, v20
  v_exp_f32 v22, v22
  s_nop 0
  v_mul_f32 v7, v16, v17
  v_fma_f32 v7, v18, v19, v7
  v_fma_f32 v7, v20, v21, v7
  v_fma_f32 v7, v22, v23, v7
  v_rcp_f32 v7, v7
  s_nop 0
  v_mul_f32 v16, v16, v7
  v_mul_f32 v18, v18, v7
  v_mul_f32 v20, v20, v7
  v_mul_f32 v22, v22, v7
  v_mul_f32 v18, v18, v114
  v_mul_f32 v20, v20, v118
  v_mul_f32 v22, v22, v122
  v_pk_mul_f32 v[128:129], v[128:129], v[16:17] op_sel_hi:[1,0]
  v_pk_mul_f32 v[130:131], v[130:131], v[16:17] op_sel_hi:[1,0]
  v_fma_mix_f32 v128, v64, v18, v128 op_sel:[0,0,0] op_sel_hi:[1,0,0]
  v_fma_mix_f32 v129, v64, v18, v129 op_sel:[1,0,0] op_sel_hi:[1,0,0]
  v_fma_mix_f32 v130, v65, v18, v130 op_sel:[0,0,0] op_sel_hi:[1,0,0]
  v_fma_mix_f32 v131, v65, v18, v131 op_sel:[1,0,0] op_sel_hi:[1,0,0]
  v_fma_mix_f32 v128, v80, v20, v128 op_sel:[0,0,0] op_sel_hi:[1,0,0]
  v_fma_mix_f32 v129, v80, v20, v129 op_sel:[1,0,0] op_sel_hi:[1,0,0]
  v_fma_mix_f32 v130, v81, v20, v130 op_sel:[0,0,0] op_sel_hi:[1,0,0]
  v_fma_mix_f32 v131, v81, v20, v131 op_sel:[1,0,0] op_sel_hi:[1,0,0]
  v_fma_mix_f32 v128, v96, v22, v128 op_sel:[0,0,0] op_sel_hi:[1,0,0]
  v_fma_mix_f32 v129, v96, v22, v129 op_sel:[1,0,0] op_sel_hi:[1,0,0]
  v_fma_mix_f32 v130, v97, v22, v130 op_sel:[0,0,0] op_sel_hi:[1,0,0]
  v_fma_mix_f32 v131, v97, v22, v131 op_sel:[1,0,0] op_sel_hi:[1,0,0]
  v_pk_mul_f32 v[144:145], v[144:145], v[16:17] op_sel_hi:[1,0]
  v_pk_mul_f32 v[146:147], v[146:147], v[16:17] op_sel_hi:[1,0]
  v_fma_mix_f32 v144, v66, v18, v144 op_sel:[0,0,0] op_sel_hi:[1,0,0]
  v_fma_mix_f32 v145, v66, v18, v145 op_sel:[1,0,0] op_sel_hi:[1,0,0]
  v_fma_mix_f32 v146, v67, v18, v146 op_sel:[0,0,0] op_sel_hi:[1,0,0]
  v_fma_mix_f32 v147, v67, v18, v147 op_sel:[1,0,0] op_sel_hi:[1,0,0]
  v_fma_mix_f32 v144, v82, v20, v144 op_sel:[0,0,0] op_sel_hi:[1,0,0]
  v_fma_mix_f32 v145, v82, v20, v145 op_sel:[1,0,0] op_sel_hi:[1,0,0]
  v_fma_mix_f32 v146, v83, v20, v146 op_sel:[0,0,0] op_sel_hi:[1,0,0]
  v_fma_mix_f32 v147, v83, v20, v147 op_sel:[1,0,0] op_sel_hi:[1,0,0]
  v_fma_mix_f32 v144, v98, v22, v144 op_sel:[0,0,0] op_sel_hi:[1,0,0]
  v_fma_mix_f32 v145, v98, v22, v145 op_sel:[1,0,0] op_sel_hi:[1,0,0]
  v_fma_mix_f32 v146, v99, v22, v146 op_sel:[0,0,0] op_sel_hi:[1,0,0]
  v_fma_mix_f32 v147, v99, v22, v147 op_sel:[1,0,0] op_sel_hi:[1,0,0]
  v_pk_mul_f32 v[160:161], v[160:161], v[16:17] op_sel_hi:[1,0]
  v_pk_mul_f32 v[162:163], v[162:163], v[16:17] op_sel_hi:[1,0]
  v_fma_mix_f32 v160, v68, v18, v160 op_sel:[0,0,0] op_sel_hi:[1,0,0]
  v_fma_mix_f32 v161, v68, v18, v161 op_sel:[1,0,0] op_sel_hi:[1,0,0]
  v_fma_mix_f32 v162, v69, v18, v162 op_sel:[0,0,0] op_sel_hi:[1,0,0]
  v_fma_mix_f32 v163, v69, v18, v163 op_sel:[1,0,0] op_sel_hi:[1,0,0]
  v_fma_mix_f32 v160, v84, v20, v160 op_sel:[0,0,0] op_sel_hi:[1,0,0]
  v_fma_mix_f32 v161, v84, v20, v161 op_sel:[1,0,0] op_sel_hi:[1,0,0]
  v_fma_mix_f32 v162, v85, v20, v162 op_sel:[0,0,0] op_sel_hi:[1,0,0]
  v_fma_mix_f32 v163, v85, v20, v163 op_sel:[1,0,0] op_sel_hi:[1,0,0]
  v_fma_mix_f32 v160, v100, v22, v160 op_sel:[0,0,0] op_sel_hi:[1,0,0]
  v_fma_mix_f32 v161, v100, v22, v161 op_sel:[1,0,0] op_sel_hi:[1,0,0]
  v_fma_mix_f32 v162, v101, v22, v162 op_sel:[0,0,0] op_sel_hi:[1,0,0]
  v_fma_mix_f32 v163, v101, v22, v163 op_sel:[1,0,0] op_sel_hi:[1,0,0]
  v_pk_mul_f32 v[176:177], v[176:177], v[16:17] op_sel_hi:[1,0]
  v_pk_mul_f32 v[178:179], v[178:179], v[16:17] op_sel_hi:[1,0]
  v_fma_mix_f32 v176, v70, v18, v176 op_sel:[0,0,0] op_sel_hi:[1,0,0]
  v_fma_mix_f32 v177, v70, v18, v177 op_sel:[1,0,0] op_sel_hi:[1,0,0]
  v_fma_mix_f32 v178, v71, v18, v178 op_sel:[0,0,0] op_sel_hi:[1,0,0]
  v_fma_mix_f32 v179, v71, v18, v179 op_sel:[1,0,0] op_sel_hi:[1,0,0]
  v_fma_mix_f32 v176, v86, v20, v176 op_sel:[0,0,0] op_sel_hi:[1,0,0]
  v_fma_mix_f32 v177, v86, v20, v177 op_sel:[1,0,0] op_sel_hi:[1,0,0]
  v_fma_mix_f32 v178, v87, v20, v178 op_sel:[0,0,0] op_sel_hi:[1,0,0]
  v_fma_mix_f32 v179, v87, v20, v179 op_sel:[1,0,0] op_sel_hi:[1,0,0]
  v_fma_mix_f32 v176, v102, v22, v176 op_sel:[0,0,0] op_sel_hi:[1,0,0]
  v_fma_mix_f32 v177, v102, v22, v177 op_sel:[1,0,0] op_sel_hi:[1,0,0]
  v_fma_mix_f32 v178, v103, v22, v178 op_sel:[0,0,0] op_sel_hi:[1,0,0]
  v_fma_mix_f32 v179, v103, v22, v179 op_sel:[1,0,0] op_sel_hi:[1,0,0]
  v_pk_mul_f32 v[192:193], v[192:193], v[16:17] op_sel_hi:[1,0]
  v_pk_mul_f32 v[194:195], v[194:195], v[16:17] op_sel_hi:[1,0]
  v_fma_mix_f32 v192, v72, v18, v192 op_sel:[0,0,0] op_sel_hi:[1,0,0]
  v_fma_mix_f32 v193, v72, v18, v193 op_sel:[1,0,0] op_sel_hi:[1,0,0]
  v_fma_mix_f32 v194, v73, v18, v194 op_sel:[0,0,0] op_sel_hi:[1,0,0]
  v_fma_mix_f32 v195, v73, v18, v195 op_sel:[1,0,0] op_sel_hi:[1,0,0]
  v_fma_mix_f32 v192, v88, v20, v192 op_sel:[0,0,0] op_sel_hi:[1,0,0]
  v_fma_mix_f32 v193, v88, v20, v193 op_sel:[1,0,0] op_sel_hi:[1,0,0]
  v_fma_mix_f32 v194, v89, v20, v194 op_sel:[0,0,0] op_sel_hi:[1,0,0]
  v_fma_mix_f32 v195, v89, v20, v195 op_sel:[1,0,0] op_sel_hi:[1,0,0]
  v_fma_mix_f32 v192, v104, v22, v192 op_sel:[0,0,0] op_sel_hi:[1,0,0]
  v_fma_mix_f32 v193, v104, v22, v193 op_sel:[1,0,0] op_sel_hi:[1,0,0]
  v_fma_mix_f32 v194, v105, v22, v194 op_sel:[0,0,0] op_sel_hi:[1,0,0]
  v_fma_mix_f32 v195, v105, v22, v195 op_sel:[1,0,0] op_sel_hi:[1,0,0]
  v_pk_mul_f32 v[208:209], v[208:209], v[16:17] op_sel_hi:[1,0]
  v_pk_mul_f32 v[210:211], v[210:211], v[16:17] op_sel_hi:[1,0]
  v_fma_mix_f32 v208, v74, v18, v208 op_sel:[0,0,0] op_sel_hi:[1,0,0]
  v_fma_mix_f32 v209, v74, v18, v209 op_sel:[1,0,0] op_sel_hi:[1,0,0]
  v_fma_mix_f32 v210, v75, v18, v210 op_sel:[0,0,0] op_sel_hi:[1,0,0]
  v_fma_mix_f32 v211, v75, v18, v211 op_sel:[1,0,0] op_sel_hi:[1,0,0]
  v_fma_mix_f32 v208, v90, v20, v208 op_sel:[0,0,0] op_sel_hi:[1,0,0]
  v_fma_mix_f32 v209, v90, v20, v209 op_sel:[1,0,0] op_sel_hi:[1,0,0]
  v_fma_mix_f32 v210, v91, v20, v210 op_sel:[0,0,0] op_sel_hi:[1,0,0]
  v_fma_mix_f32 v211, v91, v20, v211 op_sel:[1,0,0] op_sel_hi:[1,0,0]
  v_fma_mix_f32 v208, v106, v22, v208 op_sel:[0,0,0] op_sel_hi:[1,0,0]
  v_fma_mix_f32 v209, v106, v22, v209 op_sel:[1,0,0] op_sel_hi:[1,0,0]
  v_fma_mix_f32 v210, v107, v22, v210 op_sel:[0,0,0] op_sel_hi:[1,0,0]
  v_fma_mix_f32 v211, v107, v22, v211 op_sel:[1,0,0] op_sel_hi:[1,0,0]
  v_pk_mul_f32 v[224:225], v[224:225], v[16:17] op_sel_hi:[1,0]
  v_pk_mul_f32 v[226:227], v[226:227], v[16:17] op_sel_hi:[1,0]
  v_fma_mix_f32 v224, v76, v18, v224 op_sel:[0,0,0] op_sel_hi:[1,0,0]
  v_fma_mix_f32 v225, v76, v18, v225 op_sel:[1,0,0] op_sel_hi:[1,0,0]
  v_fma_mix_f32 v226, v77, v18, v226 op_sel:[0,0,0] op_sel_hi:[1,0,0]
  v_fma_mix_f32 v227, v77, v18, v227 op_sel:[1,0,0] op_sel_hi:[1,0,0]
  v_fma_mix_f32 v224, v92, v20, v224 op_sel:[0,0,0] op_sel_hi:[1,0,0]
  v_fma_mix_f32 v225, v92, v20, v225 op_sel:[1,0,0] op_sel_hi:[1,0,0]
  v_fma_mix_f32 v226, v93, v20, v226 op_sel:[0,0,0] op_sel_hi:[1,0,0]
  v_fma_mix_f32 v227, v93, v20, v227 op_sel:[1,0,0] op_sel_hi:[1,0,0]
  v_fma_mix_f32 v224, v108, v22, v224 op_sel:[0,0,0] op_sel_hi:[1,0,0]
  v_fma_mix_f32 v225, v108, v22, v225 op_sel:[1,0,0] op_sel_hi:[1,0,0]
  v_fma_mix_f32 v226, v109, v22, v226 op_sel:[0,0,0] op_sel_hi:[1,0,0]
  v_fma_mix_f32 v227, v109, v22, v227 op_sel:[1,0,0] op_sel_hi:[1,0,0]
  v_pk_mul_f32 v[240:241], v[240:241], v[16:17] op_sel_hi:[1,0]
  v_pk_mul_f32 v[242:243], v[242:243], v[16:17] op_sel_hi:[1,0]
  v_fma_mix_f32 v240, v78, v18, v240 op_sel:[0,0,0] op_sel_hi:[1,0,0]
  v_fma_mix_f32 v241, v78, v18, v241 op_sel:[1,0,0] op_sel_hi:[1,0,0]
  v_fma_mix_f32 v242, v79, v18, v242 op_sel:[0,0,0] op_sel_hi:[1,0,0]
  v_fma_mix_f32 v243, v79, v18, v243 op_sel:[1,0,0] op_sel_hi:[1,0,0]
  v_fma_mix_f32 v240, v94, v20, v240 op_sel:[0,0,0] op_sel_hi:[1,0,0]
  v_fma_mix_f32 v241, v94, v20, v241 op_sel:[1,0,0] op_sel_hi:[1,0,0]
  v_fma_mix_f32 v242, v95, v20, v242 op_sel:[0,0,0] op_sel_hi:[1,0,0]
  v_fma_mix_f32 v243, v95, v20, v243 op_sel:[1,0,0] op_sel_hi:[1,0,0]
  v_fma_mix_f32 v240, v110, v22, v240 op_sel:[0,0,0] op_sel_hi:[1,0,0]
  v_fma_mix_f32 v241, v110, v22, v241 op_sel:[1,0,0] op_sel_hi:[1,0,0]
  v_fma_mix_f32 v242, v111, v22, v242 op_sel:[0,0,0] op_sel_hi:[1,0,0]
  v_fma_mix_f32 v243, v111, v22, v243 op_sel:[1,0,0] op_sel_hi:[1,0,0]
  v_cvt_pk_bf16_f32 v32, v128, v144
  v_cvt_pk_bf16_f32 v33, v160, v176
  v_cvt_pk_bf16_f32 v34, v192, v208
  v_cvt_pk_bf16_f32 v35, v224, v240
  buffer_store_dwordx4 v[32:35], v4, s[8:11], s57 offen offset:0
  v_cvt_pk_bf16_f32 v36, v129, v145
  v_cvt_pk_bf16_f32 v37, v161, v177
  v_cvt_pk_bf16_f32 v38, v193, v209
  v_cvt_pk_bf16_f32 v39, v225, v241
  buffer_store_dwordx4 v[36:39], v4, s[8:11], s57 offen offset:16
  v_cvt_pk_bf16_f32 v40, v130, v146
  v_cvt_pk_bf16_f32 v41, v162, v178
  v_cvt_pk_bf16_f32 v42, v194, v210
  v_cvt_pk_bf16_f32 v43, v226, v242
  buffer_store_dwordx4 v[40:43], v4, s[8:11], s57 offen offset:32
  v_cvt_pk_bf16_f32 v44, v131, v147
  v_cvt_pk_bf16_f32 v45, v163, v179
  v_cvt_pk_bf16_f32 v46, v195, v211
  v_cvt_pk_bf16_f32 v47, v227, v243
  buffer_store_dwordx4 v[44:47], v4, s[8:11], s57 offen offset:48
L_fin:
L_done:
  s_endpgm
.section .rodata,"a"
.p2align 6
.amdhsa_kernel standalone__tree_speculative_verify_tree_attention_over_candidate_token_tree__sampling_kernel
  .amdhsa_next_free_vgpr 512
  .amdhsa_next_free_sgpr 96
  .amdhsa_accum_offset 256
  .amdhsa_group_segment_fixed_size 0
  .amdhsa_kernarg_size 72
  .amdhsa_user_sgpr_count 2
  .amdhsa_user_sgpr_kernarg_segment_ptr 1
  .amdhsa_system_sgpr_workgroup_id_x 1
.end_amdhsa_kernel
```
